```python
import torch

def _softmax(x, axis=-1):
    return torch.softmax(x, dim=axis)
def _gelu(x):
    return torch.nn.functional.gelu(x, approximate="tanh")
def _silu(x):
    return torch.nn.functional.silu(x)
def _sigmoid(x):
    return torch.sigmoid(x)
def _layernorm(x, axis=-1, eps=1e-5):
    m = x.mean(dim=axis, keepdim=True)
    v = x.var(dim=axis, keepdim=True, unbiased=False)
    return (x - m) / torch.sqrt(v + eps)
def _scatter_add(tgt, idx, src, axis=0):
    return tgt.clone().index_add_(axis, idx, src)
def _segment_sum(src, seg, n):
    out = torch.zeros((n,) + src.shape[1:], dtype=src.dtype)
    return out.index_add_(0, seg, src)
def _pad(x, pw):
    flat = tuple(v for pair in reversed(pw) for v in pair)
    return torch.nn.functional.pad(x, flat)

kernel_name = 'sequential_preLN__spectral_gfnet__dense_activation_squared_relu__prompt'

def setup_inputs():

    _w = (lambda a: (lambda t: t.to(torch.bfloat16) if t.is_floating_point() else t)(torch.as_tensor(a)))
    def _A_setup():
        B, S, D = 1, 2048, 640
        Df = D // 2 + 1
        return {
            "x": _w((lambda *s: torch.randn(*s, dtype=torch.bfloat16) * 0.05)(B, S, D)),
            "w_r": _w((lambda *s: torch.randn(*s, dtype=torch.bfloat16) * 0.4)(S, Df) * 0.02),
            "w_i": _w((lambda *s: torch.randn(*s, dtype=torch.bfloat16) * 0.4)(S, Df) * 0.02),
        }
    _A_in = _A_setup()

    def _B_setup():
        B, S, D, F = 1, 2048, 640, 1536
        return {
            "x": _w((lambda *s: torch.randn(*s, dtype=torch.bfloat16) * 0.05)(B, S, D)),
            "w1": _w((lambda *s: torch.randn(*s, dtype=torch.bfloat16) * 0.05)(D, F)),
            "b1": _w((lambda *s: torch.randn(*s, dtype=torch.bfloat16) * 0.2)(F)),
            "w2": _w((lambda *s: torch.randn(*s, dtype=torch.bfloat16) * 0.05)(F, D)),
            "b2": _w((lambda *s: torch.randn(*s, dtype=torch.bfloat16) * 1.6)(D)),
        }
    _B_in = _B_setup()

    return {
        "A_x": _A_in["x"],
        "A_w_r": _A_in["w_r"],
        "A_w_i": _A_in["w_i"],
        "B_x": _B_in["x"],
        "B_w1": _B_in["w1"],
        "B_b1": _B_in["b1"],
        "B_w2": _B_in["w2"],
        "B_b2": _B_in["b2"],
    }

def reference(A_x, A_w_r, A_w_i, B_x, B_w1, B_b1, B_w2, B_b2):
    def _A_ref(x, w_r, w_i):
        B, S, D = x.shape
        X = (lambda x, axes=(-2,-1): torch.fft.rfft2(x.float(), dim=axes))(x, axes=(-2, -1))
        W = w_r + 1j * w_i
        X = X * W
        y = (lambda x, s, axes=(-2,-1): torch.fft.irfft2(x, s=s, dim=axes).to(torch.bfloat16))(X, (S, D), axes=(-2, -1))
        return y

    def _B_ref(x, w1, b1, w2, b2):
        h = torch.einsum("bsd,df->bsf", x, w1) + b1
        zero = torch.zeros_like(h)
        r = torch.where(h > zero, h, zero)
        h = r * r
        out = torch.einsum("bsf,fd->bsd", h, w2) + b2
        return out

    x = A_x
    h = x + _A_ref(_layernorm(x, axis=-1), A_w_r, A_w_i)
    h2 = h + _B_ref(_layernorm(h, axis=-1), B_w1, B_b1, B_w2, B_b2)
    return h2
```

```asm
; @launch kernel=k1_kernel grid=(410,1,1) block=(320,1,1) lds=46080
; @launch kernel=k2_kernel grid=(801,1,1) block=(128,1,1) lds=38144
; @launch kernel=k3_kernel grid=(256,1,1) block=(320,1,1) lds=46080
; @launch kernel=k4_kernel grid=(256,1,1) block=(256,1,1) lds=122880
; @launch kernel=k5_kernel grid=(256,1,1) block=(256,1,1) lds=122880
.amdgcn_target "amdgcn-amd-amdhsa--gfx950"
.text
.p2align 8
.globl k1_kernel
.type k1_kernel,@function
k1_kernel:
    s_load_dwordx2 s[4:5], s[0:1], 0
    s_load_dwordx4 s[8:11], s[0:1], 8
    s_load_dwordx2 s[6:7], s[0:1], 80
    v_lshrrev_b32 v2, 6, v0
    v_and_b32 v1, 63, v0
    s_nop 0
    v_readfirstlane_b32 s3, v2
    s_waitcnt lgkmcnt(0)
    s_cmp_ge_u32 s2, 256
    s_cbranch_scc1 K1_helper
    s_add_u32 s12, s4, 0x0
    s_addc_u32 s13, s5, 0
    s_and_b32 s13, s13, 0xffff
    s_mov_b32 s14, 0x280000
    s_mov_b32 s15, 0x20000
    s_add_u32 s16, s6, 0x0
    s_addc_u32 s17, s7, 0
    s_and_b32 s17, s17, 0xffff
    s_mov_b32 s18, 0x508000
    s_mov_b32 s19, 0x20000
    s_getpc_b64 s[20:21]
L_pc_1:
    s_add_u32 s20, s20, twr - L_pc_1
    s_addc_u32 s21, s21, 0
    s_and_b32 s21, s21, 0xffff
    s_mov_b32 s22, 0x13c0
    s_mov_b32 s23, 0x20000
    s_mov_b32 s36, 4096
    v_lshrrev_b32 v3, 3, v0
    v_and_b32 v4, 7, v0
    s_cmp_ge_u32 s3, 4
    s_cbranch_scc1 K1_ld_skip
    s_lshl_b32 s37, s2, 3
    s_lshl_b32 s38, s3, 1
    s_add_u32 s37, s37, s38
    s_mul_i32 s37, s37, 1280
    v_lshlrev_b32 v5, 1, v1
    buffer_load_ushort v10, v5, s[12:15], s37 offen offset:0
    buffer_load_ushort v11, v5, s[12:15], s37 offen offset:1280
    buffer_load_ushort v12, v5, s[12:15], s37 offen offset:128
    buffer_load_ushort v13, v5, s[12:15], s37 offen offset:1408
    buffer_load_ushort v14, v5, s[12:15], s37 offen offset:256
    buffer_load_ushort v15, v5, s[12:15], s37 offen offset:1536
    buffer_load_ushort v16, v5, s[12:15], s37 offen offset:384
    buffer_load_ushort v17, v5, s[12:15], s37 offen offset:1664
    buffer_load_ushort v18, v5, s[12:15], s37 offen offset:512
    buffer_load_ushort v19, v5, s[12:15], s37 offen offset:1792
    buffer_load_ushort v20, v5, s[12:15], s37 offen offset:640
    buffer_load_ushort v21, v5, s[12:15], s37 offen offset:1920
    buffer_load_ushort v22, v5, s[12:15], s37 offen offset:768
    buffer_load_ushort v23, v5, s[12:15], s37 offen offset:2048
    buffer_load_ushort v24, v5, s[12:15], s37 offen offset:896
    buffer_load_ushort v25, v5, s[12:15], s37 offen offset:2176
    buffer_load_ushort v26, v5, s[12:15], s37 offen offset:1024
    buffer_load_ushort v27, v5, s[12:15], s37 offen offset:2304
    buffer_load_ushort v28, v5, s[12:15], s37 offen offset:1152
    buffer_load_ushort v29, v5, s[12:15], s37 offen offset:2432
    v_lshlrev_b32 v5, 3, v1
    buffer_load_dwordx2 v[50:51], v5, s[20:23], 0 offen offset:0
    buffer_load_dwordx2 v[52:53], v5, s[20:23], 0 offen offset:512
    buffer_load_dwordx2 v[54:55], v5, s[20:23], 0 offen offset:1024
    buffer_load_dwordx2 v[56:57], v5, s[20:23], 0 offen offset:1536
    buffer_load_dwordx2 v[58:59], v5, s[20:23], 0 offen offset:2048
    buffer_load_dwordx2 v[60:61], v5, s[20:23], 0 offen offset:2560
    buffer_load_dwordx2 v[62:63], v5, s[20:23], 0 offen offset:3072
    buffer_load_dwordx2 v[64:65], v5, s[20:23], 0 offen offset:3584
    buffer_load_dwordx2 v[66:67], v5, s[20:23], s36 offen
K1_ld_skip:
    v_lshlrev_b32 v5, 3, v4
    buffer_load_dwordx2 v[68:69], v5, s[20:23], s36 offen offset:512
    buffer_load_dwordx2 v[70:71], v5, s[20:23], s36 offen offset:576
    buffer_load_dwordx2 v[72:73], v5, s[20:23], s36 offen offset:640
    buffer_load_dwordx2 v[74:75], v5, s[20:23], s36 offen offset:704
    buffer_load_dwordx2 v[76:77], v5, s[20:23], s36 offen offset:768
    buffer_load_dwordx2 v[78:79], v5, s[20:23], s36 offen offset:832
    buffer_load_dwordx2 v[80:81], v5, s[20:23], s36 offen offset:896
    s_mov_b32 s24, 0x3f3504f3
    s_mov_b32 s25, 0x3f3504f3
    s_mov_b32 s26, 0x3e9e377a
    s_mov_b32 s27, 0x3e9e377a
    s_mov_b32 s28, 0xbf4f1bbd
    s_mov_b32 s29, 0xbf4f1bbd
    s_mov_b32 s30, 0x3f737871
    s_mov_b32 s31, 0x3f737871
    s_mov_b32 s32, 0x3f167918
    s_mov_b32 s33, 0x3f167918
    s_mov_b32 s40, 0x3acccccd
    s_mov_b32 s41, 0x3acccccd
    s_mov_b32 s42, 0x44200000
    s_mov_b32 s43, 0x44200000
    s_mov_b32 s44, 0x3727c5ac
    s_mov_b32 s45, 0x3727c5ac
    s_cmp_ge_u32 s3, 4
    s_cbranch_scc1 K1_s1_done
    s_waitcnt vmcnt(16)
    v_lshlrev_b32 v10, 16, v10
    v_lshlrev_b32 v11, 16, v11
    v_lshlrev_b32 v12, 16, v12
    v_lshlrev_b32 v13, 16, v13
    v_lshlrev_b32 v14, 16, v14
    v_lshlrev_b32 v15, 16, v15
    v_lshlrev_b32 v16, 16, v16
    v_lshlrev_b32 v17, 16, v17
    v_lshlrev_b32 v18, 16, v18
    v_lshlrev_b32 v19, 16, v19
    v_lshlrev_b32 v20, 16, v20
    v_lshlrev_b32 v21, 16, v21
    v_lshlrev_b32 v22, 16, v22
    v_lshlrev_b32 v23, 16, v23
    v_lshlrev_b32 v24, 16, v24
    v_lshlrev_b32 v25, 16, v25
    v_lshlrev_b32 v26, 16, v26
    v_lshlrev_b32 v27, 16, v27
    v_lshlrev_b32 v28, 16, v28
    v_lshlrev_b32 v29, 16, v29
    v_pk_add_f32 v[82:83], v[10:11], v[12:13]
    v_pk_add_f32 v[82:83], v[82:83], v[14:15]
    v_pk_add_f32 v[82:83], v[82:83], v[16:17]
    v_pk_add_f32 v[82:83], v[82:83], v[18:19]
    v_pk_add_f32 v[82:83], v[82:83], v[20:21]
    v_pk_add_f32 v[82:83], v[82:83], v[22:23]
    v_pk_add_f32 v[82:83], v[82:83], v[24:25]
    v_pk_add_f32 v[82:83], v[82:83], v[26:27]
    v_pk_add_f32 v[82:83], v[82:83], v[28:29]
    s_nop 1
    v_add_f32_dpp v82, v82, v82 quad_perm:[1,0,3,2] row_mask:0xf bank_mask:0xf
    v_add_f32_dpp v83, v83, v83 quad_perm:[1,0,3,2] row_mask:0xf bank_mask:0xf
    s_nop 1
    v_add_f32_dpp v82, v82, v82 quad_perm:[2,3,0,1] row_mask:0xf bank_mask:0xf
    v_add_f32_dpp v83, v83, v83 quad_perm:[2,3,0,1] row_mask:0xf bank_mask:0xf
    s_nop 1
    v_add_f32_dpp v82, v82, v82 row_half_mirror row_mask:0xf bank_mask:0xf
    v_add_f32_dpp v83, v83, v83 row_half_mirror row_mask:0xf bank_mask:0xf
    s_nop 1
    v_add_f32_dpp v82, v82, v82 row_mirror row_mask:0xf bank_mask:0xf
    v_add_f32_dpp v83, v83, v83 row_mirror row_mask:0xf bank_mask:0xf
    v_mov_b32 v94, v82
    v_mov_b32 v95, v83
    s_nop 1
    v_permlane16_swap_b32 v82, v94
    v_permlane16_swap_b32 v83, v95
    s_nop 0
    v_add_f32 v82, v82, v94
    v_add_f32 v83, v83, v95
    v_mov_b32 v94, v82
    v_mov_b32 v95, v83
    s_nop 1
    v_permlane32_swap_b32 v82, v94
    v_permlane32_swap_b32 v83, v95
    s_nop 0
    v_add_f32 v82, v82, v94
    v_add_f32 v83, v83, v95
    v_pk_mul_f32 v[84:85], v[82:83], s[40:41]
    v_pk_fma_f32 v[94:95], v[84:85], s[42:43], v[82:83] neg_lo:[1,0,0] neg_hi:[1,0,0]
    v_pk_fma_f32 v[84:85], v[94:95], s[40:41], v[84:85]
    v_pk_add_f32 v[90:91], v[10:11], v[84:85] neg_lo:[0,1] neg_hi:[0,1]
    v_pk_mul_f32 v[82:83], v[90:91], v[90:91]
    v_pk_add_f32 v[90:91], v[12:13], v[84:85] neg_lo:[0,1] neg_hi:[0,1]
    v_pk_fma_f32 v[82:83], v[90:91], v[90:91], v[82:83]
    v_pk_add_f32 v[90:91], v[14:15], v[84:85] neg_lo:[0,1] neg_hi:[0,1]
    v_pk_fma_f32 v[82:83], v[90:91], v[90:91], v[82:83]
    v_pk_add_f32 v[90:91], v[16:17], v[84:85] neg_lo:[0,1] neg_hi:[0,1]
    v_pk_fma_f32 v[82:83], v[90:91], v[90:91], v[82:83]
    v_pk_add_f32 v[90:91], v[18:19], v[84:85] neg_lo:[0,1] neg_hi:[0,1]
    v_pk_fma_f32 v[82:83], v[90:91], v[90:91], v[82:83]
    v_pk_add_f32 v[90:91], v[20:21], v[84:85] neg_lo:[0,1] neg_hi:[0,1]
    v_pk_fma_f32 v[82:83], v[90:91], v[90:91], v[82:83]
    v_pk_add_f32 v[90:91], v[22:23], v[84:85] neg_lo:[0,1] neg_hi:[0,1]
    v_pk_fma_f32 v[82:83], v[90:91], v[90:91], v[82:83]
    v_pk_add_f32 v[90:91], v[24:25], v[84:85] neg_lo:[0,1] neg_hi:[0,1]
    v_pk_fma_f32 v[82:83], v[90:91], v[90:91], v[82:83]
    v_pk_add_f32 v[90:91], v[26:27], v[84:85] neg_lo:[0,1] neg_hi:[0,1]
    v_pk_fma_f32 v[82:83], v[90:91], v[90:91], v[82:83]
    v_pk_add_f32 v[90:91], v[28:29], v[84:85] neg_lo:[0,1] neg_hi:[0,1]
    v_pk_fma_f32 v[82:83], v[90:91], v[90:91], v[82:83]
    s_nop 1
    v_add_f32_dpp v82, v82, v82 quad_perm:[1,0,3,2] row_mask:0xf bank_mask:0xf
    v_add_f32_dpp v83, v83, v83 quad_perm:[1,0,3,2] row_mask:0xf bank_mask:0xf
    s_nop 1
    v_add_f32_dpp v82, v82, v82 quad_perm:[2,3,0,1] row_mask:0xf bank_mask:0xf
    v_add_f32_dpp v83, v83, v83 quad_perm:[2,3,0,1] row_mask:0xf bank_mask:0xf
    s_nop 1
    v_add_f32_dpp v82, v82, v82 row_half_mirror row_mask:0xf bank_mask:0xf
    v_add_f32_dpp v83, v83, v83 row_half_mirror row_mask:0xf bank_mask:0xf
    s_nop 1
    v_add_f32_dpp v82, v82, v82 row_mirror row_mask:0xf bank_mask:0xf
    v_add_f32_dpp v83, v83, v83 row_mirror row_mask:0xf bank_mask:0xf
    v_mov_b32 v94, v82
    v_mov_b32 v95, v83
    s_nop 1
    v_permlane16_swap_b32 v82, v94
    v_permlane16_swap_b32 v83, v95
    s_nop 0
    v_add_f32 v82, v82, v94
    v_add_f32 v83, v83, v95
    v_mov_b32 v94, v82
    v_mov_b32 v95, v83
    s_nop 1
    v_permlane32_swap_b32 v82, v94
    v_permlane32_swap_b32 v83, v95
    s_nop 0
    v_add_f32 v82, v82, v94
    v_add_f32 v83, v83, v95
    v_pk_mul_f32 v[86:87], v[82:83], s[40:41]
    v_pk_fma_f32 v[94:95], v[86:87], s[42:43], v[82:83] neg_lo:[1,0,0] neg_hi:[1,0,0]
    v_pk_fma_f32 v[86:87], v[94:95], s[40:41], v[86:87]
    v_cvt_pk_bf16_f32 v96, v84, v85
    v_lshlrev_b32 v84, 16, v96
    v_and_b32 v85, 0xffff0000, v96
    v_cvt_pk_bf16_f32 v96, v86, v87
    v_lshlrev_b32 v86, 16, v96
    v_and_b32 v87, 0xffff0000, v96
    v_pk_add_f32 v[86:87], v[86:87], s[44:45]
    v_cvt_pk_bf16_f32 v96, v86, v87
    v_lshlrev_b32 v86, 16, v96
    v_and_b32 v87, 0xffff0000, v96
    v_sqrt_f32 v86, v86
    v_sqrt_f32 v87, v87
    s_nop 0
    v_cvt_pk_bf16_f32 v96, v86, v87
    v_lshlrev_b32 v86, 16, v96
    v_and_b32 v87, 0xffff0000, v96
    v_rcp_f32 v88, v86
    v_rcp_f32 v89, v87
    s_nop 0
    v_pk_add_f32 v[90:91], v[10:11], v[84:85] neg_lo:[0,1] neg_hi:[0,1]
    v_cvt_pk_bf16_f32 v96, v90, v91
    v_lshlrev_b32 v90, 16, v96
    v_and_b32 v91, 0xffff0000, v96
    v_pk_mul_f32 v[92:93], v[90:91], v[88:89]
    v_pk_fma_f32 v[90:91], v[92:93], v[86:87], v[90:91] neg_lo:[1,0,0] neg_hi:[1,0,0]
    v_pk_fma_f32 v[92:93], v[90:91], v[88:89], v[92:93]
    v_cvt_pk_bf16_f32 v10, v92, v93
    v_pk_add_f32 v[90:91], v[12:13], v[84:85] neg_lo:[0,1] neg_hi:[0,1]
    v_cvt_pk_bf16_f32 v96, v90, v91
    v_lshlrev_b32 v90, 16, v96
    v_and_b32 v91, 0xffff0000, v96
    v_pk_mul_f32 v[92:93], v[90:91], v[88:89]
    v_pk_fma_f32 v[90:91], v[92:93], v[86:87], v[90:91] neg_lo:[1,0,0] neg_hi:[1,0,0]
    v_pk_fma_f32 v[92:93], v[90:91], v[88:89], v[92:93]
    v_cvt_pk_bf16_f32 v12, v92, v93
    v_pk_add_f32 v[90:91], v[14:15], v[84:85] neg_lo:[0,1] neg_hi:[0,1]
    v_cvt_pk_bf16_f32 v96, v90, v91
    v_lshlrev_b32 v90, 16, v96
    v_and_b32 v91, 0xffff0000, v96
    v_pk_mul_f32 v[92:93], v[90:91], v[88:89]
    v_pk_fma_f32 v[90:91], v[92:93], v[86:87], v[90:91] neg_lo:[1,0,0] neg_hi:[1,0,0]
    v_pk_fma_f32 v[92:93], v[90:91], v[88:89], v[92:93]
    v_cvt_pk_bf16_f32 v14, v92, v93
    v_pk_add_f32 v[90:91], v[16:17], v[84:85] neg_lo:[0,1] neg_hi:[0,1]
    v_cvt_pk_bf16_f32 v96, v90, v91
    v_lshlrev_b32 v90, 16, v96
    v_and_b32 v91, 0xffff0000, v96
    v_pk_mul_f32 v[92:93], v[90:91], v[88:89]
    v_pk_fma_f32 v[90:91], v[92:93], v[86:87], v[90:91] neg_lo:[1,0,0] neg_hi:[1,0,0]
    v_pk_fma_f32 v[92:93], v[90:91], v[88:89], v[92:93]
    v_cvt_pk_bf16_f32 v16, v92, v93
    v_pk_add_f32 v[90:91], v[18:19], v[84:85] neg_lo:[0,1] neg_hi:[0,1]
    v_cvt_pk_bf16_f32 v96, v90, v91
    v_lshlrev_b32 v90, 16, v96
    v_and_b32 v91, 0xffff0000, v96
    v_pk_mul_f32 v[92:93], v[90:91], v[88:89]
    v_pk_fma_f32 v[90:91], v[92:93], v[86:87], v[90:91] neg_lo:[1,0,0] neg_hi:[1,0,0]
    v_pk_fma_f32 v[92:93], v[90:91], v[88:89], v[92:93]
    v_cvt_pk_bf16_f32 v18, v92, v93
    v_pk_add_f32 v[90:91], v[20:21], v[84:85] neg_lo:[0,1] neg_hi:[0,1]
    v_cvt_pk_bf16_f32 v96, v90, v91
    v_lshlrev_b32 v90, 16, v96
    v_and_b32 v91, 0xffff0000, v96
    v_pk_mul_f32 v[92:93], v[90:91], v[88:89]
    v_pk_fma_f32 v[90:91], v[92:93], v[86:87], v[90:91] neg_lo:[1,0,0] neg_hi:[1,0,0]
    v_pk_fma_f32 v[92:93], v[90:91], v[88:89], v[92:93]
    v_cvt_pk_bf16_f32 v20, v92, v93
    v_pk_add_f32 v[90:91], v[22:23], v[84:85] neg_lo:[0,1] neg_hi:[0,1]
    v_cvt_pk_bf16_f32 v96, v90, v91
    v_lshlrev_b32 v90, 16, v96
    v_and_b32 v91, 0xffff0000, v96
    v_pk_mul_f32 v[92:93], v[90:91], v[88:89]
    v_pk_fma_f32 v[90:91], v[92:93], v[86:87], v[90:91] neg_lo:[1,0,0] neg_hi:[1,0,0]
    v_pk_fma_f32 v[92:93], v[90:91], v[88:89], v[92:93]
    v_cvt_pk_bf16_f32 v22, v92, v93
    v_pk_add_f32 v[90:91], v[24:25], v[84:85] neg_lo:[0,1] neg_hi:[0,1]
    v_cvt_pk_bf16_f32 v96, v90, v91
    v_lshlrev_b32 v90, 16, v96
    v_and_b32 v91, 0xffff0000, v96
    v_pk_mul_f32 v[92:93], v[90:91], v[88:89]
    v_pk_fma_f32 v[90:91], v[92:93], v[86:87], v[90:91] neg_lo:[1,0,0] neg_hi:[1,0,0]
    v_pk_fma_f32 v[92:93], v[90:91], v[88:89], v[92:93]
    v_cvt_pk_bf16_f32 v24, v92, v93
    v_pk_add_f32 v[90:91], v[26:27], v[84:85] neg_lo:[0,1] neg_hi:[0,1]
    v_cvt_pk_bf16_f32 v96, v90, v91
    v_lshlrev_b32 v90, 16, v96
    v_and_b32 v91, 0xffff0000, v96
    v_pk_mul_f32 v[92:93], v[90:91], v[88:89]
    v_pk_fma_f32 v[90:91], v[92:93], v[86:87], v[90:91] neg_lo:[1,0,0] neg_hi:[1,0,0]
    v_pk_fma_f32 v[92:93], v[90:91], v[88:89], v[92:93]
    v_cvt_pk_bf16_f32 v26, v92, v93
    v_pk_add_f32 v[90:91], v[28:29], v[84:85] neg_lo:[0,1] neg_hi:[0,1]
    v_cvt_pk_bf16_f32 v96, v90, v91
    v_lshlrev_b32 v90, 16, v96
    v_and_b32 v91, 0xffff0000, v96
    v_pk_mul_f32 v[92:93], v[90:91], v[88:89]
    v_pk_fma_f32 v[90:91], v[92:93], v[86:87], v[90:91] neg_lo:[1,0,0] neg_hi:[1,0,0]
    v_pk_fma_f32 v[92:93], v[90:91], v[88:89], v[92:93]
    v_cvt_pk_bf16_f32 v28, v92, v93
    v_and_b32 v11, 0xffff0000, v10
    v_lshlrev_b32 v10, 16, v10
    v_and_b32 v13, 0xffff0000, v12
    v_lshlrev_b32 v12, 16, v12
    v_and_b32 v15, 0xffff0000, v14
    v_lshlrev_b32 v14, 16, v14
    v_and_b32 v17, 0xffff0000, v16
    v_lshlrev_b32 v16, 16, v16
    v_and_b32 v19, 0xffff0000, v18
    v_lshlrev_b32 v18, 16, v18
    v_and_b32 v21, 0xffff0000, v20
    v_lshlrev_b32 v20, 16, v20
    v_and_b32 v23, 0xffff0000, v22
    v_lshlrev_b32 v22, 16, v22
    v_and_b32 v25, 0xffff0000, v24
    v_lshlrev_b32 v24, 16, v24
    v_and_b32 v27, 0xffff0000, v26
    v_lshlrev_b32 v26, 16, v26
    v_and_b32 v29, 0xffff0000, v28
    v_lshlrev_b32 v28, 16, v28
    v_pk_add_f32 v[30:31], v[10:11], v[20:21]
    v_pk_add_f32 v[40:41], v[10:11], v[20:21] neg_lo:[0,1] neg_hi:[0,1]
    v_pk_add_f32 v[32:33], v[14:15], v[24:25]
    v_pk_add_f32 v[42:43], v[14:15], v[24:25] neg_lo:[0,1] neg_hi:[0,1]
    v_pk_add_f32 v[34:35], v[18:19], v[28:29]
    v_pk_add_f32 v[44:45], v[18:19], v[28:29] neg_lo:[0,1] neg_hi:[0,1]
    v_pk_add_f32 v[36:37], v[22:23], v[12:13]
    v_pk_add_f32 v[46:47], v[22:23], v[12:13] neg_lo:[0,1] neg_hi:[0,1]
    v_pk_add_f32 v[38:39], v[26:27], v[16:17]
    v_pk_add_f32 v[48:49], v[26:27], v[16:17] neg_lo:[0,1] neg_hi:[0,1]
    v_pk_add_f32 v[10:11], v[32:33], v[38:39]
    v_pk_add_f32 v[12:13], v[34:35], v[36:37]
    v_pk_add_f32 v[14:15], v[32:33], v[38:39] neg_lo:[0,1] neg_hi:[0,1]
    v_pk_add_f32 v[16:17], v[34:35], v[36:37] neg_lo:[0,1] neg_hi:[0,1]
    v_pk_fma_f32 v[20:21], v[10:11], s[26:27], v[30:31]
    v_pk_fma_f32 v[22:23], v[10:11], s[28:29], v[30:31]
    v_pk_mul_f32 v[24:25], v[14:15], s[30:31]
    v_pk_mul_f32 v[26:27], v[14:15], s[32:33]
    v_pk_add_f32 v[18:19], v[10:11], v[12:13]
    v_pk_fma_f32 v[20:21], v[12:13], s[28:29], v[20:21]
    v_pk_fma_f32 v[22:23], v[12:13], s[26:27], v[22:23]
    v_pk_fma_f32 v[24:25], v[16:17], s[32:33], v[24:25]
    v_pk_fma_f32 v[26:27], v[16:17], s[30:31], v[26:27] neg_lo:[1,0,0] neg_hi:[1,0,0]
    v_pk_add_f32 v[30:31], v[30:31], v[18:19]
    v_pk_add_f32 v[32:33], v[20:21], v[24:25] op_sel:[0,1] op_sel_hi:[1,0] neg_hi:[0,1]
    v_pk_add_f32 v[38:39], v[20:21], v[24:25] op_sel:[0,1] op_sel_hi:[1,0] neg_lo:[0,1]
    v_pk_add_f32 v[34:35], v[22:23], v[26:27] op_sel:[0,1] op_sel_hi:[1,0] neg_hi:[0,1]
    v_pk_add_f32 v[36:37], v[22:23], v[26:27] op_sel:[0,1] op_sel_hi:[1,0] neg_lo:[0,1]
    v_pk_add_f32 v[10:11], v[42:43], v[48:49]
    v_pk_add_f32 v[12:13], v[44:45], v[46:47]
    v_pk_add_f32 v[14:15], v[42:43], v[48:49] neg_lo:[0,1] neg_hi:[0,1]
    v_pk_add_f32 v[16:17], v[44:45], v[46:47] neg_lo:[0,1] neg_hi:[0,1]
    v_pk_fma_f32 v[20:21], v[10:11], s[26:27], v[40:41]
    v_pk_fma_f32 v[22:23], v[10:11], s[28:29], v[40:41]
    v_pk_mul_f32 v[24:25], v[14:15], s[30:31]
    v_pk_mul_f32 v[26:27], v[14:15], s[32:33]
    v_pk_add_f32 v[18:19], v[10:11], v[12:13]
    v_pk_fma_f32 v[20:21], v[12:13], s[28:29], v[20:21]
    v_pk_fma_f32 v[22:23], v[12:13], s[26:27], v[22:23]
    v_pk_fma_f32 v[24:25], v[16:17], s[32:33], v[24:25]
    v_pk_fma_f32 v[26:27], v[16:17], s[30:31], v[26:27] neg_lo:[1,0,0] neg_hi:[1,0,0]
    v_pk_add_f32 v[40:41], v[40:41], v[18:19]
    v_pk_add_f32 v[42:43], v[20:21], v[24:25] op_sel:[0,1] op_sel_hi:[1,0] neg_hi:[0,1]
    v_pk_add_f32 v[48:49], v[20:21], v[24:25] op_sel:[0,1] op_sel_hi:[1,0] neg_lo:[0,1]
    v_pk_add_f32 v[44:45], v[22:23], v[26:27] op_sel:[0,1] op_sel_hi:[1,0] neg_hi:[0,1]
    v_pk_add_f32 v[46:47], v[22:23], v[26:27] op_sel:[0,1] op_sel_hi:[1,0] neg_lo:[0,1]
    s_waitcnt vmcnt(7)
    s_mul_i32 s38, s3, 5760
    v_lshlrev_b32 v5, 3, v1
    v_add_u32 v5, s38, v5
    ds_write_b64 v5, v[30:31] offset:0
    v_pk_mul_f32 v[10:11], v[42:43], v[50:51] op_sel:[0,0] op_sel_hi:[1,0]
    v_pk_fma_f32 v[42:43], v[42:43], v[50:51], v[10:11] op_sel:[1,1,0] op_sel_hi:[0,1,1] neg_lo:[1,0,0]
    ds_write_b64 v5, v[42:43] offset:576
    v_pk_mul_f32 v[10:11], v[34:35], v[52:53] op_sel:[0,0] op_sel_hi:[1,0]
    v_pk_fma_f32 v[34:35], v[34:35], v[52:53], v[10:11] op_sel:[1,1,0] op_sel_hi:[0,1,1] neg_lo:[1,0,0]
    ds_write_b64 v5, v[34:35] offset:1152
    v_pk_mul_f32 v[10:11], v[46:47], v[54:55] op_sel:[0,0] op_sel_hi:[1,0]
    v_pk_fma_f32 v[46:47], v[46:47], v[54:55], v[10:11] op_sel:[1,1,0] op_sel_hi:[0,1,1] neg_lo:[1,0,0]
    ds_write_b64 v5, v[46:47] offset:1728
    v_pk_mul_f32 v[10:11], v[38:39], v[56:57] op_sel:[0,0] op_sel_hi:[1,0]
    v_pk_fma_f32 v[38:39], v[38:39], v[56:57], v[10:11] op_sel:[1,1,0] op_sel_hi:[0,1,1] neg_lo:[1,0,0]
    ds_write_b64 v5, v[38:39] offset:2304
    v_pk_mul_f32 v[10:11], v[40:41], v[58:59] op_sel:[0,0] op_sel_hi:[1,0]
    v_pk_fma_f32 v[40:41], v[40:41], v[58:59], v[10:11] op_sel:[1,1,0] op_sel_hi:[0,1,1] neg_lo:[1,0,0]
    ds_write_b64 v5, v[40:41] offset:2880
    v_pk_mul_f32 v[10:11], v[32:33], v[60:61] op_sel:[0,0] op_sel_hi:[1,0]
    v_pk_fma_f32 v[32:33], v[32:33], v[60:61], v[10:11] op_sel:[1,1,0] op_sel_hi:[0,1,1] neg_lo:[1,0,0]
    ds_write_b64 v5, v[32:33] offset:3456
    v_pk_mul_f32 v[10:11], v[44:45], v[62:63] op_sel:[0,0] op_sel_hi:[1,0]
    v_pk_fma_f32 v[44:45], v[44:45], v[62:63], v[10:11] op_sel:[1,1,0] op_sel_hi:[0,1,1] neg_lo:[1,0,0]
    ds_write_b64 v5, v[44:45] offset:4032
    v_pk_mul_f32 v[10:11], v[36:37], v[64:65] op_sel:[0,0] op_sel_hi:[1,0]
    v_pk_fma_f32 v[36:37], v[36:37], v[64:65], v[10:11] op_sel:[1,1,0] op_sel_hi:[0,1,1] neg_lo:[1,0,0]
    ds_write_b64 v5, v[36:37] offset:4608
    v_pk_mul_f32 v[10:11], v[48:49], v[66:67] op_sel:[0,0] op_sel_hi:[1,0]
    v_pk_fma_f32 v[48:49], v[48:49], v[66:67], v[10:11] op_sel:[1,1,0] op_sel_hi:[0,1,1] neg_lo:[1,0,0]
    ds_write_b64 v5, v[48:49] offset:5184
K1_s1_done:
    s_waitcnt vmcnt(0) lgkmcnt(0)
    s_barrier
    v_mul_u32_u24 v5, 576, v3
    v_lshl_add_u32 v5, v4, 3, v5
    ds_read_b64 v[10:11], v5 offset:0
    ds_read_b64 v[12:13], v5 offset:64
    ds_read_b64 v[14:15], v5 offset:128
    ds_read_b64 v[16:17], v5 offset:192
    ds_read_b64 v[18:19], v5 offset:256
    ds_read_b64 v[20:21], v5 offset:320
    ds_read_b64 v[22:23], v5 offset:384
    ds_read_b64 v[24:25], v5 offset:448
    s_waitcnt lgkmcnt(0)
    v_pk_add_f32 v[30:31], v[10:11], v[18:19]
    v_pk_add_f32 v[38:39], v[10:11], v[18:19] neg_lo:[0,1] neg_hi:[0,1]
    v_pk_add_f32 v[32:33], v[12:13], v[20:21]
    v_pk_add_f32 v[40:41], v[12:13], v[20:21] neg_lo:[0,1] neg_hi:[0,1]
    v_pk_add_f32 v[34:35], v[14:15], v[22:23]
    v_pk_add_f32 v[42:43], v[14:15], v[22:23] neg_lo:[0,1] neg_hi:[0,1]
    v_pk_add_f32 v[36:37], v[16:17], v[24:25]
    v_pk_add_f32 v[44:45], v[16:17], v[24:25] neg_lo:[0,1] neg_hi:[0,1]
    v_pk_add_f32 v[10:11], v[30:31], v[34:35]
    v_pk_add_f32 v[12:13], v[30:31], v[34:35] neg_lo:[0,1] neg_hi:[0,1]
    v_pk_add_f32 v[14:15], v[32:33], v[36:37]
    v_pk_add_f32 v[16:17], v[32:33], v[36:37] neg_lo:[0,1] neg_hi:[0,1]
    v_pk_add_f32 v[18:19], v[40:41], v[40:41] op_sel:[0,1] op_sel_hi:[1,0] neg_hi:[0,1]
    v_pk_add_f32 v[20:21], v[44:45], v[44:45] op_sel:[0,1] op_sel_hi:[1,0] neg_lo:[1,0] neg_hi:[1,1]
    v_pk_add_f32 v[22:23], v[38:39], v[42:43] op_sel:[0,1] op_sel_hi:[1,0] neg_hi:[0,1]
    v_pk_add_f32 v[24:25], v[38:39], v[42:43] op_sel:[0,1] op_sel_hi:[1,0] neg_lo:[0,1]
    v_pk_add_f32 v[40:41], v[18:19], v[20:21]
    v_pk_add_f32 v[44:45], v[18:19], v[20:21] neg_lo:[0,1] neg_hi:[0,1]
    v_pk_add_f32 v[30:31], v[10:11], v[14:15]
    v_pk_add_f32 v[38:39], v[10:11], v[14:15] neg_lo:[0,1] neg_hi:[0,1]
    v_pk_add_f32 v[34:35], v[12:13], v[16:17] op_sel:[0,1] op_sel_hi:[1,0] neg_hi:[0,1]
    v_pk_add_f32 v[42:43], v[12:13], v[16:17] op_sel:[0,1] op_sel_hi:[1,0] neg_lo:[0,1]
    v_pk_fma_f32 v[32:33], v[40:41], s[24:25], v[22:23]
    v_pk_fma_f32 v[40:41], v[40:41], s[24:25], v[22:23] neg_lo:[1,0,0] neg_hi:[1,0,0]
    v_pk_fma_f32 v[36:37], v[44:45], s[24:25], v[24:25] op_sel:[1,0,0] op_sel_hi:[0,1,1] neg_hi:[1,0,0]
    v_pk_fma_f32 v[44:45], v[44:45], s[24:25], v[24:25] op_sel:[1,0,0] op_sel_hi:[0,1,1] neg_lo:[1,0,0]
    ds_write_b64 v5, v[30:31] offset:23040
    v_pk_mul_f32 v[10:11], v[32:33], v[68:69] op_sel:[0,0] op_sel_hi:[1,0]
    v_pk_fma_f32 v[32:33], v[32:33], v[68:69], v[10:11] op_sel:[1,1,0] op_sel_hi:[0,1,1] neg_lo:[1,0,0]
    ds_write_b64 v5, v[32:33] offset:23104
    v_pk_mul_f32 v[10:11], v[34:35], v[70:71] op_sel:[0,0] op_sel_hi:[1,0]
    v_pk_fma_f32 v[34:35], v[34:35], v[70:71], v[10:11] op_sel:[1,1,0] op_sel_hi:[0,1,1] neg_lo:[1,0,0]
    ds_write_b64 v5, v[34:35] offset:23168
    v_pk_mul_f32 v[10:11], v[36:37], v[72:73] op_sel:[0,0] op_sel_hi:[1,0]
    v_pk_fma_f32 v[36:37], v[36:37], v[72:73], v[10:11] op_sel:[1,1,0] op_sel_hi:[0,1,1] neg_lo:[1,0,0]
    ds_write_b64 v5, v[36:37] offset:23232
    v_pk_mul_f32 v[10:11], v[38:39], v[74:75] op_sel:[0,0] op_sel_hi:[1,0]
    v_pk_fma_f32 v[38:39], v[38:39], v[74:75], v[10:11] op_sel:[1,1,0] op_sel_hi:[0,1,1] neg_lo:[1,0,0]
    ds_write_b64 v5, v[38:39] offset:23296
    v_pk_mul_f32 v[10:11], v[40:41], v[76:77] op_sel:[0,0] op_sel_hi:[1,0]
    v_pk_fma_f32 v[40:41], v[40:41], v[76:77], v[10:11] op_sel:[1,1,0] op_sel_hi:[0,1,1] neg_lo:[1,0,0]
    ds_write_b64 v5, v[40:41] offset:23360
    v_pk_mul_f32 v[10:11], v[42:43], v[78:79] op_sel:[0,0] op_sel_hi:[1,0]
    v_pk_fma_f32 v[42:43], v[42:43], v[78:79], v[10:11] op_sel:[1,1,0] op_sel_hi:[0,1,1] neg_lo:[1,0,0]
    ds_write_b64 v5, v[42:43] offset:23424
    v_pk_mul_f32 v[10:11], v[44:45], v[80:81] op_sel:[0,0] op_sel_hi:[1,0]
    v_pk_fma_f32 v[44:45], v[44:45], v[80:81], v[10:11] op_sel:[1,1,0] op_sel_hi:[0,1,1] neg_lo:[1,0,0]
    ds_write_b64 v5, v[44:45] offset:23488
    s_waitcnt lgkmcnt(0)
    s_barrier
    v_mul_u32_u24 v5, 576, v3
    v_lshl_add_u32 v5, v4, 6, v5
    ds_read_b128 v[10:13], v5 offset:23040
    ds_read_b128 v[14:17], v5 offset:23056
    ds_read_b128 v[18:21], v5 offset:23072
    ds_read_b128 v[22:25], v5 offset:23088
    v_mul_u32_u24 v6, 205, v3
    v_lshrrev_b32 v6, 11, v6
    v_mul_u32_u24 v7, 10, v6
    v_sub_u32 v7, v3, v7
    v_mul_u32_u24 v8, 10, v4
    v_add_u32 v7, v7, v8
    v_lshlrev_b32 v7, 3, v7
    v_mul_u32_u24 v6, 5248, v6
    v_add_u32 v7, v7, v6
    s_waitcnt lgkmcnt(0)
    v_pk_add_f32 v[30:31], v[10:11], v[18:19]
    v_pk_add_f32 v[38:39], v[10:11], v[18:19] neg_lo:[0,1] neg_hi:[0,1]
    v_pk_add_f32 v[32:33], v[12:13], v[20:21]
    v_pk_add_f32 v[40:41], v[12:13], v[20:21] neg_lo:[0,1] neg_hi:[0,1]
    v_pk_add_f32 v[34:35], v[14:15], v[22:23]
    v_pk_add_f32 v[42:43], v[14:15], v[22:23] neg_lo:[0,1] neg_hi:[0,1]
    v_pk_add_f32 v[36:37], v[16:17], v[24:25]
    v_pk_add_f32 v[44:45], v[16:17], v[24:25] neg_lo:[0,1] neg_hi:[0,1]
    v_pk_add_f32 v[10:11], v[30:31], v[34:35]
    v_pk_add_f32 v[12:13], v[30:31], v[34:35] neg_lo:[0,1] neg_hi:[0,1]
    v_pk_add_f32 v[14:15], v[32:33], v[36:37]
    v_pk_add_f32 v[16:17], v[32:33], v[36:37] neg_lo:[0,1] neg_hi:[0,1]
    v_pk_add_f32 v[18:19], v[40:41], v[40:41] op_sel:[0,1] op_sel_hi:[1,0] neg_hi:[0,1]
    v_pk_add_f32 v[20:21], v[44:45], v[44:45] op_sel:[0,1] op_sel_hi:[1,0] neg_lo:[1,0] neg_hi:[1,1]
    v_pk_add_f32 v[22:23], v[38:39], v[42:43] op_sel:[0,1] op_sel_hi:[1,0] neg_hi:[0,1]
    v_pk_add_f32 v[24:25], v[38:39], v[42:43] op_sel:[0,1] op_sel_hi:[1,0] neg_lo:[0,1]
    v_pk_add_f32 v[40:41], v[18:19], v[20:21]
    v_pk_add_f32 v[44:45], v[18:19], v[20:21] neg_lo:[0,1] neg_hi:[0,1]
    v_pk_add_f32 v[30:31], v[10:11], v[14:15]
    v_pk_add_f32 v[38:39], v[10:11], v[14:15] neg_lo:[0,1] neg_hi:[0,1]
    v_pk_add_f32 v[34:35], v[12:13], v[16:17] op_sel:[0,1] op_sel_hi:[1,0] neg_hi:[0,1]
    v_pk_add_f32 v[42:43], v[12:13], v[16:17] op_sel:[0,1] op_sel_hi:[1,0] neg_lo:[0,1]
    v_pk_fma_f32 v[32:33], v[40:41], s[24:25], v[22:23]
    v_pk_fma_f32 v[40:41], v[40:41], s[24:25], v[22:23] neg_lo:[1,0,0] neg_hi:[1,0,0]
    v_pk_fma_f32 v[36:37], v[44:45], s[24:25], v[24:25] op_sel:[1,0,0] op_sel_hi:[0,1,1] neg_hi:[1,0,0]
    v_pk_fma_f32 v[44:45], v[44:45], s[24:25], v[24:25] op_sel:[1,0,0] op_sel_hi:[0,1,1] neg_lo:[1,0,0]
    ds_write_b64 v7, v[30:31] offset:0
    ds_write_b64 v7, v[32:33] offset:640
    ds_write_b64 v7, v[34:35] offset:1280
    ds_write_b64 v7, v[36:37] offset:1920
    ds_write_b64 v7, v[38:39] offset:2560
    ds_write_b64 v7, v[40:41] offset:3200
    ds_write_b64 v7, v[42:43] offset:3840
    ds_write_b64 v7, v[44:45] offset:4480
    v_and_b32 v8, 3, v0
    v_lshrrev_b32 v9, 2, v0
    v_mul_u32_u24 v5, 5248, v8
    v_sub_u32 v6, 400, v9
    v_lshl_add_u32 v6, v6, 3, v5
    v_lshl_add_u32 v5, v9, 3, v5
    v_cmp_gt_u32 vcc, 4, v0
    v_add_u32 v3, 1920, v6
    v_subrev_u32 v4, 2560, v3
    v_lshlrev_b32 v7, 14, v9
    v_cndmask_b32 v3, v3, v4, vcc
    v_lshl_add_u32 v7, v8, 4, v7
    s_lshl_b32 s37, s2, 6
    s_waitcnt lgkmcnt(0)
    s_barrier
    ds_read_b64 v[10:11], v5 offset:0
    ds_read_b64 v[12:13], v3
    ds_read_b64 v[14:15], v5 offset:640
    ds_read_b64 v[16:17], v6 offset:1280
    ds_read_b64 v[18:19], v5 offset:1280
    ds_read_b64 v[20:21], v6 offset:640
    ds_read_b64 v[22:23], v5 offset:1920
    ds_read_b64 v[24:25], v6 offset:0
    s_waitcnt lgkmcnt(0)
    v_pk_add_f32 v[30:31], v[10:11], v[12:13] neg_hi:[0,1]
    v_pk_add_f32 v[32:33], v[10:11], v[12:13] op_sel:[1,1] op_sel_hi:[0,0] neg_hi:[1,0]
    v_pk_add_f32 v[34:35], v[14:15], v[16:17] neg_hi:[0,1]
    v_pk_add_f32 v[36:37], v[14:15], v[16:17] op_sel:[1,1] op_sel_hi:[0,0] neg_hi:[1,0]
    v_pk_add_f32 v[38:39], v[18:19], v[20:21] neg_hi:[0,1]
    v_pk_add_f32 v[40:41], v[18:19], v[20:21] op_sel:[1,1] op_sel_hi:[0,0] neg_hi:[1,0]
    v_pk_add_f32 v[42:43], v[22:23], v[24:25] neg_hi:[0,1]
    v_pk_add_f32 v[44:45], v[22:23], v[24:25] op_sel:[1,1] op_sel_hi:[0,0] neg_hi:[1,0]
    s_cmp_lg_u32 s3, 0
    s_cbranch_scc1 K1_st
    v_pk_add_f32 v[82:83], v[10:11], v[10:11]
    v_cndmask_b32 v30, v30, v82, vcc
    v_cndmask_b32 v31, v31, 0, vcc
    v_cndmask_b32 v32, v32, v83, vcc
    v_cndmask_b32 v33, v33, 0, vcc
    v_add_f32 v50, v12, v12
    v_mov_b32 v51, 0
    v_add_f32 v52, v13, v13
    v_mov_b32 v53, 0
    s_add_u32 s38, s37, 0x500000
    s_and_saveexec_b64 s[46:47], vcc
    buffer_store_dwordx4 v[50:53], v7, s[16:19], s38 offen
    s_mov_b64 exec, s[46:47]
K1_st:
    buffer_store_dwordx4 v[30:33], v7, s[16:19], s37 offen
    s_add_u32 s37, s37, 0x140000
    buffer_store_dwordx4 v[34:37], v7, s[16:19], s37 offen
    s_add_u32 s37, s37, 0x140000
    buffer_store_dwordx4 v[38:41], v7, s[16:19], s37 offen
    s_add_u32 s37, s37, 0x140000
    buffer_store_dwordx4 v[42:45], v7, s[16:19], s37 offen
K1_end:
    s_endpgm
K1_helper:
    s_sub_u32 s4, s2, 256
    s_mul_i32 s4, s4, 5
    s_add_u32 s4, s4, s3
    s_cmp_ge_u32 s4, 768
    s_cbranch_scc1 K1_end
    s_add_u32 s12, s8, 0x0
    s_addc_u32 s13, s9, 0
    s_and_b32 s13, s13, 0xffff
    s_mov_b32 s14, 0x141000
    s_mov_b32 s15, 0x20000
    s_add_u32 s16, s10, 0x0
    s_addc_u32 s17, s11, 0
    s_and_b32 s17, s17, 0xffff
    s_mov_b32 s18, 0x141000
    s_mov_b32 s19, 0x20000
    s_add_u32 s20, s6, 0x600000
    s_addc_u32 s21, s7, 0
    s_and_b32 s21, s21, 0xffff
    s_mov_b32 s22, 0x284000
    s_mov_b32 s23, 0x20000
    s_and_b32 s5, s4, 127
    s_lshr_b32 s24, s4, 7
    s_lshr_b32 s25, s5, 3
    s_and_b32 s26, s5, 7
    s_lshl_b32 s26, s26, 5
    s_add_u32 s25, s25, s26
    s_mul_i32 s25, s25, 642
    s_lshl_b32 s27, s24, 6
    v_add_u32 v2, s27, v1
    v_lshlrev_b32 v3, 1, v2
    v_lshlrev_b32 v4, 13, v2
    s_lshl_b32 s28, s5, 6
    v_cmp_gt_u32 vcc, 321, v2
    s_and_saveexec_b64 s[40:41], vcc
    s_cbranch_execz K1_end
    s_add_u32 s29, s25, 0
    buffer_load_ushort v10, v3, s[12:15], s29 offen
    buffer_load_ushort v26, v3, s[16:19], s29 offen
    s_add_u32 s29, s25, 164352
    buffer_load_ushort v11, v3, s[12:15], s29 offen
    buffer_load_ushort v27, v3, s[16:19], s29 offen
    s_add_u32 s29, s25, 328704
    buffer_load_ushort v12, v3, s[12:15], s29 offen
    buffer_load_ushort v28, v3, s[16:19], s29 offen
    s_add_u32 s29, s25, 493056
    buffer_load_ushort v13, v3, s[12:15], s29 offen
    buffer_load_ushort v29, v3, s[16:19], s29 offen
    s_add_u32 s29, s25, 657408
    buffer_load_ushort v14, v3, s[12:15], s29 offen
    buffer_load_ushort v30, v3, s[16:19], s29 offen
    s_add_u32 s29, s25, 821760
    buffer_load_ushort v15, v3, s[12:15], s29 offen
    buffer_load_ushort v31, v3, s[16:19], s29 offen
    s_add_u32 s29, s25, 986112
    buffer_load_ushort v16, v3, s[12:15], s29 offen
    buffer_load_ushort v32, v3, s[16:19], s29 offen
    s_add_u32 s29, s25, 1150464
    buffer_load_ushort v17, v3, s[12:15], s29 offen
    buffer_load_ushort v33, v3, s[16:19], s29 offen
    s_add_u32 s29, s25, 10272
    buffer_load_ushort v18, v3, s[12:15], s29 offen
    buffer_load_ushort v34, v3, s[16:19], s29 offen
    s_add_u32 s29, s25, 174624
    buffer_load_ushort v19, v3, s[12:15], s29 offen
    buffer_load_ushort v35, v3, s[16:19], s29 offen
    s_add_u32 s29, s25, 338976
    buffer_load_ushort v20, v3, s[12:15], s29 offen
    buffer_load_ushort v36, v3, s[16:19], s29 offen
    s_add_u32 s29, s25, 503328
    buffer_load_ushort v21, v3, s[12:15], s29 offen
    buffer_load_ushort v37, v3, s[16:19], s29 offen
    s_add_u32 s29, s25, 667680
    buffer_load_ushort v22, v3, s[12:15], s29 offen
    buffer_load_ushort v38, v3, s[16:19], s29 offen
    s_add_u32 s29, s25, 832032
    buffer_load_ushort v23, v3, s[12:15], s29 offen
    buffer_load_ushort v39, v3, s[16:19], s29 offen
    s_add_u32 s29, s25, 996384
    buffer_load_ushort v24, v3, s[12:15], s29 offen
    buffer_load_ushort v40, v3, s[16:19], s29 offen
    s_add_u32 s29, s25, 1160736
    buffer_load_ushort v25, v3, s[12:15], s29 offen
    buffer_load_ushort v41, v3, s[16:19], s29 offen
    s_waitcnt vmcnt(0)
    v_lshl_or_b32 v10, v26, 16, v10
    v_lshl_or_b32 v11, v27, 16, v11
    v_lshl_or_b32 v12, v28, 16, v12
    v_lshl_or_b32 v13, v29, 16, v13
    v_lshl_or_b32 v14, v30, 16, v14
    v_lshl_or_b32 v15, v31, 16, v15
    v_lshl_or_b32 v16, v32, 16, v16
    v_lshl_or_b32 v17, v33, 16, v17
    v_lshl_or_b32 v18, v34, 16, v18
    v_lshl_or_b32 v19, v35, 16, v19
    v_lshl_or_b32 v20, v36, 16, v20
    v_lshl_or_b32 v21, v37, 16, v21
    v_lshl_or_b32 v22, v38, 16, v22
    v_lshl_or_b32 v23, v39, 16, v23
    v_lshl_or_b32 v24, v40, 16, v24
    v_lshl_or_b32 v25, v41, 16, v25
    buffer_store_dwordx4 v[10:13], v4, s[20:23], s28 offen offset:0
    buffer_store_dwordx4 v[14:17], v4, s[20:23], s28 offen offset:16
    buffer_store_dwordx4 v[18:21], v4, s[20:23], s28 offen offset:32
    buffer_store_dwordx4 v[22:25], v4, s[20:23], s28 offen offset:48
    s_endpgm
.p2align 8
.globl k2_kernel
.type k2_kernel,@function
k2_kernel:
    s_load_dwordx2 s[6:7], s[0:1], 80
    v_lshrrev_b32 v2, 6, v0
    v_and_b32 v1, 63, v0
    s_nop 0
    v_readfirstlane_b32 s3, v2
    s_waitcnt lgkmcnt(0)
    s_cmp_ge_u32 s2, 321
    s_cbranch_scc1 K2_helper
    s_add_u32 s12, s6, 0x0
    s_addc_u32 s13, s7, 0
    s_and_b32 s13, s13, 0xffff
    s_mov_b32 s14, 0x508000
    s_mov_b32 s15, 0x20000
    s_add_u32 s16, s6, 0x600000
    s_addc_u32 s17, s7, 0
    s_and_b32 s17, s17, 0xffff
    s_mov_b32 s18, 0x284000
    s_mov_b32 s19, 0x20000
    s_getpc_b64 s[20:21]
L_pc_2:
    s_add_u32 s20, s20, twk2 - L_pc_2
    s_addc_u32 s21, s21, 0
    s_and_b32 s21, s21, 0xffff
    s_mov_b32 s22, 0x3fc0
    s_mov_b32 s23, 0x20000
    s_lshl_b32 s28, s2, 14
    v_lshlrev_b32 v5, 3, v0
    buffer_load_dwordx2 v[10:11], v5, s[12:15], s28 offen offset:0
    buffer_load_dwordx2 v[12:13], v5, s[12:15], s28 offen offset:1024
    buffer_load_dwordx2 v[14:15], v5, s[12:15], s28 offen offset:2048
    buffer_load_dwordx2 v[16:17], v5, s[12:15], s28 offen offset:3072
    s_add_u32 s28, s28, 4096
    buffer_load_dwordx2 v[18:19], v5, s[12:15], s28 offen offset:0
    buffer_load_dwordx2 v[20:21], v5, s[12:15], s28 offen offset:1024
    buffer_load_dwordx2 v[22:23], v5, s[12:15], s28 offen offset:2048
    buffer_load_dwordx2 v[24:25], v5, s[12:15], s28 offen offset:3072
    s_add_u32 s28, s28, 4096
    buffer_load_dwordx2 v[26:27], v5, s[12:15], s28 offen offset:0
    buffer_load_dwordx2 v[28:29], v5, s[12:15], s28 offen offset:1024
    buffer_load_dwordx2 v[30:31], v5, s[12:15], s28 offen offset:2048
    buffer_load_dwordx2 v[32:33], v5, s[12:15], s28 offen offset:3072
    s_add_u32 s28, s28, 4096
    buffer_load_dwordx2 v[34:35], v5, s[12:15], s28 offen offset:0
    buffer_load_dwordx2 v[36:37], v5, s[12:15], s28 offen offset:1024
    buffer_load_dwordx2 v[38:39], v5, s[12:15], s28 offen offset:2048
    buffer_load_dwordx2 v[40:41], v5, s[12:15], s28 offen offset:3072
    s_mov_b32 s29, 0
    buffer_load_dwordx2 v[74:75], v5, s[20:23], s29 offen offset:0
    buffer_load_dwordx2 v[76:77], v5, s[20:23], s29 offen offset:1024
    buffer_load_dwordx2 v[78:79], v5, s[20:23], s29 offen offset:2048
    buffer_load_dwordx2 v[80:81], v5, s[20:23], s29 offen offset:3072
    s_add_u32 s29, s29, 4096
    buffer_load_dwordx2 v[82:83], v5, s[20:23], s29 offen offset:0
    buffer_load_dwordx2 v[84:85], v5, s[20:23], s29 offen offset:1024
    buffer_load_dwordx2 v[86:87], v5, s[20:23], s29 offen offset:2048
    buffer_load_dwordx2 v[88:89], v5, s[20:23], s29 offen offset:3072
    s_add_u32 s29, s29, 4096
    buffer_load_dwordx2 v[90:91], v5, s[20:23], s29 offen offset:0
    buffer_load_dwordx2 v[92:93], v5, s[20:23], s29 offen offset:1024
    buffer_load_dwordx2 v[94:95], v5, s[20:23], s29 offen offset:2048
    buffer_load_dwordx2 v[96:97], v5, s[20:23], s29 offen offset:3072
    s_add_u32 s29, s29, 4096
    buffer_load_dwordx2 v[98:99], v5, s[20:23], s29 offen offset:0
    buffer_load_dwordx2 v[100:101], v5, s[20:23], s29 offen offset:1024
    buffer_load_dwordx2 v[102:103], v5, s[20:23], s29 offen offset:2048
    v_and_b32 v3, 7, v0
    v_lshlrev_b32 v7, 3, v3
    s_mov_b32 s29, 15360
    buffer_load_dwordx2 v[104:105], v7, s[20:23], s29 offen offset:0
    buffer_load_dwordx2 v[106:107], v7, s[20:23], s29 offen offset:64
    buffer_load_dwordx2 v[108:109], v7, s[20:23], s29 offen offset:128
    buffer_load_dwordx2 v[110:111], v7, s[20:23], s29 offen offset:192
    buffer_load_dwordx2 v[112:113], v7, s[20:23], s29 offen offset:256
    buffer_load_dwordx2 v[114:115], v7, s[20:23], s29 offen offset:320
    buffer_load_dwordx2 v[116:117], v7, s[20:23], s29 offen offset:384
    buffer_load_dwordx2 v[118:119], v7, s[20:23], s29 offen offset:448
    buffer_load_dwordx2 v[120:121], v7, s[20:23], s29 offen offset:512
    buffer_load_dwordx2 v[122:123], v7, s[20:23], s29 offen offset:576
    buffer_load_dwordx2 v[124:125], v7, s[20:23], s29 offen offset:640
    buffer_load_dwordx2 v[126:127], v7, s[20:23], s29 offen offset:704
    buffer_load_dwordx2 v[128:129], v7, s[20:23], s29 offen offset:768
    buffer_load_dwordx2 v[130:131], v7, s[20:23], s29 offen offset:832
    buffer_load_dwordx2 v[132:133], v7, s[20:23], s29 offen offset:896
    s_lshl_b32 s29, s2, 13
    v_lshlrev_b32 v6, 6, v0
    buffer_load_dwordx4 v[134:137], v6, s[16:19], s29 offen offset:0
    buffer_load_dwordx4 v[138:141], v6, s[16:19], s29 offen offset:16
    buffer_load_dwordx4 v[142:145], v6, s[16:19], s29 offen offset:32
    buffer_load_dwordx4 v[146:149], v6, s[16:19], s29 offen offset:48
    s_mov_b32 s24, 0x3f3504f3
    s_mov_b32 s25, 0x3f3504f3
    s_mov_b32 s26, 0x34cccccd
    s_mov_b32 s27, 0x34cccccd
    s_mov_b32 s30, 0x3f6c835e
    s_mov_b32 s31, 0xbec3ef15
    s_mov_b32 s32, 0x3f3504f3
    s_mov_b32 s33, 0xbf3504f3
    s_mov_b32 s34, 0x3ec3ef15
    s_mov_b32 s35, 0xbf6c835e
    s_mov_b32 s36, 0x248d3132
    s_mov_b32 s37, 0xbf800000
    s_mov_b32 s38, 0xbf3504f3
    s_mov_b32 s39, 0xbf3504f3
    s_mov_b32 s40, 0xbf6c835e
    s_mov_b32 s41, 0x3ec3ef15
    v_lshrrev_b32 v4, 3, v0
    v_mul_u32_u24 v8, 1296, v4
    v_mul_u32_u24 v4, 1088, v4
    v_lshl_add_u32 v6, v3, 3, v4
    v_mul_u32_u24 v7, 160, v3
    v_add_u32 v7, v7, v8
    v_lshl_add_u32 v8, v3, 3, v8
    s_waitcnt vmcnt(34)
    v_pk_add_f32 v[42:43], v[10:11], v[26:27]
    v_pk_add_f32 v[44:45], v[10:11], v[26:27] neg_lo:[0,1] neg_hi:[0,1]
    v_pk_add_f32 v[46:47], v[18:19], v[34:35]
    v_pk_add_f32 v[48:49], v[18:19], v[34:35] neg_lo:[0,1] neg_hi:[0,1]
    v_pk_add_f32 v[10:11], v[42:43], v[46:47]
    v_pk_add_f32 v[26:27], v[42:43], v[46:47] neg_lo:[0,1] neg_hi:[0,1]
    v_pk_add_f32 v[18:19], v[44:45], v[48:49] op_sel:[0,1] op_sel_hi:[1,0] neg_hi:[0,1]
    v_pk_add_f32 v[34:35], v[44:45], v[48:49] op_sel:[0,1] op_sel_hi:[1,0] neg_lo:[0,1]
    v_pk_add_f32 v[50:51], v[12:13], v[28:29]
    v_pk_add_f32 v[52:53], v[12:13], v[28:29] neg_lo:[0,1] neg_hi:[0,1]
    v_pk_add_f32 v[54:55], v[20:21], v[36:37]
    v_pk_add_f32 v[56:57], v[20:21], v[36:37] neg_lo:[0,1] neg_hi:[0,1]
    v_pk_add_f32 v[12:13], v[50:51], v[54:55]
    v_pk_add_f32 v[28:29], v[50:51], v[54:55] neg_lo:[0,1] neg_hi:[0,1]
    v_pk_add_f32 v[20:21], v[52:53], v[56:57] op_sel:[0,1] op_sel_hi:[1,0] neg_hi:[0,1]
    v_pk_add_f32 v[36:37], v[52:53], v[56:57] op_sel:[0,1] op_sel_hi:[1,0] neg_lo:[0,1]
    v_pk_add_f32 v[58:59], v[14:15], v[30:31]
    v_pk_add_f32 v[60:61], v[14:15], v[30:31] neg_lo:[0,1] neg_hi:[0,1]
    v_pk_add_f32 v[62:63], v[22:23], v[38:39]
    v_pk_add_f32 v[64:65], v[22:23], v[38:39] neg_lo:[0,1] neg_hi:[0,1]
    v_pk_add_f32 v[14:15], v[58:59], v[62:63]
    v_pk_add_f32 v[30:31], v[58:59], v[62:63] neg_lo:[0,1] neg_hi:[0,1]
    v_pk_add_f32 v[22:23], v[60:61], v[64:65] op_sel:[0,1] op_sel_hi:[1,0] neg_hi:[0,1]
    v_pk_add_f32 v[38:39], v[60:61], v[64:65] op_sel:[0,1] op_sel_hi:[1,0] neg_lo:[0,1]
    v_pk_add_f32 v[66:67], v[16:17], v[32:33]
    v_pk_add_f32 v[68:69], v[16:17], v[32:33] neg_lo:[0,1] neg_hi:[0,1]
    v_pk_add_f32 v[70:71], v[24:25], v[40:41]
    v_pk_add_f32 v[72:73], v[24:25], v[40:41] neg_lo:[0,1] neg_hi:[0,1]
    v_pk_add_f32 v[16:17], v[66:67], v[70:71]
    v_pk_add_f32 v[32:33], v[66:67], v[70:71] neg_lo:[0,1] neg_hi:[0,1]
    v_pk_add_f32 v[24:25], v[68:69], v[72:73] op_sel:[0,1] op_sel_hi:[1,0] neg_hi:[0,1]
    v_pk_add_f32 v[40:41], v[68:69], v[72:73] op_sel:[0,1] op_sel_hi:[1,0] neg_lo:[0,1]
    v_pk_mul_f32 v[42:43], v[20:21], s[30:31] op_sel:[0,0] op_sel_hi:[1,0]
    v_pk_fma_f32 v[20:21], v[20:21], s[30:31], v[42:43] op_sel:[1,1,0] op_sel_hi:[0,1,1] neg_lo:[1,0,0]
    v_pk_mul_f32 v[42:43], v[28:29], s[32:33] op_sel:[0,0] op_sel_hi:[1,0]
    v_pk_fma_f32 v[28:29], v[28:29], s[32:33], v[42:43] op_sel:[1,1,0] op_sel_hi:[0,1,1] neg_lo:[1,0,0]
    v_pk_mul_f32 v[42:43], v[36:37], s[34:35] op_sel:[0,0] op_sel_hi:[1,0]
    v_pk_fma_f32 v[36:37], v[36:37], s[34:35], v[42:43] op_sel:[1,1,0] op_sel_hi:[0,1,1] neg_lo:[1,0,0]
    v_pk_mul_f32 v[42:43], v[22:23], s[32:33] op_sel:[0,0] op_sel_hi:[1,0]
    v_pk_fma_f32 v[22:23], v[22:23], s[32:33], v[42:43] op_sel:[1,1,0] op_sel_hi:[0,1,1] neg_lo:[1,0,0]
    v_pk_mul_f32 v[42:43], v[30:31], s[36:37] op_sel:[0,0] op_sel_hi:[1,0]
    v_pk_fma_f32 v[30:31], v[30:31], s[36:37], v[42:43] op_sel:[1,1,0] op_sel_hi:[0,1,1] neg_lo:[1,0,0]
    v_pk_mul_f32 v[42:43], v[38:39], s[38:39] op_sel:[0,0] op_sel_hi:[1,0]
    v_pk_fma_f32 v[38:39], v[38:39], s[38:39], v[42:43] op_sel:[1,1,0] op_sel_hi:[0,1,1] neg_lo:[1,0,0]
    v_pk_mul_f32 v[42:43], v[24:25], s[34:35] op_sel:[0,0] op_sel_hi:[1,0]
    v_pk_fma_f32 v[24:25], v[24:25], s[34:35], v[42:43] op_sel:[1,1,0] op_sel_hi:[0,1,1] neg_lo:[1,0,0]
    v_pk_mul_f32 v[42:43], v[32:33], s[38:39] op_sel:[0,0] op_sel_hi:[1,0]
    v_pk_fma_f32 v[32:33], v[32:33], s[38:39], v[42:43] op_sel:[1,1,0] op_sel_hi:[0,1,1] neg_lo:[1,0,0]
    v_pk_mul_f32 v[42:43], v[40:41], s[40:41] op_sel:[0,0] op_sel_hi:[1,0]
    v_pk_fma_f32 v[40:41], v[40:41], s[40:41], v[42:43] op_sel:[1,1,0] op_sel_hi:[0,1,1] neg_lo:[1,0,0]
    v_pk_add_f32 v[42:43], v[10:11], v[14:15]
    v_pk_add_f32 v[44:45], v[10:11], v[14:15] neg_lo:[0,1] neg_hi:[0,1]
    v_pk_add_f32 v[46:47], v[12:13], v[16:17]
    v_pk_add_f32 v[48:49], v[12:13], v[16:17] neg_lo:[0,1] neg_hi:[0,1]
    v_pk_add_f32 v[10:11], v[42:43], v[46:47]
    v_pk_add_f32 v[14:15], v[42:43], v[46:47] neg_lo:[0,1] neg_hi:[0,1]
    v_pk_add_f32 v[12:13], v[44:45], v[48:49] op_sel:[0,1] op_sel_hi:[1,0] neg_hi:[0,1]
    v_pk_add_f32 v[16:17], v[44:45], v[48:49] op_sel:[0,1] op_sel_hi:[1,0] neg_lo:[0,1]
    v_pk_add_f32 v[50:51], v[18:19], v[22:23]
    v_pk_add_f32 v[52:53], v[18:19], v[22:23] neg_lo:[0,1] neg_hi:[0,1]
    v_pk_add_f32 v[54:55], v[20:21], v[24:25]
    v_pk_add_f32 v[56:57], v[20:21], v[24:25] neg_lo:[0,1] neg_hi:[0,1]
    v_pk_add_f32 v[18:19], v[50:51], v[54:55]
    v_pk_add_f32 v[22:23], v[50:51], v[54:55] neg_lo:[0,1] neg_hi:[0,1]
    v_pk_add_f32 v[20:21], v[52:53], v[56:57] op_sel:[0,1] op_sel_hi:[1,0] neg_hi:[0,1]
    v_pk_add_f32 v[24:25], v[52:53], v[56:57] op_sel:[0,1] op_sel_hi:[1,0] neg_lo:[0,1]
    v_pk_add_f32 v[58:59], v[26:27], v[30:31]
    v_pk_add_f32 v[60:61], v[26:27], v[30:31] neg_lo:[0,1] neg_hi:[0,1]
    v_pk_add_f32 v[62:63], v[28:29], v[32:33]
    v_pk_add_f32 v[64:65], v[28:29], v[32:33] neg_lo:[0,1] neg_hi:[0,1]
    v_pk_add_f32 v[26:27], v[58:59], v[62:63]
    v_pk_add_f32 v[30:31], v[58:59], v[62:63] neg_lo:[0,1] neg_hi:[0,1]
    v_pk_add_f32 v[28:29], v[60:61], v[64:65] op_sel:[0,1] op_sel_hi:[1,0] neg_hi:[0,1]
    v_pk_add_f32 v[32:33], v[60:61], v[64:65] op_sel:[0,1] op_sel_hi:[1,0] neg_lo:[0,1]
    v_pk_add_f32 v[66:67], v[34:35], v[38:39]
    v_pk_add_f32 v[68:69], v[34:35], v[38:39] neg_lo:[0,1] neg_hi:[0,1]
    v_pk_add_f32 v[70:71], v[36:37], v[40:41]
    v_pk_add_f32 v[72:73], v[36:37], v[40:41] neg_lo:[0,1] neg_hi:[0,1]
    v_pk_add_f32 v[34:35], v[66:67], v[70:71]
    v_pk_add_f32 v[38:39], v[66:67], v[70:71] neg_lo:[0,1] neg_hi:[0,1]
    v_pk_add_f32 v[36:37], v[68:69], v[72:73] op_sel:[0,1] op_sel_hi:[1,0] neg_hi:[0,1]
    v_pk_add_f32 v[40:41], v[68:69], v[72:73] op_sel:[0,1] op_sel_hi:[1,0] neg_lo:[0,1]
    s_waitcnt vmcnt(19)
    ds_write_b64 v5, v[10:11] offset:0
    v_pk_mul_f32 v[44:45], v[18:19], v[74:75] op_sel:[0,0] op_sel_hi:[1,0]
    v_pk_fma_f32 v[18:19], v[18:19], v[74:75], v[44:45] op_sel:[1,1,0] op_sel_hi:[0,1,1] neg_lo:[1,0,0]
    ds_write_b64 v5, v[18:19] offset:1088
    v_pk_mul_f32 v[46:47], v[26:27], v[76:77] op_sel:[0,0] op_sel_hi:[1,0]
    v_pk_fma_f32 v[26:27], v[26:27], v[76:77], v[46:47] op_sel:[1,1,0] op_sel_hi:[0,1,1] neg_lo:[1,0,0]
    ds_write_b64 v5, v[26:27] offset:2176
    v_pk_mul_f32 v[48:49], v[34:35], v[78:79] op_sel:[0,0] op_sel_hi:[1,0]
    v_pk_fma_f32 v[34:35], v[34:35], v[78:79], v[48:49] op_sel:[1,1,0] op_sel_hi:[0,1,1] neg_lo:[1,0,0]
    ds_write_b64 v5, v[34:35] offset:3264
    v_pk_mul_f32 v[50:51], v[12:13], v[80:81] op_sel:[0,0] op_sel_hi:[1,0]
    v_pk_fma_f32 v[12:13], v[12:13], v[80:81], v[50:51] op_sel:[1,1,0] op_sel_hi:[0,1,1] neg_lo:[1,0,0]
    ds_write_b64 v5, v[12:13] offset:4352
    v_pk_mul_f32 v[52:53], v[20:21], v[82:83] op_sel:[0,0] op_sel_hi:[1,0]
    v_pk_fma_f32 v[20:21], v[20:21], v[82:83], v[52:53] op_sel:[1,1,0] op_sel_hi:[0,1,1] neg_lo:[1,0,0]
    ds_write_b64 v5, v[20:21] offset:5440
    v_pk_mul_f32 v[54:55], v[28:29], v[84:85] op_sel:[0,0] op_sel_hi:[1,0]
    v_pk_fma_f32 v[28:29], v[28:29], v[84:85], v[54:55] op_sel:[1,1,0] op_sel_hi:[0,1,1] neg_lo:[1,0,0]
    ds_write_b64 v5, v[28:29] offset:6528
    v_pk_mul_f32 v[56:57], v[36:37], v[86:87] op_sel:[0,0] op_sel_hi:[1,0]
    v_pk_fma_f32 v[36:37], v[36:37], v[86:87], v[56:57] op_sel:[1,1,0] op_sel_hi:[0,1,1] neg_lo:[1,0,0]
    ds_write_b64 v5, v[36:37] offset:7616
    v_pk_mul_f32 v[58:59], v[14:15], v[88:89] op_sel:[0,0] op_sel_hi:[1,0]
    v_pk_fma_f32 v[14:15], v[14:15], v[88:89], v[58:59] op_sel:[1,1,0] op_sel_hi:[0,1,1] neg_lo:[1,0,0]
    ds_write_b64 v5, v[14:15] offset:8704
    v_pk_mul_f32 v[60:61], v[22:23], v[90:91] op_sel:[0,0] op_sel_hi:[1,0]
    v_pk_fma_f32 v[22:23], v[22:23], v[90:91], v[60:61] op_sel:[1,1,0] op_sel_hi:[0,1,1] neg_lo:[1,0,0]
    ds_write_b64 v5, v[22:23] offset:9792
    v_pk_mul_f32 v[62:63], v[30:31], v[92:93] op_sel:[0,0] op_sel_hi:[1,0]
    v_pk_fma_f32 v[30:31], v[30:31], v[92:93], v[62:63] op_sel:[1,1,0] op_sel_hi:[0,1,1] neg_lo:[1,0,0]
    ds_write_b64 v5, v[30:31] offset:10880
    v_pk_mul_f32 v[64:65], v[38:39], v[94:95] op_sel:[0,0] op_sel_hi:[1,0]
    v_pk_fma_f32 v[38:39], v[38:39], v[94:95], v[64:65] op_sel:[1,1,0] op_sel_hi:[0,1,1] neg_lo:[1,0,0]
    ds_write_b64 v5, v[38:39] offset:11968
    v_pk_mul_f32 v[66:67], v[16:17], v[96:97] op_sel:[0,0] op_sel_hi:[1,0]
    v_pk_fma_f32 v[16:17], v[16:17], v[96:97], v[66:67] op_sel:[1,1,0] op_sel_hi:[0,1,1] neg_lo:[1,0,0]
    ds_write_b64 v5, v[16:17] offset:13056
    v_pk_mul_f32 v[68:69], v[24:25], v[98:99] op_sel:[0,0] op_sel_hi:[1,0]
    v_pk_fma_f32 v[24:25], v[24:25], v[98:99], v[68:69] op_sel:[1,1,0] op_sel_hi:[0,1,1] neg_lo:[1,0,0]
    ds_write_b64 v5, v[24:25] offset:14144
    v_pk_mul_f32 v[70:71], v[32:33], v[100:101] op_sel:[0,0] op_sel_hi:[1,0]
    v_pk_fma_f32 v[32:33], v[32:33], v[100:101], v[70:71] op_sel:[1,1,0] op_sel_hi:[0,1,1] neg_lo:[1,0,0]
    ds_write_b64 v5, v[32:33] offset:15232
    v_pk_mul_f32 v[72:73], v[40:41], v[102:103] op_sel:[0,0] op_sel_hi:[1,0]
    v_pk_fma_f32 v[40:41], v[40:41], v[102:103], v[72:73] op_sel:[1,1,0] op_sel_hi:[0,1,1] neg_lo:[1,0,0]
    ds_write_b64 v5, v[40:41] offset:16320
    s_waitcnt lgkmcnt(0)
    s_barrier
    ds_read_b64 v[10:11], v6 offset:0
    ds_read_b64 v[12:13], v6 offset:64
    ds_read_b64 v[14:15], v6 offset:128
    ds_read_b64 v[16:17], v6 offset:192
    ds_read_b64 v[18:19], v6 offset:256
    ds_read_b64 v[20:21], v6 offset:320
    ds_read_b64 v[22:23], v6 offset:384
    ds_read_b64 v[24:25], v6 offset:448
    ds_read_b64 v[26:27], v6 offset:512
    ds_read_b64 v[28:29], v6 offset:576
    ds_read_b64 v[30:31], v6 offset:640
    ds_read_b64 v[32:33], v6 offset:704
    ds_read_b64 v[34:35], v6 offset:768
    ds_read_b64 v[36:37], v6 offset:832
    ds_read_b64 v[38:39], v6 offset:896
    ds_read_b64 v[40:41], v6 offset:960
    s_waitcnt lgkmcnt(0)
    v_pk_add_f32 v[42:43], v[10:11], v[26:27]
    v_pk_add_f32 v[44:45], v[10:11], v[26:27] neg_lo:[0,1] neg_hi:[0,1]
    v_pk_add_f32 v[46:47], v[18:19], v[34:35]
    v_pk_add_f32 v[48:49], v[18:19], v[34:35] neg_lo:[0,1] neg_hi:[0,1]
    v_pk_add_f32 v[10:11], v[42:43], v[46:47]
    v_pk_add_f32 v[26:27], v[42:43], v[46:47] neg_lo:[0,1] neg_hi:[0,1]
    v_pk_add_f32 v[18:19], v[44:45], v[48:49] op_sel:[0,1] op_sel_hi:[1,0] neg_hi:[0,1]
    v_pk_add_f32 v[34:35], v[44:45], v[48:49] op_sel:[0,1] op_sel_hi:[1,0] neg_lo:[0,1]
    v_pk_add_f32 v[50:51], v[12:13], v[28:29]
    v_pk_add_f32 v[52:53], v[12:13], v[28:29] neg_lo:[0,1] neg_hi:[0,1]
    v_pk_add_f32 v[54:55], v[20:21], v[36:37]
    v_pk_add_f32 v[56:57], v[20:21], v[36:37] neg_lo:[0,1] neg_hi:[0,1]
    v_pk_add_f32 v[12:13], v[50:51], v[54:55]
    v_pk_add_f32 v[28:29], v[50:51], v[54:55] neg_lo:[0,1] neg_hi:[0,1]
    v_pk_add_f32 v[20:21], v[52:53], v[56:57] op_sel:[0,1] op_sel_hi:[1,0] neg_hi:[0,1]
    v_pk_add_f32 v[36:37], v[52:53], v[56:57] op_sel:[0,1] op_sel_hi:[1,0] neg_lo:[0,1]
    v_pk_add_f32 v[58:59], v[14:15], v[30:31]
    v_pk_add_f32 v[60:61], v[14:15], v[30:31] neg_lo:[0,1] neg_hi:[0,1]
    v_pk_add_f32 v[62:63], v[22:23], v[38:39]
    v_pk_add_f32 v[64:65], v[22:23], v[38:39] neg_lo:[0,1] neg_hi:[0,1]
    v_pk_add_f32 v[14:15], v[58:59], v[62:63]
    v_pk_add_f32 v[30:31], v[58:59], v[62:63] neg_lo:[0,1] neg_hi:[0,1]
    v_pk_add_f32 v[22:23], v[60:61], v[64:65] op_sel:[0,1] op_sel_hi:[1,0] neg_hi:[0,1]
    v_pk_add_f32 v[38:39], v[60:61], v[64:65] op_sel:[0,1] op_sel_hi:[1,0] neg_lo:[0,1]
    v_pk_add_f32 v[66:67], v[16:17], v[32:33]
    v_pk_add_f32 v[68:69], v[16:17], v[32:33] neg_lo:[0,1] neg_hi:[0,1]
    v_pk_add_f32 v[70:71], v[24:25], v[40:41]
    v_pk_add_f32 v[72:73], v[24:25], v[40:41] neg_lo:[0,1] neg_hi:[0,1]
    v_pk_add_f32 v[16:17], v[66:67], v[70:71]
    v_pk_add_f32 v[32:33], v[66:67], v[70:71] neg_lo:[0,1] neg_hi:[0,1]
    v_pk_add_f32 v[24:25], v[68:69], v[72:73] op_sel:[0,1] op_sel_hi:[1,0] neg_hi:[0,1]
    v_pk_add_f32 v[40:41], v[68:69], v[72:73] op_sel:[0,1] op_sel_hi:[1,0] neg_lo:[0,1]
    v_pk_mul_f32 v[42:43], v[20:21], s[30:31] op_sel:[0,0] op_sel_hi:[1,0]
    v_pk_fma_f32 v[20:21], v[20:21], s[30:31], v[42:43] op_sel:[1,1,0] op_sel_hi:[0,1,1] neg_lo:[1,0,0]
    v_pk_mul_f32 v[42:43], v[28:29], s[32:33] op_sel:[0,0] op_sel_hi:[1,0]
    v_pk_fma_f32 v[28:29], v[28:29], s[32:33], v[42:43] op_sel:[1,1,0] op_sel_hi:[0,1,1] neg_lo:[1,0,0]
    v_pk_mul_f32 v[42:43], v[36:37], s[34:35] op_sel:[0,0] op_sel_hi:[1,0]
    v_pk_fma_f32 v[36:37], v[36:37], s[34:35], v[42:43] op_sel:[1,1,0] op_sel_hi:[0,1,1] neg_lo:[1,0,0]
    v_pk_mul_f32 v[42:43], v[22:23], s[32:33] op_sel:[0,0] op_sel_hi:[1,0]
    v_pk_fma_f32 v[22:23], v[22:23], s[32:33], v[42:43] op_sel:[1,1,0] op_sel_hi:[0,1,1] neg_lo:[1,0,0]
    v_pk_mul_f32 v[42:43], v[30:31], s[36:37] op_sel:[0,0] op_sel_hi:[1,0]
    v_pk_fma_f32 v[30:31], v[30:31], s[36:37], v[42:43] op_sel:[1,1,0] op_sel_hi:[0,1,1] neg_lo:[1,0,0]
    v_pk_mul_f32 v[42:43], v[38:39], s[38:39] op_sel:[0,0] op_sel_hi:[1,0]
    v_pk_fma_f32 v[38:39], v[38:39], s[38:39], v[42:43] op_sel:[1,1,0] op_sel_hi:[0,1,1] neg_lo:[1,0,0]
    v_pk_mul_f32 v[42:43], v[24:25], s[34:35] op_sel:[0,0] op_sel_hi:[1,0]
    v_pk_fma_f32 v[24:25], v[24:25], s[34:35], v[42:43] op_sel:[1,1,0] op_sel_hi:[0,1,1] neg_lo:[1,0,0]
    v_pk_mul_f32 v[42:43], v[32:33], s[38:39] op_sel:[0,0] op_sel_hi:[1,0]
    v_pk_fma_f32 v[32:33], v[32:33], s[38:39], v[42:43] op_sel:[1,1,0] op_sel_hi:[0,1,1] neg_lo:[1,0,0]
    v_pk_mul_f32 v[42:43], v[40:41], s[40:41] op_sel:[0,0] op_sel_hi:[1,0]
    v_pk_fma_f32 v[40:41], v[40:41], s[40:41], v[42:43] op_sel:[1,1,0] op_sel_hi:[0,1,1] neg_lo:[1,0,0]
    v_pk_add_f32 v[42:43], v[10:11], v[14:15]
    v_pk_add_f32 v[44:45], v[10:11], v[14:15] neg_lo:[0,1] neg_hi:[0,1]
    v_pk_add_f32 v[46:47], v[12:13], v[16:17]
    v_pk_add_f32 v[48:49], v[12:13], v[16:17] neg_lo:[0,1] neg_hi:[0,1]
    v_pk_add_f32 v[10:11], v[42:43], v[46:47]
    v_pk_add_f32 v[14:15], v[42:43], v[46:47] neg_lo:[0,1] neg_hi:[0,1]
    v_pk_add_f32 v[12:13], v[44:45], v[48:49] op_sel:[0,1] op_sel_hi:[1,0] neg_hi:[0,1]
    v_pk_add_f32 v[16:17], v[44:45], v[48:49] op_sel:[0,1] op_sel_hi:[1,0] neg_lo:[0,1]
    v_pk_add_f32 v[50:51], v[18:19], v[22:23]
    v_pk_add_f32 v[52:53], v[18:19], v[22:23] neg_lo:[0,1] neg_hi:[0,1]
    v_pk_add_f32 v[54:55], v[20:21], v[24:25]
    v_pk_add_f32 v[56:57], v[20:21], v[24:25] neg_lo:[0,1] neg_hi:[0,1]
    v_pk_add_f32 v[18:19], v[50:51], v[54:55]
    v_pk_add_f32 v[22:23], v[50:51], v[54:55] neg_lo:[0,1] neg_hi:[0,1]
    v_pk_add_f32 v[20:21], v[52:53], v[56:57] op_sel:[0,1] op_sel_hi:[1,0] neg_hi:[0,1]
    v_pk_add_f32 v[24:25], v[52:53], v[56:57] op_sel:[0,1] op_sel_hi:[1,0] neg_lo:[0,1]
    v_pk_add_f32 v[58:59], v[26:27], v[30:31]
    v_pk_add_f32 v[60:61], v[26:27], v[30:31] neg_lo:[0,1] neg_hi:[0,1]
    v_pk_add_f32 v[62:63], v[28:29], v[32:33]
    v_pk_add_f32 v[64:65], v[28:29], v[32:33] neg_lo:[0,1] neg_hi:[0,1]
    v_pk_add_f32 v[26:27], v[58:59], v[62:63]
    v_pk_add_f32 v[30:31], v[58:59], v[62:63] neg_lo:[0,1] neg_hi:[0,1]
    v_pk_add_f32 v[28:29], v[60:61], v[64:65] op_sel:[0,1] op_sel_hi:[1,0] neg_hi:[0,1]
    v_pk_add_f32 v[32:33], v[60:61], v[64:65] op_sel:[0,1] op_sel_hi:[1,0] neg_lo:[0,1]
    v_pk_add_f32 v[66:67], v[34:35], v[38:39]
    v_pk_add_f32 v[68:69], v[34:35], v[38:39] neg_lo:[0,1] neg_hi:[0,1]
    v_pk_add_f32 v[70:71], v[36:37], v[40:41]
    v_pk_add_f32 v[72:73], v[36:37], v[40:41] neg_lo:[0,1] neg_hi:[0,1]
    v_pk_add_f32 v[34:35], v[66:67], v[70:71]
    v_pk_add_f32 v[38:39], v[66:67], v[70:71] neg_lo:[0,1] neg_hi:[0,1]
    v_pk_add_f32 v[36:37], v[68:69], v[72:73] op_sel:[0,1] op_sel_hi:[1,0] neg_hi:[0,1]
    v_pk_add_f32 v[40:41], v[68:69], v[72:73] op_sel:[0,1] op_sel_hi:[1,0] neg_lo:[0,1]
    s_waitcnt vmcnt(4)
    ds_write_b64 v8, v[10:11] offset:17408
    v_pk_mul_f32 v[44:45], v[18:19], v[104:105] op_sel:[0,0] op_sel_hi:[1,0]
    v_pk_fma_f32 v[18:19], v[18:19], v[104:105], v[44:45] op_sel:[1,1,0] op_sel_hi:[0,1,1] neg_lo:[1,0,0]
    ds_write_b64 v8, v[18:19] offset:17488
    v_pk_mul_f32 v[46:47], v[26:27], v[106:107] op_sel:[0,0] op_sel_hi:[1,0]
    v_pk_fma_f32 v[26:27], v[26:27], v[106:107], v[46:47] op_sel:[1,1,0] op_sel_hi:[0,1,1] neg_lo:[1,0,0]
    ds_write_b64 v8, v[26:27] offset:17568
    v_pk_mul_f32 v[48:49], v[34:35], v[108:109] op_sel:[0,0] op_sel_hi:[1,0]
    v_pk_fma_f32 v[34:35], v[34:35], v[108:109], v[48:49] op_sel:[1,1,0] op_sel_hi:[0,1,1] neg_lo:[1,0,0]
    ds_write_b64 v8, v[34:35] offset:17648
    v_pk_mul_f32 v[50:51], v[12:13], v[110:111] op_sel:[0,0] op_sel_hi:[1,0]
    v_pk_fma_f32 v[12:13], v[12:13], v[110:111], v[50:51] op_sel:[1,1,0] op_sel_hi:[0,1,1] neg_lo:[1,0,0]
    ds_write_b64 v8, v[12:13] offset:17728
    v_pk_mul_f32 v[52:53], v[20:21], v[112:113] op_sel:[0,0] op_sel_hi:[1,0]
    v_pk_fma_f32 v[20:21], v[20:21], v[112:113], v[52:53] op_sel:[1,1,0] op_sel_hi:[0,1,1] neg_lo:[1,0,0]
    ds_write_b64 v8, v[20:21] offset:17808
    v_pk_mul_f32 v[54:55], v[28:29], v[114:115] op_sel:[0,0] op_sel_hi:[1,0]
    v_pk_fma_f32 v[28:29], v[28:29], v[114:115], v[54:55] op_sel:[1,1,0] op_sel_hi:[0,1,1] neg_lo:[1,0,0]
    ds_write_b64 v8, v[28:29] offset:17888
    v_pk_mul_f32 v[56:57], v[36:37], v[116:117] op_sel:[0,0] op_sel_hi:[1,0]
    v_pk_fma_f32 v[36:37], v[36:37], v[116:117], v[56:57] op_sel:[1,1,0] op_sel_hi:[0,1,1] neg_lo:[1,0,0]
    ds_write_b64 v8, v[36:37] offset:17968
    v_pk_mul_f32 v[58:59], v[14:15], v[118:119] op_sel:[0,0] op_sel_hi:[1,0]
    v_pk_fma_f32 v[14:15], v[14:15], v[118:119], v[58:59] op_sel:[1,1,0] op_sel_hi:[0,1,1] neg_lo:[1,0,0]
    ds_write_b64 v8, v[14:15] offset:18048
    v_pk_mul_f32 v[60:61], v[22:23], v[120:121] op_sel:[0,0] op_sel_hi:[1,0]
    v_pk_fma_f32 v[22:23], v[22:23], v[120:121], v[60:61] op_sel:[1,1,0] op_sel_hi:[0,1,1] neg_lo:[1,0,0]
    ds_write_b64 v8, v[22:23] offset:18128
    v_pk_mul_f32 v[62:63], v[30:31], v[122:123] op_sel:[0,0] op_sel_hi:[1,0]
    v_pk_fma_f32 v[30:31], v[30:31], v[122:123], v[62:63] op_sel:[1,1,0] op_sel_hi:[0,1,1] neg_lo:[1,0,0]
    ds_write_b64 v8, v[30:31] offset:18208
    v_pk_mul_f32 v[64:65], v[38:39], v[124:125] op_sel:[0,0] op_sel_hi:[1,0]
    v_pk_fma_f32 v[38:39], v[38:39], v[124:125], v[64:65] op_sel:[1,1,0] op_sel_hi:[0,1,1] neg_lo:[1,0,0]
    ds_write_b64 v8, v[38:39] offset:18288
    v_pk_mul_f32 v[66:67], v[16:17], v[126:127] op_sel:[0,0] op_sel_hi:[1,0]
    v_pk_fma_f32 v[16:17], v[16:17], v[126:127], v[66:67] op_sel:[1,1,0] op_sel_hi:[0,1,1] neg_lo:[1,0,0]
    ds_write_b64 v8, v[16:17] offset:18368
    v_pk_mul_f32 v[68:69], v[24:25], v[128:129] op_sel:[0,0] op_sel_hi:[1,0]
    v_pk_fma_f32 v[24:25], v[24:25], v[128:129], v[68:69] op_sel:[1,1,0] op_sel_hi:[0,1,1] neg_lo:[1,0,0]
    ds_write_b64 v8, v[24:25] offset:18448
    v_pk_mul_f32 v[70:71], v[32:33], v[130:131] op_sel:[0,0] op_sel_hi:[1,0]
    v_pk_fma_f32 v[32:33], v[32:33], v[130:131], v[70:71] op_sel:[1,1,0] op_sel_hi:[0,1,1] neg_lo:[1,0,0]
    ds_write_b64 v8, v[32:33] offset:18528
    v_pk_mul_f32 v[72:73], v[40:41], v[132:133] op_sel:[0,0] op_sel_hi:[1,0]
    v_pk_fma_f32 v[40:41], v[40:41], v[132:133], v[72:73] op_sel:[1,1,0] op_sel_hi:[0,1,1] neg_lo:[1,0,0]
    ds_write_b64 v8, v[40:41] offset:18608
    s_waitcnt lgkmcnt(0)
    s_barrier
    ds_read_b128 v[10:13], v7 offset:17408
    ds_read_b128 v[14:17], v7 offset:17424
    ds_read_b128 v[18:21], v7 offset:17440
    ds_read_b128 v[22:25], v7 offset:17456
    ds_read_b128 v[26:29], v7 offset:17488
    ds_read_b128 v[30:33], v7 offset:17504
    ds_read_b128 v[34:37], v7 offset:17520
    ds_read_b128 v[38:41], v7 offset:17536
    s_waitcnt lgkmcnt(0)
    v_pk_add_f32 v[42:43], v[10:11], v[18:19]
    v_pk_add_f32 v[50:51], v[10:11], v[18:19] neg_lo:[0,1] neg_hi:[0,1]
    v_pk_add_f32 v[44:45], v[12:13], v[20:21]
    v_pk_add_f32 v[52:53], v[12:13], v[20:21] neg_lo:[0,1] neg_hi:[0,1]
    v_pk_add_f32 v[46:47], v[14:15], v[22:23]
    v_pk_add_f32 v[54:55], v[14:15], v[22:23] neg_lo:[0,1] neg_hi:[0,1]
    v_pk_add_f32 v[48:49], v[16:17], v[24:25]
    v_pk_add_f32 v[56:57], v[16:17], v[24:25] neg_lo:[0,1] neg_hi:[0,1]
    v_pk_add_f32 v[10:11], v[42:43], v[46:47]
    v_pk_add_f32 v[12:13], v[42:43], v[46:47] neg_lo:[0,1] neg_hi:[0,1]
    v_pk_add_f32 v[14:15], v[44:45], v[48:49]
    v_pk_add_f32 v[16:17], v[44:45], v[48:49] neg_lo:[0,1] neg_hi:[0,1]
    v_pk_add_f32 v[18:19], v[52:53], v[52:53] op_sel:[0,1] op_sel_hi:[1,0] neg_hi:[0,1]
    v_pk_add_f32 v[20:21], v[56:57], v[56:57] op_sel:[0,1] op_sel_hi:[1,0] neg_lo:[1,0] neg_hi:[1,1]
    v_pk_add_f32 v[22:23], v[50:51], v[54:55] op_sel:[0,1] op_sel_hi:[1,0] neg_hi:[0,1]
    v_pk_add_f32 v[24:25], v[50:51], v[54:55] op_sel:[0,1] op_sel_hi:[1,0] neg_lo:[0,1]
    v_pk_add_f32 v[52:53], v[18:19], v[20:21]
    v_pk_add_f32 v[56:57], v[18:19], v[20:21] neg_lo:[0,1] neg_hi:[0,1]
    v_pk_add_f32 v[42:43], v[10:11], v[14:15]
    v_pk_add_f32 v[50:51], v[10:11], v[14:15] neg_lo:[0,1] neg_hi:[0,1]
    v_pk_add_f32 v[46:47], v[12:13], v[16:17] op_sel:[0,1] op_sel_hi:[1,0] neg_hi:[0,1]
    v_pk_add_f32 v[54:55], v[12:13], v[16:17] op_sel:[0,1] op_sel_hi:[1,0] neg_lo:[0,1]
    v_pk_fma_f32 v[44:45], v[52:53], s[24:25], v[22:23]
    v_pk_fma_f32 v[52:53], v[52:53], s[24:25], v[22:23] neg_lo:[1,0,0] neg_hi:[1,0,0]
    v_pk_fma_f32 v[48:49], v[56:57], s[24:25], v[24:25] op_sel:[1,0,0] op_sel_hi:[0,1,1] neg_hi:[1,0,0]
    v_pk_fma_f32 v[56:57], v[56:57], s[24:25], v[24:25] op_sel:[1,0,0] op_sel_hi:[0,1,1] neg_lo:[1,0,0]
    v_pk_add_f32 v[58:59], v[26:27], v[34:35]
    v_pk_add_f32 v[66:67], v[26:27], v[34:35] neg_lo:[0,1] neg_hi:[0,1]
    v_pk_add_f32 v[60:61], v[28:29], v[36:37]
    v_pk_add_f32 v[68:69], v[28:29], v[36:37] neg_lo:[0,1] neg_hi:[0,1]
    v_pk_add_f32 v[62:63], v[30:31], v[38:39]
    v_pk_add_f32 v[70:71], v[30:31], v[38:39] neg_lo:[0,1] neg_hi:[0,1]
    v_pk_add_f32 v[64:65], v[32:33], v[40:41]
    v_pk_add_f32 v[72:73], v[32:33], v[40:41] neg_lo:[0,1] neg_hi:[0,1]
    v_pk_add_f32 v[26:27], v[58:59], v[62:63]
    v_pk_add_f32 v[28:29], v[58:59], v[62:63] neg_lo:[0,1] neg_hi:[0,1]
    v_pk_add_f32 v[30:31], v[60:61], v[64:65]
    v_pk_add_f32 v[32:33], v[60:61], v[64:65] neg_lo:[0,1] neg_hi:[0,1]
    v_pk_add_f32 v[34:35], v[68:69], v[68:69] op_sel:[0,1] op_sel_hi:[1,0] neg_hi:[0,1]
    v_pk_add_f32 v[36:37], v[72:73], v[72:73] op_sel:[0,1] op_sel_hi:[1,0] neg_lo:[1,0] neg_hi:[1,1]
    v_pk_add_f32 v[38:39], v[66:67], v[70:71] op_sel:[0,1] op_sel_hi:[1,0] neg_hi:[0,1]
    v_pk_add_f32 v[40:41], v[66:67], v[70:71] op_sel:[0,1] op_sel_hi:[1,0] neg_lo:[0,1]
    v_pk_add_f32 v[68:69], v[34:35], v[36:37]
    v_pk_add_f32 v[72:73], v[34:35], v[36:37] neg_lo:[0,1] neg_hi:[0,1]
    v_pk_add_f32 v[58:59], v[26:27], v[30:31]
    v_pk_add_f32 v[66:67], v[26:27], v[30:31] neg_lo:[0,1] neg_hi:[0,1]
    v_pk_add_f32 v[62:63], v[28:29], v[32:33] op_sel:[0,1] op_sel_hi:[1,0] neg_hi:[0,1]
    v_pk_add_f32 v[70:71], v[28:29], v[32:33] op_sel:[0,1] op_sel_hi:[1,0] neg_lo:[0,1]
    v_pk_fma_f32 v[60:61], v[68:69], s[24:25], v[38:39]
    v_pk_fma_f32 v[68:69], v[68:69], s[24:25], v[38:39] neg_lo:[1,0,0] neg_hi:[1,0,0]
    v_pk_fma_f32 v[64:65], v[72:73], s[24:25], v[40:41] op_sel:[1,0,0] op_sel_hi:[0,1,1] neg_hi:[1,0,0]
    v_pk_fma_f32 v[72:73], v[72:73], s[24:25], v[40:41] op_sel:[1,0,0] op_sel_hi:[0,1,1] neg_lo:[1,0,0]
    s_waitcnt vmcnt(0)
    v_lshlrev_b32 v10, 16, v134
    v_and_b32 v11, 0xffff0000, v134
    v_pk_mul_f32 v[10:11], v[10:11], s[26:27]
    v_pk_mul_f32 v[26:27], v[42:43], v[10:11] op_sel:[0,0] op_sel_hi:[1,0]
    v_pk_fma_f32 v[42:43], v[42:43], v[10:11], v[26:27] op_sel:[1,1,0] op_sel_hi:[0,1,1] neg_lo:[1,0,0]
    v_lshlrev_b32 v12, 16, v135
    v_and_b32 v13, 0xffff0000, v135
    v_pk_mul_f32 v[12:13], v[12:13], s[26:27]
    v_pk_mul_f32 v[28:29], v[44:45], v[12:13] op_sel:[0,0] op_sel_hi:[1,0]
    v_pk_fma_f32 v[44:45], v[44:45], v[12:13], v[28:29] op_sel:[1,1,0] op_sel_hi:[0,1,1] neg_lo:[1,0,0]
    v_lshlrev_b32 v14, 16, v136
    v_and_b32 v15, 0xffff0000, v136
    v_pk_mul_f32 v[14:15], v[14:15], s[26:27]
    v_pk_mul_f32 v[30:31], v[46:47], v[14:15] op_sel:[0,0] op_sel_hi:[1,0]
    v_pk_fma_f32 v[46:47], v[46:47], v[14:15], v[30:31] op_sel:[1,1,0] op_sel_hi:[0,1,1] neg_lo:[1,0,0]
    v_lshlrev_b32 v16, 16, v137
    v_and_b32 v17, 0xffff0000, v137
    v_pk_mul_f32 v[16:17], v[16:17], s[26:27]
    v_pk_mul_f32 v[32:33], v[48:49], v[16:17] op_sel:[0,0] op_sel_hi:[1,0]
    v_pk_fma_f32 v[48:49], v[48:49], v[16:17], v[32:33] op_sel:[1,1,0] op_sel_hi:[0,1,1] neg_lo:[1,0,0]
    v_lshlrev_b32 v18, 16, v138
    v_and_b32 v19, 0xffff0000, v138
    v_pk_mul_f32 v[18:19], v[18:19], s[26:27]
    v_pk_mul_f32 v[34:35], v[50:51], v[18:19] op_sel:[0,0] op_sel_hi:[1,0]
    v_pk_fma_f32 v[50:51], v[50:51], v[18:19], v[34:35] op_sel:[1,1,0] op_sel_hi:[0,1,1] neg_lo:[1,0,0]
    v_lshlrev_b32 v20, 16, v139
    v_and_b32 v21, 0xffff0000, v139
    v_pk_mul_f32 v[20:21], v[20:21], s[26:27]
    v_pk_mul_f32 v[36:37], v[52:53], v[20:21] op_sel:[0,0] op_sel_hi:[1,0]
    v_pk_fma_f32 v[52:53], v[52:53], v[20:21], v[36:37] op_sel:[1,1,0] op_sel_hi:[0,1,1] neg_lo:[1,0,0]
    v_lshlrev_b32 v22, 16, v140
    v_and_b32 v23, 0xffff0000, v140
    v_pk_mul_f32 v[22:23], v[22:23], s[26:27]
    v_pk_mul_f32 v[38:39], v[54:55], v[22:23] op_sel:[0,0] op_sel_hi:[1,0]
    v_pk_fma_f32 v[54:55], v[54:55], v[22:23], v[38:39] op_sel:[1,1,0] op_sel_hi:[0,1,1] neg_lo:[1,0,0]
    v_lshlrev_b32 v24, 16, v141
    v_and_b32 v25, 0xffff0000, v141
    v_pk_mul_f32 v[24:25], v[24:25], s[26:27]
    v_pk_mul_f32 v[40:41], v[56:57], v[24:25] op_sel:[0,0] op_sel_hi:[1,0]
    v_pk_fma_f32 v[56:57], v[56:57], v[24:25], v[40:41] op_sel:[1,1,0] op_sel_hi:[0,1,1] neg_lo:[1,0,0]
    v_lshlrev_b32 v10, 16, v142
    v_and_b32 v11, 0xffff0000, v142
    v_pk_mul_f32 v[10:11], v[10:11], s[26:27]
    v_pk_mul_f32 v[26:27], v[58:59], v[10:11] op_sel:[0,0] op_sel_hi:[1,0]
    v_pk_fma_f32 v[58:59], v[58:59], v[10:11], v[26:27] op_sel:[1,1,0] op_sel_hi:[0,1,1] neg_lo:[1,0,0]
    v_lshlrev_b32 v12, 16, v143
    v_and_b32 v13, 0xffff0000, v143
    v_pk_mul_f32 v[12:13], v[12:13], s[26:27]
    v_pk_mul_f32 v[28:29], v[60:61], v[12:13] op_sel:[0,0] op_sel_hi:[1,0]
    v_pk_fma_f32 v[60:61], v[60:61], v[12:13], v[28:29] op_sel:[1,1,0] op_sel_hi:[0,1,1] neg_lo:[1,0,0]
    v_lshlrev_b32 v14, 16, v144
    v_and_b32 v15, 0xffff0000, v144
    v_pk_mul_f32 v[14:15], v[14:15], s[26:27]
    v_pk_mul_f32 v[30:31], v[62:63], v[14:15] op_sel:[0,0] op_sel_hi:[1,0]
    v_pk_fma_f32 v[62:63], v[62:63], v[14:15], v[30:31] op_sel:[1,1,0] op_sel_hi:[0,1,1] neg_lo:[1,0,0]
    v_lshlrev_b32 v16, 16, v145
    v_and_b32 v17, 0xffff0000, v145
    v_pk_mul_f32 v[16:17], v[16:17], s[26:27]
    v_pk_mul_f32 v[32:33], v[64:65], v[16:17] op_sel:[0,0] op_sel_hi:[1,0]
    v_pk_fma_f32 v[64:65], v[64:65], v[16:17], v[32:33] op_sel:[1,1,0] op_sel_hi:[0,1,1] neg_lo:[1,0,0]
    v_lshlrev_b32 v18, 16, v146
    v_and_b32 v19, 0xffff0000, v146
    v_pk_mul_f32 v[18:19], v[18:19], s[26:27]
    v_pk_mul_f32 v[34:35], v[66:67], v[18:19] op_sel:[0,0] op_sel_hi:[1,0]
    v_pk_fma_f32 v[66:67], v[66:67], v[18:19], v[34:35] op_sel:[1,1,0] op_sel_hi:[0,1,1] neg_lo:[1,0,0]
    v_lshlrev_b32 v20, 16, v147
    v_and_b32 v21, 0xffff0000, v147
    v_pk_mul_f32 v[20:21], v[20:21], s[26:27]
    v_pk_mul_f32 v[36:37], v[68:69], v[20:21] op_sel:[0,0] op_sel_hi:[1,0]
    v_pk_fma_f32 v[68:69], v[68:69], v[20:21], v[36:37] op_sel:[1,1,0] op_sel_hi:[0,1,1] neg_lo:[1,0,0]
    v_lshlrev_b32 v22, 16, v148
    v_and_b32 v23, 0xffff0000, v148
    v_pk_mul_f32 v[22:23], v[22:23], s[26:27]
    v_pk_mul_f32 v[38:39], v[70:71], v[22:23] op_sel:[0,0] op_sel_hi:[1,0]
    v_pk_fma_f32 v[70:71], v[70:71], v[22:23], v[38:39] op_sel:[1,1,0] op_sel_hi:[0,1,1] neg_lo:[1,0,0]
    v_lshlrev_b32 v24, 16, v149
    v_and_b32 v25, 0xffff0000, v149
    v_pk_mul_f32 v[24:25], v[24:25], s[26:27]
    v_pk_mul_f32 v[40:41], v[72:73], v[24:25] op_sel:[0,0] op_sel_hi:[1,0]
    v_pk_fma_f32 v[72:73], v[72:73], v[24:25], v[40:41] op_sel:[1,1,0] op_sel_hi:[0,1,1] neg_lo:[1,0,0]
    v_pk_add_f32 v[10:11], v[42:43], v[50:51]
    v_pk_add_f32 v[18:19], v[42:43], v[50:51] neg_lo:[0,1] neg_hi:[0,1]
    v_pk_add_f32 v[12:13], v[44:45], v[52:53]
    v_pk_add_f32 v[20:21], v[44:45], v[52:53] neg_lo:[0,1] neg_hi:[0,1]
    v_pk_add_f32 v[14:15], v[46:47], v[54:55]
    v_pk_add_f32 v[22:23], v[46:47], v[54:55] neg_lo:[0,1] neg_hi:[0,1]
    v_pk_add_f32 v[16:17], v[48:49], v[56:57]
    v_pk_add_f32 v[24:25], v[48:49], v[56:57] neg_lo:[0,1] neg_hi:[0,1]
    v_pk_add_f32 v[42:43], v[10:11], v[14:15]
    v_pk_add_f32 v[44:45], v[10:11], v[14:15] neg_lo:[0,1] neg_hi:[0,1]
    v_pk_add_f32 v[46:47], v[12:13], v[16:17]
    v_pk_add_f32 v[48:49], v[12:13], v[16:17] neg_lo:[0,1] neg_hi:[0,1]
    v_pk_add_f32 v[50:51], v[20:21], v[20:21] op_sel:[0,1] op_sel_hi:[1,0] neg_lo:[0,1]
    v_pk_add_f32 v[52:53], v[24:25], v[24:25] op_sel:[0,1] op_sel_hi:[1,0] neg_lo:[1,1] neg_hi:[1,0]
    v_pk_add_f32 v[54:55], v[18:19], v[22:23] op_sel:[0,1] op_sel_hi:[1,0] neg_lo:[0,1]
    v_pk_add_f32 v[56:57], v[18:19], v[22:23] op_sel:[0,1] op_sel_hi:[1,0] neg_hi:[0,1]
    v_pk_add_f32 v[20:21], v[50:51], v[52:53]
    v_pk_add_f32 v[24:25], v[50:51], v[52:53] neg_lo:[0,1] neg_hi:[0,1]
    v_pk_add_f32 v[10:11], v[42:43], v[46:47]
    v_pk_add_f32 v[18:19], v[42:43], v[46:47] neg_lo:[0,1] neg_hi:[0,1]
    v_pk_add_f32 v[14:15], v[44:45], v[48:49] op_sel:[0,1] op_sel_hi:[1,0] neg_lo:[0,1]
    v_pk_add_f32 v[22:23], v[44:45], v[48:49] op_sel:[0,1] op_sel_hi:[1,0] neg_hi:[0,1]
    v_pk_fma_f32 v[12:13], v[20:21], s[24:25], v[54:55]
    v_pk_fma_f32 v[20:21], v[20:21], s[24:25], v[54:55] neg_lo:[1,0,0] neg_hi:[1,0,0]
    v_pk_fma_f32 v[16:17], v[24:25], s[24:25], v[56:57] op_sel:[1,0,0] op_sel_hi:[0,1,1] neg_lo:[1,0,0]
    v_pk_fma_f32 v[24:25], v[24:25], s[24:25], v[56:57] op_sel:[1,0,0] op_sel_hi:[0,1,1] neg_hi:[1,0,0]
    v_pk_add_f32 v[26:27], v[58:59], v[66:67]
    v_pk_add_f32 v[34:35], v[58:59], v[66:67] neg_lo:[0,1] neg_hi:[0,1]
    v_pk_add_f32 v[28:29], v[60:61], v[68:69]
    v_pk_add_f32 v[36:37], v[60:61], v[68:69] neg_lo:[0,1] neg_hi:[0,1]
    v_pk_add_f32 v[30:31], v[62:63], v[70:71]
    v_pk_add_f32 v[38:39], v[62:63], v[70:71] neg_lo:[0,1] neg_hi:[0,1]
    v_pk_add_f32 v[32:33], v[64:65], v[72:73]
    v_pk_add_f32 v[40:41], v[64:65], v[72:73] neg_lo:[0,1] neg_hi:[0,1]
    v_pk_add_f32 v[58:59], v[26:27], v[30:31]
    v_pk_add_f32 v[60:61], v[26:27], v[30:31] neg_lo:[0,1] neg_hi:[0,1]
    v_pk_add_f32 v[62:63], v[28:29], v[32:33]
    v_pk_add_f32 v[64:65], v[28:29], v[32:33] neg_lo:[0,1] neg_hi:[0,1]
    v_pk_add_f32 v[66:67], v[36:37], v[36:37] op_sel:[0,1] op_sel_hi:[1,0] neg_lo:[0,1]
    v_pk_add_f32 v[68:69], v[40:41], v[40:41] op_sel:[0,1] op_sel_hi:[1,0] neg_lo:[1,1] neg_hi:[1,0]
    v_pk_add_f32 v[70:71], v[34:35], v[38:39] op_sel:[0,1] op_sel_hi:[1,0] neg_lo:[0,1]
    v_pk_add_f32 v[72:73], v[34:35], v[38:39] op_sel:[0,1] op_sel_hi:[1,0] neg_hi:[0,1]
    v_pk_add_f32 v[36:37], v[66:67], v[68:69]
    v_pk_add_f32 v[40:41], v[66:67], v[68:69] neg_lo:[0,1] neg_hi:[0,1]
    v_pk_add_f32 v[26:27], v[58:59], v[62:63]
    v_pk_add_f32 v[34:35], v[58:59], v[62:63] neg_lo:[0,1] neg_hi:[0,1]
    v_pk_add_f32 v[30:31], v[60:61], v[64:65] op_sel:[0,1] op_sel_hi:[1,0] neg_lo:[0,1]
    v_pk_add_f32 v[38:39], v[60:61], v[64:65] op_sel:[0,1] op_sel_hi:[1,0] neg_hi:[0,1]
    v_pk_fma_f32 v[28:29], v[36:37], s[24:25], v[70:71]
    v_pk_fma_f32 v[36:37], v[36:37], s[24:25], v[70:71] neg_lo:[1,0,0] neg_hi:[1,0,0]
    v_pk_fma_f32 v[32:33], v[40:41], s[24:25], v[72:73] op_sel:[1,0,0] op_sel_hi:[0,1,1] neg_lo:[1,0,0]
    v_pk_fma_f32 v[40:41], v[40:41], s[24:25], v[72:73] op_sel:[1,0,0] op_sel_hi:[0,1,1] neg_hi:[1,0,0]
    ds_write_b128 v7, v[10:13] offset:17408
    ds_write_b128 v7, v[14:17] offset:17424
    ds_write_b128 v7, v[18:21] offset:17440
    ds_write_b128 v7, v[22:25] offset:17456
    ds_write_b128 v7, v[26:29] offset:17488
    ds_write_b128 v7, v[30:33] offset:17504
    ds_write_b128 v7, v[34:37] offset:17520
    ds_write_b128 v7, v[38:41] offset:17536
    s_waitcnt lgkmcnt(0)
    s_barrier
    ds_read_b64 v[10:11], v8 offset:17408
    ds_read_b64 v[12:13], v8 offset:17488
    ds_read_b64 v[14:15], v8 offset:17568
    ds_read_b64 v[16:17], v8 offset:17648
    ds_read_b64 v[18:19], v8 offset:17728
    ds_read_b64 v[20:21], v8 offset:17808
    ds_read_b64 v[22:23], v8 offset:17888
    ds_read_b64 v[24:25], v8 offset:17968
    ds_read_b64 v[26:27], v8 offset:18048
    ds_read_b64 v[28:29], v8 offset:18128
    ds_read_b64 v[30:31], v8 offset:18208
    ds_read_b64 v[32:33], v8 offset:18288
    ds_read_b64 v[34:35], v8 offset:18368
    ds_read_b64 v[36:37], v8 offset:18448
    ds_read_b64 v[38:39], v8 offset:18528
    ds_read_b64 v[40:41], v8 offset:18608
    s_waitcnt lgkmcnt(0)
    v_pk_mul_f32 v[44:45], v[12:13], v[104:105] op_sel:[0,0] op_sel_hi:[1,0]
    v_pk_fma_f32 v[12:13], v[12:13], v[104:105], v[44:45] op_sel:[1,1,0] op_sel_hi:[0,1,1] neg_hi:[1,0,0]
    v_pk_mul_f32 v[46:47], v[14:15], v[106:107] op_sel:[0,0] op_sel_hi:[1,0]
    v_pk_fma_f32 v[14:15], v[14:15], v[106:107], v[46:47] op_sel:[1,1,0] op_sel_hi:[0,1,1] neg_hi:[1,0,0]
    v_pk_mul_f32 v[48:49], v[16:17], v[108:109] op_sel:[0,0] op_sel_hi:[1,0]
    v_pk_fma_f32 v[16:17], v[16:17], v[108:109], v[48:49] op_sel:[1,1,0] op_sel_hi:[0,1,1] neg_hi:[1,0,0]
    v_pk_mul_f32 v[50:51], v[18:19], v[110:111] op_sel:[0,0] op_sel_hi:[1,0]
    v_pk_fma_f32 v[18:19], v[18:19], v[110:111], v[50:51] op_sel:[1,1,0] op_sel_hi:[0,1,1] neg_hi:[1,0,0]
    v_pk_mul_f32 v[52:53], v[20:21], v[112:113] op_sel:[0,0] op_sel_hi:[1,0]
    v_pk_fma_f32 v[20:21], v[20:21], v[112:113], v[52:53] op_sel:[1,1,0] op_sel_hi:[0,1,1] neg_hi:[1,0,0]
    v_pk_mul_f32 v[54:55], v[22:23], v[114:115] op_sel:[0,0] op_sel_hi:[1,0]
    v_pk_fma_f32 v[22:23], v[22:23], v[114:115], v[54:55] op_sel:[1,1,0] op_sel_hi:[0,1,1] neg_hi:[1,0,0]
    v_pk_mul_f32 v[56:57], v[24:25], v[116:117] op_sel:[0,0] op_sel_hi:[1,0]
    v_pk_fma_f32 v[24:25], v[24:25], v[116:117], v[56:57] op_sel:[1,1,0] op_sel_hi:[0,1,1] neg_hi:[1,0,0]
    v_pk_mul_f32 v[58:59], v[26:27], v[118:119] op_sel:[0,0] op_sel_hi:[1,0]
    v_pk_fma_f32 v[26:27], v[26:27], v[118:119], v[58:59] op_sel:[1,1,0] op_sel_hi:[0,1,1] neg_hi:[1,0,0]
    v_pk_mul_f32 v[60:61], v[28:29], v[120:121] op_sel:[0,0] op_sel_hi:[1,0]
    v_pk_fma_f32 v[28:29], v[28:29], v[120:121], v[60:61] op_sel:[1,1,0] op_sel_hi:[0,1,1] neg_hi:[1,0,0]
    v_pk_mul_f32 v[62:63], v[30:31], v[122:123] op_sel:[0,0] op_sel_hi:[1,0]
    v_pk_fma_f32 v[30:31], v[30:31], v[122:123], v[62:63] op_sel:[1,1,0] op_sel_hi:[0,1,1] neg_hi:[1,0,0]
    v_pk_mul_f32 v[64:65], v[32:33], v[124:125] op_sel:[0,0] op_sel_hi:[1,0]
    v_pk_fma_f32 v[32:33], v[32:33], v[124:125], v[64:65] op_sel:[1,1,0] op_sel_hi:[0,1,1] neg_hi:[1,0,0]
    v_pk_mul_f32 v[66:67], v[34:35], v[126:127] op_sel:[0,0] op_sel_hi:[1,0]
    v_pk_fma_f32 v[34:35], v[34:35], v[126:127], v[66:67] op_sel:[1,1,0] op_sel_hi:[0,1,1] neg_hi:[1,0,0]
    v_pk_mul_f32 v[68:69], v[36:37], v[128:129] op_sel:[0,0] op_sel_hi:[1,0]
    v_pk_fma_f32 v[36:37], v[36:37], v[128:129], v[68:69] op_sel:[1,1,0] op_sel_hi:[0,1,1] neg_hi:[1,0,0]
    v_pk_mul_f32 v[70:71], v[38:39], v[130:131] op_sel:[0,0] op_sel_hi:[1,0]
    v_pk_fma_f32 v[38:39], v[38:39], v[130:131], v[70:71] op_sel:[1,1,0] op_sel_hi:[0,1,1] neg_hi:[1,0,0]
    v_pk_mul_f32 v[72:73], v[40:41], v[132:133] op_sel:[0,0] op_sel_hi:[1,0]
    v_pk_fma_f32 v[40:41], v[40:41], v[132:133], v[72:73] op_sel:[1,1,0] op_sel_hi:[0,1,1] neg_hi:[1,0,0]
    v_pk_add_f32 v[42:43], v[10:11], v[26:27]
    v_pk_add_f32 v[44:45], v[10:11], v[26:27] neg_lo:[0,1] neg_hi:[0,1]
    v_pk_add_f32 v[46:47], v[18:19], v[34:35]
    v_pk_add_f32 v[48:49], v[18:19], v[34:35] neg_lo:[0,1] neg_hi:[0,1]
    v_pk_add_f32 v[10:11], v[42:43], v[46:47]
    v_pk_add_f32 v[26:27], v[42:43], v[46:47] neg_lo:[0,1] neg_hi:[0,1]
    v_pk_add_f32 v[18:19], v[44:45], v[48:49] op_sel:[0,1] op_sel_hi:[1,0] neg_lo:[0,1]
    v_pk_add_f32 v[34:35], v[44:45], v[48:49] op_sel:[0,1] op_sel_hi:[1,0] neg_hi:[0,1]
    v_pk_add_f32 v[50:51], v[12:13], v[28:29]
    v_pk_add_f32 v[52:53], v[12:13], v[28:29] neg_lo:[0,1] neg_hi:[0,1]
    v_pk_add_f32 v[54:55], v[20:21], v[36:37]
    v_pk_add_f32 v[56:57], v[20:21], v[36:37] neg_lo:[0,1] neg_hi:[0,1]
    v_pk_add_f32 v[12:13], v[50:51], v[54:55]
    v_pk_add_f32 v[28:29], v[50:51], v[54:55] neg_lo:[0,1] neg_hi:[0,1]
    v_pk_add_f32 v[20:21], v[52:53], v[56:57] op_sel:[0,1] op_sel_hi:[1,0] neg_lo:[0,1]
    v_pk_add_f32 v[36:37], v[52:53], v[56:57] op_sel:[0,1] op_sel_hi:[1,0] neg_hi:[0,1]
    v_pk_add_f32 v[58:59], v[14:15], v[30:31]
    v_pk_add_f32 v[60:61], v[14:15], v[30:31] neg_lo:[0,1] neg_hi:[0,1]
    v_pk_add_f32 v[62:63], v[22:23], v[38:39]
    v_pk_add_f32 v[64:65], v[22:23], v[38:39] neg_lo:[0,1] neg_hi:[0,1]
    v_pk_add_f32 v[14:15], v[58:59], v[62:63]
    v_pk_add_f32 v[30:31], v[58:59], v[62:63] neg_lo:[0,1] neg_hi:[0,1]
    v_pk_add_f32 v[22:23], v[60:61], v[64:65] op_sel:[0,1] op_sel_hi:[1,0] neg_lo:[0,1]
    v_pk_add_f32 v[38:39], v[60:61], v[64:65] op_sel:[0,1] op_sel_hi:[1,0] neg_hi:[0,1]
    v_pk_add_f32 v[66:67], v[16:17], v[32:33]
    v_pk_add_f32 v[68:69], v[16:17], v[32:33] neg_lo:[0,1] neg_hi:[0,1]
    v_pk_add_f32 v[70:71], v[24:25], v[40:41]
    v_pk_add_f32 v[72:73], v[24:25], v[40:41] neg_lo:[0,1] neg_hi:[0,1]
    v_pk_add_f32 v[16:17], v[66:67], v[70:71]
    v_pk_add_f32 v[32:33], v[66:67], v[70:71] neg_lo:[0,1] neg_hi:[0,1]
    v_pk_add_f32 v[24:25], v[68:69], v[72:73] op_sel:[0,1] op_sel_hi:[1,0] neg_lo:[0,1]
    v_pk_add_f32 v[40:41], v[68:69], v[72:73] op_sel:[0,1] op_sel_hi:[1,0] neg_hi:[0,1]
    v_pk_mul_f32 v[42:43], v[20:21], s[30:31] op_sel:[0,0] op_sel_hi:[1,0]
    v_pk_fma_f32 v[20:21], v[20:21], s[30:31], v[42:43] op_sel:[1,1,0] op_sel_hi:[0,1,1] neg_hi:[1,0,0]
    v_pk_mul_f32 v[42:43], v[28:29], s[32:33] op_sel:[0,0] op_sel_hi:[1,0]
    v_pk_fma_f32 v[28:29], v[28:29], s[32:33], v[42:43] op_sel:[1,1,0] op_sel_hi:[0,1,1] neg_hi:[1,0,0]
    v_pk_mul_f32 v[42:43], v[36:37], s[34:35] op_sel:[0,0] op_sel_hi:[1,0]
    v_pk_fma_f32 v[36:37], v[36:37], s[34:35], v[42:43] op_sel:[1,1,0] op_sel_hi:[0,1,1] neg_hi:[1,0,0]
    v_pk_mul_f32 v[42:43], v[22:23], s[32:33] op_sel:[0,0] op_sel_hi:[1,0]
    v_pk_fma_f32 v[22:23], v[22:23], s[32:33], v[42:43] op_sel:[1,1,0] op_sel_hi:[0,1,1] neg_hi:[1,0,0]
    v_pk_mul_f32 v[42:43], v[30:31], s[36:37] op_sel:[0,0] op_sel_hi:[1,0]
    v_pk_fma_f32 v[30:31], v[30:31], s[36:37], v[42:43] op_sel:[1,1,0] op_sel_hi:[0,1,1] neg_hi:[1,0,0]
    v_pk_mul_f32 v[42:43], v[38:39], s[38:39] op_sel:[0,0] op_sel_hi:[1,0]
    v_pk_fma_f32 v[38:39], v[38:39], s[38:39], v[42:43] op_sel:[1,1,0] op_sel_hi:[0,1,1] neg_hi:[1,0,0]
    v_pk_mul_f32 v[42:43], v[24:25], s[34:35] op_sel:[0,0] op_sel_hi:[1,0]
    v_pk_fma_f32 v[24:25], v[24:25], s[34:35], v[42:43] op_sel:[1,1,0] op_sel_hi:[0,1,1] neg_hi:[1,0,0]
    v_pk_mul_f32 v[42:43], v[32:33], s[38:39] op_sel:[0,0] op_sel_hi:[1,0]
    v_pk_fma_f32 v[32:33], v[32:33], s[38:39], v[42:43] op_sel:[1,1,0] op_sel_hi:[0,1,1] neg_hi:[1,0,0]
    v_pk_mul_f32 v[42:43], v[40:41], s[40:41] op_sel:[0,0] op_sel_hi:[1,0]
    v_pk_fma_f32 v[40:41], v[40:41], s[40:41], v[42:43] op_sel:[1,1,0] op_sel_hi:[0,1,1] neg_hi:[1,0,0]
    v_pk_add_f32 v[42:43], v[10:11], v[14:15]
    v_pk_add_f32 v[44:45], v[10:11], v[14:15] neg_lo:[0,1] neg_hi:[0,1]
    v_pk_add_f32 v[46:47], v[12:13], v[16:17]
    v_pk_add_f32 v[48:49], v[12:13], v[16:17] neg_lo:[0,1] neg_hi:[0,1]
    v_pk_add_f32 v[10:11], v[42:43], v[46:47]
    v_pk_add_f32 v[14:15], v[42:43], v[46:47] neg_lo:[0,1] neg_hi:[0,1]
    v_pk_add_f32 v[12:13], v[44:45], v[48:49] op_sel:[0,1] op_sel_hi:[1,0] neg_lo:[0,1]
    v_pk_add_f32 v[16:17], v[44:45], v[48:49] op_sel:[0,1] op_sel_hi:[1,0] neg_hi:[0,1]
    v_pk_add_f32 v[50:51], v[18:19], v[22:23]
    v_pk_add_f32 v[52:53], v[18:19], v[22:23] neg_lo:[0,1] neg_hi:[0,1]
    v_pk_add_f32 v[54:55], v[20:21], v[24:25]
    v_pk_add_f32 v[56:57], v[20:21], v[24:25] neg_lo:[0,1] neg_hi:[0,1]
    v_pk_add_f32 v[18:19], v[50:51], v[54:55]
    v_pk_add_f32 v[22:23], v[50:51], v[54:55] neg_lo:[0,1] neg_hi:[0,1]
    v_pk_add_f32 v[20:21], v[52:53], v[56:57] op_sel:[0,1] op_sel_hi:[1,0] neg_lo:[0,1]
    v_pk_add_f32 v[24:25], v[52:53], v[56:57] op_sel:[0,1] op_sel_hi:[1,0] neg_hi:[0,1]
    v_pk_add_f32 v[58:59], v[26:27], v[30:31]
    v_pk_add_f32 v[60:61], v[26:27], v[30:31] neg_lo:[0,1] neg_hi:[0,1]
    v_pk_add_f32 v[62:63], v[28:29], v[32:33]
    v_pk_add_f32 v[64:65], v[28:29], v[32:33] neg_lo:[0,1] neg_hi:[0,1]
    v_pk_add_f32 v[26:27], v[58:59], v[62:63]
    v_pk_add_f32 v[30:31], v[58:59], v[62:63] neg_lo:[0,1] neg_hi:[0,1]
    v_pk_add_f32 v[28:29], v[60:61], v[64:65] op_sel:[0,1] op_sel_hi:[1,0] neg_lo:[0,1]
    v_pk_add_f32 v[32:33], v[60:61], v[64:65] op_sel:[0,1] op_sel_hi:[1,0] neg_hi:[0,1]
    v_pk_add_f32 v[66:67], v[34:35], v[38:39]
    v_pk_add_f32 v[68:69], v[34:35], v[38:39] neg_lo:[0,1] neg_hi:[0,1]
    v_pk_add_f32 v[70:71], v[36:37], v[40:41]
    v_pk_add_f32 v[72:73], v[36:37], v[40:41] neg_lo:[0,1] neg_hi:[0,1]
    v_pk_add_f32 v[34:35], v[66:67], v[70:71]
    v_pk_add_f32 v[38:39], v[66:67], v[70:71] neg_lo:[0,1] neg_hi:[0,1]
    v_pk_add_f32 v[36:37], v[68:69], v[72:73] op_sel:[0,1] op_sel_hi:[1,0] neg_lo:[0,1]
    v_pk_add_f32 v[40:41], v[68:69], v[72:73] op_sel:[0,1] op_sel_hi:[1,0] neg_hi:[0,1]
    ds_write_b64 v6, v[10:11] offset:0
    ds_write_b64 v6, v[18:19] offset:64
    ds_write_b64 v6, v[26:27] offset:128
    ds_write_b64 v6, v[34:35] offset:192
    ds_write_b64 v6, v[12:13] offset:256
    ds_write_b64 v6, v[20:21] offset:320
    ds_write_b64 v6, v[28:29] offset:384
    ds_write_b64 v6, v[36:37] offset:448
    ds_write_b64 v6, v[14:15] offset:512
    ds_write_b64 v6, v[22:23] offset:576
    ds_write_b64 v6, v[30:31] offset:640
    ds_write_b64 v6, v[38:39] offset:704
    ds_write_b64 v6, v[16:17] offset:768
    ds_write_b64 v6, v[24:25] offset:832
    ds_write_b64 v6, v[32:33] offset:896
    ds_write_b64 v6, v[40:41] offset:960
    s_waitcnt lgkmcnt(0)
    s_barrier
    ds_read_b64 v[10:11], v5 offset:0
    ds_read_b64 v[12:13], v5 offset:1088
    ds_read_b64 v[14:15], v5 offset:2176
    ds_read_b64 v[16:17], v5 offset:3264
    ds_read_b64 v[18:19], v5 offset:4352
    ds_read_b64 v[20:21], v5 offset:5440
    ds_read_b64 v[22:23], v5 offset:6528
    ds_read_b64 v[24:25], v5 offset:7616
    ds_read_b64 v[26:27], v5 offset:8704
    ds_read_b64 v[28:29], v5 offset:9792
    ds_read_b64 v[30:31], v5 offset:10880
    ds_read_b64 v[32:33], v5 offset:11968
    ds_read_b64 v[34:35], v5 offset:13056
    ds_read_b64 v[36:37], v5 offset:14144
    ds_read_b64 v[38:39], v5 offset:15232
    ds_read_b64 v[40:41], v5 offset:16320
    s_waitcnt lgkmcnt(0)
    v_pk_mul_f32 v[44:45], v[12:13], v[74:75] op_sel:[0,0] op_sel_hi:[1,0]
    v_pk_fma_f32 v[12:13], v[12:13], v[74:75], v[44:45] op_sel:[1,1,0] op_sel_hi:[0,1,1] neg_hi:[1,0,0]
    v_pk_mul_f32 v[46:47], v[14:15], v[76:77] op_sel:[0,0] op_sel_hi:[1,0]
    v_pk_fma_f32 v[14:15], v[14:15], v[76:77], v[46:47] op_sel:[1,1,0] op_sel_hi:[0,1,1] neg_hi:[1,0,0]
    v_pk_mul_f32 v[48:49], v[16:17], v[78:79] op_sel:[0,0] op_sel_hi:[1,0]
    v_pk_fma_f32 v[16:17], v[16:17], v[78:79], v[48:49] op_sel:[1,1,0] op_sel_hi:[0,1,1] neg_hi:[1,0,0]
    v_pk_mul_f32 v[50:51], v[18:19], v[80:81] op_sel:[0,0] op_sel_hi:[1,0]
    v_pk_fma_f32 v[18:19], v[18:19], v[80:81], v[50:51] op_sel:[1,1,0] op_sel_hi:[0,1,1] neg_hi:[1,0,0]
    v_pk_mul_f32 v[52:53], v[20:21], v[82:83] op_sel:[0,0] op_sel_hi:[1,0]
    v_pk_fma_f32 v[20:21], v[20:21], v[82:83], v[52:53] op_sel:[1,1,0] op_sel_hi:[0,1,1] neg_hi:[1,0,0]
    v_pk_mul_f32 v[54:55], v[22:23], v[84:85] op_sel:[0,0] op_sel_hi:[1,0]
    v_pk_fma_f32 v[22:23], v[22:23], v[84:85], v[54:55] op_sel:[1,1,0] op_sel_hi:[0,1,1] neg_hi:[1,0,0]
    v_pk_mul_f32 v[56:57], v[24:25], v[86:87] op_sel:[0,0] op_sel_hi:[1,0]
    v_pk_fma_f32 v[24:25], v[24:25], v[86:87], v[56:57] op_sel:[1,1,0] op_sel_hi:[0,1,1] neg_hi:[1,0,0]
    v_pk_mul_f32 v[58:59], v[26:27], v[88:89] op_sel:[0,0] op_sel_hi:[1,0]
    v_pk_fma_f32 v[26:27], v[26:27], v[88:89], v[58:59] op_sel:[1,1,0] op_sel_hi:[0,1,1] neg_hi:[1,0,0]
    v_pk_mul_f32 v[60:61], v[28:29], v[90:91] op_sel:[0,0] op_sel_hi:[1,0]
    v_pk_fma_f32 v[28:29], v[28:29], v[90:91], v[60:61] op_sel:[1,1,0] op_sel_hi:[0,1,1] neg_hi:[1,0,0]
    v_pk_mul_f32 v[62:63], v[30:31], v[92:93] op_sel:[0,0] op_sel_hi:[1,0]
    v_pk_fma_f32 v[30:31], v[30:31], v[92:93], v[62:63] op_sel:[1,1,0] op_sel_hi:[0,1,1] neg_hi:[1,0,0]
    v_pk_mul_f32 v[64:65], v[32:33], v[94:95] op_sel:[0,0] op_sel_hi:[1,0]
    v_pk_fma_f32 v[32:33], v[32:33], v[94:95], v[64:65] op_sel:[1,1,0] op_sel_hi:[0,1,1] neg_hi:[1,0,0]
    v_pk_mul_f32 v[66:67], v[34:35], v[96:97] op_sel:[0,0] op_sel_hi:[1,0]
    v_pk_fma_f32 v[34:35], v[34:35], v[96:97], v[66:67] op_sel:[1,1,0] op_sel_hi:[0,1,1] neg_hi:[1,0,0]
    v_pk_mul_f32 v[68:69], v[36:37], v[98:99] op_sel:[0,0] op_sel_hi:[1,0]
    v_pk_fma_f32 v[36:37], v[36:37], v[98:99], v[68:69] op_sel:[1,1,0] op_sel_hi:[0,1,1] neg_hi:[1,0,0]
    v_pk_mul_f32 v[70:71], v[38:39], v[100:101] op_sel:[0,0] op_sel_hi:[1,0]
    v_pk_fma_f32 v[38:39], v[38:39], v[100:101], v[70:71] op_sel:[1,1,0] op_sel_hi:[0,1,1] neg_hi:[1,0,0]
    v_pk_mul_f32 v[72:73], v[40:41], v[102:103] op_sel:[0,0] op_sel_hi:[1,0]
    v_pk_fma_f32 v[40:41], v[40:41], v[102:103], v[72:73] op_sel:[1,1,0] op_sel_hi:[0,1,1] neg_hi:[1,0,0]
    v_pk_add_f32 v[42:43], v[10:11], v[26:27]
    v_pk_add_f32 v[44:45], v[10:11], v[26:27] neg_lo:[0,1] neg_hi:[0,1]
    v_pk_add_f32 v[46:47], v[18:19], v[34:35]
    v_pk_add_f32 v[48:49], v[18:19], v[34:35] neg_lo:[0,1] neg_hi:[0,1]
    v_pk_add_f32 v[10:11], v[42:43], v[46:47]
    v_pk_add_f32 v[26:27], v[42:43], v[46:47] neg_lo:[0,1] neg_hi:[0,1]
    v_pk_add_f32 v[18:19], v[44:45], v[48:49] op_sel:[0,1] op_sel_hi:[1,0] neg_lo:[0,1]
    v_pk_add_f32 v[34:35], v[44:45], v[48:49] op_sel:[0,1] op_sel_hi:[1,0] neg_hi:[0,1]
    v_pk_add_f32 v[50:51], v[12:13], v[28:29]
    v_pk_add_f32 v[52:53], v[12:13], v[28:29] neg_lo:[0,1] neg_hi:[0,1]
    v_pk_add_f32 v[54:55], v[20:21], v[36:37]
    v_pk_add_f32 v[56:57], v[20:21], v[36:37] neg_lo:[0,1] neg_hi:[0,1]
    v_pk_add_f32 v[12:13], v[50:51], v[54:55]
    v_pk_add_f32 v[28:29], v[50:51], v[54:55] neg_lo:[0,1] neg_hi:[0,1]
    v_pk_add_f32 v[20:21], v[52:53], v[56:57] op_sel:[0,1] op_sel_hi:[1,0] neg_lo:[0,1]
    v_pk_add_f32 v[36:37], v[52:53], v[56:57] op_sel:[0,1] op_sel_hi:[1,0] neg_hi:[0,1]
    v_pk_add_f32 v[58:59], v[14:15], v[30:31]
    v_pk_add_f32 v[60:61], v[14:15], v[30:31] neg_lo:[0,1] neg_hi:[0,1]
    v_pk_add_f32 v[62:63], v[22:23], v[38:39]
    v_pk_add_f32 v[64:65], v[22:23], v[38:39] neg_lo:[0,1] neg_hi:[0,1]
    v_pk_add_f32 v[14:15], v[58:59], v[62:63]
    v_pk_add_f32 v[30:31], v[58:59], v[62:63] neg_lo:[0,1] neg_hi:[0,1]
    v_pk_add_f32 v[22:23], v[60:61], v[64:65] op_sel:[0,1] op_sel_hi:[1,0] neg_lo:[0,1]
    v_pk_add_f32 v[38:39], v[60:61], v[64:65] op_sel:[0,1] op_sel_hi:[1,0] neg_hi:[0,1]
    v_pk_add_f32 v[66:67], v[16:17], v[32:33]
    v_pk_add_f32 v[68:69], v[16:17], v[32:33] neg_lo:[0,1] neg_hi:[0,1]
    v_pk_add_f32 v[70:71], v[24:25], v[40:41]
    v_pk_add_f32 v[72:73], v[24:25], v[40:41] neg_lo:[0,1] neg_hi:[0,1]
    v_pk_add_f32 v[16:17], v[66:67], v[70:71]
    v_pk_add_f32 v[32:33], v[66:67], v[70:71] neg_lo:[0,1] neg_hi:[0,1]
    v_pk_add_f32 v[24:25], v[68:69], v[72:73] op_sel:[0,1] op_sel_hi:[1,0] neg_lo:[0,1]
    v_pk_add_f32 v[40:41], v[68:69], v[72:73] op_sel:[0,1] op_sel_hi:[1,0] neg_hi:[0,1]
    v_pk_mul_f32 v[42:43], v[20:21], s[30:31] op_sel:[0,0] op_sel_hi:[1,0]
    v_pk_fma_f32 v[20:21], v[20:21], s[30:31], v[42:43] op_sel:[1,1,0] op_sel_hi:[0,1,1] neg_hi:[1,0,0]
    v_pk_mul_f32 v[42:43], v[28:29], s[32:33] op_sel:[0,0] op_sel_hi:[1,0]
    v_pk_fma_f32 v[28:29], v[28:29], s[32:33], v[42:43] op_sel:[1,1,0] op_sel_hi:[0,1,1] neg_hi:[1,0,0]
    v_pk_mul_f32 v[42:43], v[36:37], s[34:35] op_sel:[0,0] op_sel_hi:[1,0]
    v_pk_fma_f32 v[36:37], v[36:37], s[34:35], v[42:43] op_sel:[1,1,0] op_sel_hi:[0,1,1] neg_hi:[1,0,0]
    v_pk_mul_f32 v[42:43], v[22:23], s[32:33] op_sel:[0,0] op_sel_hi:[1,0]
    v_pk_fma_f32 v[22:23], v[22:23], s[32:33], v[42:43] op_sel:[1,1,0] op_sel_hi:[0,1,1] neg_hi:[1,0,0]
    v_pk_mul_f32 v[42:43], v[30:31], s[36:37] op_sel:[0,0] op_sel_hi:[1,0]
    v_pk_fma_f32 v[30:31], v[30:31], s[36:37], v[42:43] op_sel:[1,1,0] op_sel_hi:[0,1,1] neg_hi:[1,0,0]
    v_pk_mul_f32 v[42:43], v[38:39], s[38:39] op_sel:[0,0] op_sel_hi:[1,0]
    v_pk_fma_f32 v[38:39], v[38:39], s[38:39], v[42:43] op_sel:[1,1,0] op_sel_hi:[0,1,1] neg_hi:[1,0,0]
    v_pk_mul_f32 v[42:43], v[24:25], s[34:35] op_sel:[0,0] op_sel_hi:[1,0]
    v_pk_fma_f32 v[24:25], v[24:25], s[34:35], v[42:43] op_sel:[1,1,0] op_sel_hi:[0,1,1] neg_hi:[1,0,0]
    v_pk_mul_f32 v[42:43], v[32:33], s[38:39] op_sel:[0,0] op_sel_hi:[1,0]
    v_pk_fma_f32 v[32:33], v[32:33], s[38:39], v[42:43] op_sel:[1,1,0] op_sel_hi:[0,1,1] neg_hi:[1,0,0]
    v_pk_mul_f32 v[42:43], v[40:41], s[40:41] op_sel:[0,0] op_sel_hi:[1,0]
    v_pk_fma_f32 v[40:41], v[40:41], s[40:41], v[42:43] op_sel:[1,1,0] op_sel_hi:[0,1,1] neg_hi:[1,0,0]
    v_pk_add_f32 v[42:43], v[10:11], v[14:15]
    v_pk_add_f32 v[44:45], v[10:11], v[14:15] neg_lo:[0,1] neg_hi:[0,1]
    v_pk_add_f32 v[46:47], v[12:13], v[16:17]
    v_pk_add_f32 v[48:49], v[12:13], v[16:17] neg_lo:[0,1] neg_hi:[0,1]
    v_pk_add_f32 v[10:11], v[42:43], v[46:47]
    v_pk_add_f32 v[14:15], v[42:43], v[46:47] neg_lo:[0,1] neg_hi:[0,1]
    v_pk_add_f32 v[12:13], v[44:45], v[48:49] op_sel:[0,1] op_sel_hi:[1,0] neg_lo:[0,1]
    v_pk_add_f32 v[16:17], v[44:45], v[48:49] op_sel:[0,1] op_sel_hi:[1,0] neg_hi:[0,1]
    v_pk_add_f32 v[50:51], v[18:19], v[22:23]
    v_pk_add_f32 v[52:53], v[18:19], v[22:23] neg_lo:[0,1] neg_hi:[0,1]
    v_pk_add_f32 v[54:55], v[20:21], v[24:25]
    v_pk_add_f32 v[56:57], v[20:21], v[24:25] neg_lo:[0,1] neg_hi:[0,1]
    v_pk_add_f32 v[18:19], v[50:51], v[54:55]
    v_pk_add_f32 v[22:23], v[50:51], v[54:55] neg_lo:[0,1] neg_hi:[0,1]
    v_pk_add_f32 v[20:21], v[52:53], v[56:57] op_sel:[0,1] op_sel_hi:[1,0] neg_lo:[0,1]
    v_pk_add_f32 v[24:25], v[52:53], v[56:57] op_sel:[0,1] op_sel_hi:[1,0] neg_hi:[0,1]
    v_pk_add_f32 v[58:59], v[26:27], v[30:31]
    v_pk_add_f32 v[60:61], v[26:27], v[30:31] neg_lo:[0,1] neg_hi:[0,1]
    v_pk_add_f32 v[62:63], v[28:29], v[32:33]
    v_pk_add_f32 v[64:65], v[28:29], v[32:33] neg_lo:[0,1] neg_hi:[0,1]
    v_pk_add_f32 v[26:27], v[58:59], v[62:63]
    v_pk_add_f32 v[30:31], v[58:59], v[62:63] neg_lo:[0,1] neg_hi:[0,1]
    v_pk_add_f32 v[28:29], v[60:61], v[64:65] op_sel:[0,1] op_sel_hi:[1,0] neg_lo:[0,1]
    v_pk_add_f32 v[32:33], v[60:61], v[64:65] op_sel:[0,1] op_sel_hi:[1,0] neg_hi:[0,1]
    v_pk_add_f32 v[66:67], v[34:35], v[38:39]
    v_pk_add_f32 v[68:69], v[34:35], v[38:39] neg_lo:[0,1] neg_hi:[0,1]
    v_pk_add_f32 v[70:71], v[36:37], v[40:41]
    v_pk_add_f32 v[72:73], v[36:37], v[40:41] neg_lo:[0,1] neg_hi:[0,1]
    v_pk_add_f32 v[34:35], v[66:67], v[70:71]
    v_pk_add_f32 v[38:39], v[66:67], v[70:71] neg_lo:[0,1] neg_hi:[0,1]
    v_pk_add_f32 v[36:37], v[68:69], v[72:73] op_sel:[0,1] op_sel_hi:[1,0] neg_lo:[0,1]
    v_pk_add_f32 v[40:41], v[68:69], v[72:73] op_sel:[0,1] op_sel_hi:[1,0] neg_hi:[0,1]
    s_lshl_b32 s28, s2, 14
    buffer_store_dwordx2 v[10:11], v5, s[12:15], s28 offen offset:0 sc1
    buffer_store_dwordx2 v[18:19], v5, s[12:15], s28 offen offset:1024 sc1
    buffer_store_dwordx2 v[26:27], v5, s[12:15], s28 offen offset:2048 sc1
    buffer_store_dwordx2 v[34:35], v5, s[12:15], s28 offen offset:3072 sc1
    s_add_u32 s28, s28, 4096
    buffer_store_dwordx2 v[12:13], v5, s[12:15], s28 offen offset:0 sc1
    buffer_store_dwordx2 v[20:21], v5, s[12:15], s28 offen offset:1024 sc1
    buffer_store_dwordx2 v[28:29], v5, s[12:15], s28 offen offset:2048 sc1
    buffer_store_dwordx2 v[36:37], v5, s[12:15], s28 offen offset:3072 sc1
    s_add_u32 s28, s28, 4096
    buffer_store_dwordx2 v[14:15], v5, s[12:15], s28 offen offset:0 sc1
    buffer_store_dwordx2 v[22:23], v5, s[12:15], s28 offen offset:1024 sc1
    buffer_store_dwordx2 v[30:31], v5, s[12:15], s28 offen offset:2048 sc1
    buffer_store_dwordx2 v[38:39], v5, s[12:15], s28 offen offset:3072 sc1
    s_add_u32 s28, s28, 4096
    buffer_store_dwordx2 v[16:17], v5, s[12:15], s28 offen offset:0 sc1
    buffer_store_dwordx2 v[24:25], v5, s[12:15], s28 offen offset:1024 sc1
    buffer_store_dwordx2 v[32:33], v5, s[12:15], s28 offen offset:2048 sc1
    buffer_store_dwordx2 v[40:41], v5, s[12:15], s28 offen offset:3072 sc1
K2_end:
    s_endpgm
K2_helper:
    s_sub_u32 s4, s2, 321
    s_lshl_b32 s4, s4, 1
    s_add_u32 s4, s4, s3
    s_cmp_ge_u32 s4, 960
    s_cbranch_scc1 K2_end
    s_cmp_ge_u32 s4, 480
    s_cbranch_scc1 K2_helper2
    s_load_dwordx2 s[8:9], s[0:1], 32
    s_mul_i32 s5, s4, 104858
    s_lshr_b32 s5, s5, 20
    s_mul_i32 s24, s5, 10
    s_sub_u32 s24, s4, s24
    s_waitcnt lgkmcnt(0)
    s_add_u32 s12, s8, 0x0
    s_addc_u32 s13, s9, 0
    s_and_b32 s13, s13, 0xffff
    s_mov_b32 s14, 0x1e0000
    s_mov_b32 s15, 0x20000
    s_add_u32 s16, s6, 0x1800000
    s_addc_u32 s17, s7, 0
    s_and_b32 s17, s17, 0xffff
    s_mov_b32 s18, 0x1e0000
    s_mov_b32 s19, 0x20000
    v_lshlrev_b32 v4, 4, v1
    v_lshrrev_b32 v2, 5, v1
    v_and_b32 v3, 31, v1
    v_mul_u32_u24 v2, 24576, v2
    v_lshl_add_u32 v2, v3, 1, v2
    s_lshl_b32 s25, s5, 6
    s_mul_i32 s26, s24, 196608
    s_add_u32 s25, s25, s26
    s_mul_i32 s27, s5, 40960
    s_lshl_b32 s26, s24, 12
    s_add_u32 s27, s27, s26
    s_add_u32 s28, s25, 0
    buffer_load_ushort v10, v2, s[12:15], s28 offen
    s_add_u32 s28, s25, 3072
    buffer_load_ushort v11, v2, s[12:15], s28 offen
    s_add_u32 s28, s25, 6144
    buffer_load_ushort v12, v2, s[12:15], s28 offen
    s_add_u32 s28, s25, 9216
    buffer_load_ushort v13, v2, s[12:15], s28 offen
    s_add_u32 s28, s25, 12288
    buffer_load_ushort v14, v2, s[12:15], s28 offen
    s_add_u32 s28, s25, 15360
    buffer_load_ushort v15, v2, s[12:15], s28 offen
    s_add_u32 s28, s25, 18432
    buffer_load_ushort v16, v2, s[12:15], s28 offen
    s_add_u32 s28, s25, 21504
    buffer_load_ushort v17, v2, s[12:15], s28 offen
    s_add_u32 s28, s25, 49152
    buffer_load_ushort v18, v2, s[12:15], s28 offen
    s_add_u32 s28, s25, 52224
    buffer_load_ushort v19, v2, s[12:15], s28 offen
    s_add_u32 s28, s25, 55296
    buffer_load_ushort v20, v2, s[12:15], s28 offen
    s_add_u32 s28, s25, 58368
    buffer_load_ushort v21, v2, s[12:15], s28 offen
    s_add_u32 s28, s25, 61440
    buffer_load_ushort v22, v2, s[12:15], s28 offen
    s_add_u32 s28, s25, 64512
    buffer_load_ushort v23, v2, s[12:15], s28 offen
    s_add_u32 s28, s25, 67584
    buffer_load_ushort v24, v2, s[12:15], s28 offen
    s_add_u32 s28, s25, 70656
    buffer_load_ushort v25, v2, s[12:15], s28 offen
    s_add_u32 s28, s25, 98304
    buffer_load_ushort v26, v2, s[12:15], s28 offen
    s_add_u32 s28, s25, 101376
    buffer_load_ushort v27, v2, s[12:15], s28 offen
    s_add_u32 s28, s25, 104448
    buffer_load_ushort v28, v2, s[12:15], s28 offen
    s_add_u32 s28, s25, 107520
    buffer_load_ushort v29, v2, s[12:15], s28 offen
    s_add_u32 s28, s25, 110592
    buffer_load_ushort v30, v2, s[12:15], s28 offen
    s_add_u32 s28, s25, 113664
    buffer_load_ushort v31, v2, s[12:15], s28 offen
    s_add_u32 s28, s25, 116736
    buffer_load_ushort v32, v2, s[12:15], s28 offen
    s_add_u32 s28, s25, 119808
    buffer_load_ushort v33, v2, s[12:15], s28 offen
    s_add_u32 s28, s25, 147456
    buffer_load_ushort v34, v2, s[12:15], s28 offen
    s_add_u32 s28, s25, 150528
    buffer_load_ushort v35, v2, s[12:15], s28 offen
    s_add_u32 s28, s25, 153600
    buffer_load_ushort v36, v2, s[12:15], s28 offen
    s_add_u32 s28, s25, 156672
    buffer_load_ushort v37, v2, s[12:15], s28 offen
    s_add_u32 s28, s25, 159744
    buffer_load_ushort v38, v2, s[12:15], s28 offen
    s_add_u32 s28, s25, 162816
    buffer_load_ushort v39, v2, s[12:15], s28 offen
    s_add_u32 s28, s25, 165888
    buffer_load_ushort v40, v2, s[12:15], s28 offen
    s_add_u32 s28, s25, 168960
    buffer_load_ushort v41, v2, s[12:15], s28 offen
    s_waitcnt vmcnt(0)
    v_lshl_or_b32 v50, v11, 16, v10
    v_lshl_or_b32 v51, v13, 16, v12
    v_lshl_or_b32 v52, v15, 16, v14
    v_lshl_or_b32 v53, v17, 16, v16
    v_lshl_or_b32 v54, v19, 16, v18
    v_lshl_or_b32 v55, v21, 16, v20
    v_lshl_or_b32 v56, v23, 16, v22
    v_lshl_or_b32 v57, v25, 16, v24
    v_lshl_or_b32 v58, v27, 16, v26
    v_lshl_or_b32 v59, v29, 16, v28
    v_lshl_or_b32 v60, v31, 16, v30
    v_lshl_or_b32 v61, v33, 16, v32
    v_lshl_or_b32 v62, v35, 16, v34
    v_lshl_or_b32 v63, v37, 16, v36
    v_lshl_or_b32 v64, v39, 16, v38
    v_lshl_or_b32 v65, v41, 16, v40
    buffer_store_dwordx4 v[50:53], v4, s[16:19], s27 offen sc1
    s_add_u32 s27, s27, 1024
    buffer_store_dwordx4 v[54:57], v4, s[16:19], s27 offen sc1
    s_add_u32 s27, s27, 1024
    buffer_store_dwordx4 v[58:61], v4, s[16:19], s27 offen sc1
    s_add_u32 s27, s27, 1024
    buffer_store_dwordx4 v[62:65], v4, s[16:19], s27 offen sc1
    s_endpgm
K2_helper2:
    s_sub_u32 s4, s4, 480
    s_load_dwordx2 s[8:9], s[0:1], 48
    s_mul_i32 s5, s4, 87382
    s_lshr_b32 s5, s5, 20
    s_mul_i32 s24, s5, 12
    s_sub_u32 s24, s4, s24
    s_waitcnt lgkmcnt(0)
    s_add_u32 s12, s8, 0x0
    s_addc_u32 s13, s9, 0
    s_and_b32 s13, s13, 0xffff
    s_mov_b32 s14, 0x1e0000
    s_mov_b32 s15, 0x20000
    s_add_u32 s16, s6, 0x1a00000
    s_addc_u32 s17, s7, 0
    s_and_b32 s17, s17, 0xffff
    s_mov_b32 s18, 0x1e0000
    s_mov_b32 s19, 0x20000
    v_lshlrev_b32 v4, 4, v1
    v_lshrrev_b32 v2, 5, v1
    v_lshrrev_b32 v3, 4, v1
    v_and_b32 v3, 1, v3
    v_lshl_add_u32 v2, v2, 2, v3
    v_mul_u32_u24 v2, 5120, v2
    v_and_b32 v3, 15, v1
    v_lshl_add_u32 v2, v3, 1, v2
    s_lshl_b32 s25, s5, 5
    s_mul_i32 s26, s24, 163840
    s_add_u32 s25, s25, s26
    s_mul_i32 s26, s5, 52429
    s_lshr_b32 s26, s26, 18
    s_mul_i32 s27, s26, 5
    s_sub_u32 s27, s5, s27
    s_mul_i32 s26, s26, 240
    s_add_u32 s27, s27, s26
    s_mul_i32 s26, s24, 20
    s_add_u32 s27, s27, s26
    s_lshl_b32 s27, s27, 10
    s_add_u32 s28, s25, 0
    buffer_load_ushort v10, v2, s[12:15], s28 offen
    s_add_u32 s28, s25, 1280
    buffer_load_ushort v11, v2, s[12:15], s28 offen
    s_add_u32 s28, s25, 2560
    buffer_load_ushort v12, v2, s[12:15], s28 offen
    s_add_u32 s28, s25, 3840
    buffer_load_ushort v13, v2, s[12:15], s28 offen
    s_add_u32 s28, s25, 10240
    buffer_load_ushort v14, v2, s[12:15], s28 offen
    s_add_u32 s28, s25, 11520
    buffer_load_ushort v15, v2, s[12:15], s28 offen
    s_add_u32 s28, s25, 12800
    buffer_load_ushort v16, v2, s[12:15], s28 offen
    s_add_u32 s28, s25, 14080
    buffer_load_ushort v17, v2, s[12:15], s28 offen
    s_add_u32 s28, s25, 40960
    buffer_load_ushort v18, v2, s[12:15], s28 offen
    s_add_u32 s28, s25, 42240
    buffer_load_ushort v19, v2, s[12:15], s28 offen
    s_add_u32 s28, s25, 43520
    buffer_load_ushort v20, v2, s[12:15], s28 offen
    s_add_u32 s28, s25, 44800
    buffer_load_ushort v21, v2, s[12:15], s28 offen
    s_add_u32 s28, s25, 51200
    buffer_load_ushort v22, v2, s[12:15], s28 offen
    s_add_u32 s28, s25, 52480
    buffer_load_ushort v23, v2, s[12:15], s28 offen
    s_add_u32 s28, s25, 53760
    buffer_load_ushort v24, v2, s[12:15], s28 offen
    s_add_u32 s28, s25, 55040
    buffer_load_ushort v25, v2, s[12:15], s28 offen
    s_add_u32 s28, s25, 81920
    buffer_load_ushort v26, v2, s[12:15], s28 offen
    s_add_u32 s28, s25, 83200
    buffer_load_ushort v27, v2, s[12:15], s28 offen
    s_add_u32 s28, s25, 84480
    buffer_load_ushort v28, v2, s[12:15], s28 offen
    s_add_u32 s28, s25, 85760
    buffer_load_ushort v29, v2, s[12:15], s28 offen
    s_add_u32 s28, s25, 92160
    buffer_load_ushort v30, v2, s[12:15], s28 offen
    s_add_u32 s28, s25, 93440
    buffer_load_ushort v31, v2, s[12:15], s28 offen
    s_add_u32 s28, s25, 94720
    buffer_load_ushort v32, v2, s[12:15], s28 offen
    s_add_u32 s28, s25, 96000
    buffer_load_ushort v33, v2, s[12:15], s28 offen
    s_add_u32 s28, s25, 122880
    buffer_load_ushort v34, v2, s[12:15], s28 offen
    s_add_u32 s28, s25, 124160
    buffer_load_ushort v35, v2, s[12:15], s28 offen
    s_add_u32 s28, s25, 125440
    buffer_load_ushort v36, v2, s[12:15], s28 offen
    s_add_u32 s28, s25, 126720
    buffer_load_ushort v37, v2, s[12:15], s28 offen
    s_add_u32 s28, s25, 133120
    buffer_load_ushort v38, v2, s[12:15], s28 offen
    s_add_u32 s28, s25, 134400
    buffer_load_ushort v39, v2, s[12:15], s28 offen
    s_add_u32 s28, s25, 135680
    buffer_load_ushort v40, v2, s[12:15], s28 offen
    s_add_u32 s28, s25, 136960
    buffer_load_ushort v41, v2, s[12:15], s28 offen
    s_waitcnt vmcnt(0)
    v_lshl_or_b32 v50, v11, 16, v10
    v_lshl_or_b32 v51, v13, 16, v12
    v_lshl_or_b32 v52, v15, 16, v14
    v_lshl_or_b32 v53, v17, 16, v16
    v_lshl_or_b32 v54, v19, 16, v18
    v_lshl_or_b32 v55, v21, 16, v20
    v_lshl_or_b32 v56, v23, 16, v22
    v_lshl_or_b32 v57, v25, 16, v24
    v_lshl_or_b32 v58, v27, 16, v26
    v_lshl_or_b32 v59, v29, 16, v28
    v_lshl_or_b32 v60, v31, 16, v30
    v_lshl_or_b32 v61, v33, 16, v32
    v_lshl_or_b32 v62, v35, 16, v34
    v_lshl_or_b32 v63, v37, 16, v36
    v_lshl_or_b32 v64, v39, 16, v38
    v_lshl_or_b32 v65, v41, 16, v40
    buffer_store_dwordx4 v[50:53], v4, s[16:19], s27 offen sc1
    s_add_u32 s27, s27, 5120
    buffer_store_dwordx4 v[54:57], v4, s[16:19], s27 offen sc1
    s_add_u32 s27, s27, 5120
    buffer_store_dwordx4 v[58:61], v4, s[16:19], s27 offen sc1
    s_add_u32 s27, s27, 5120
    buffer_store_dwordx4 v[62:65], v4, s[16:19], s27 offen sc1
    s_endpgm
.p2align 8
.globl k3_kernel
.type k3_kernel,@function
k3_kernel:
    s_load_dwordx2 s[4:5], s[0:1], 0
    s_load_dwordx2 s[6:7], s[0:1], 80
    v_lshrrev_b32 v2, 6, v0
    v_and_b32 v1, 63, v0
    s_nop 0
    v_readfirstlane_b32 s3, v2
    s_waitcnt lgkmcnt(0)
    s_cmp_ge_u32 s2, 256
    s_cbranch_scc1 K3_end
    s_add_u32 s12, s4, 0x0
    s_addc_u32 s13, s5, 0
    s_and_b32 s13, s13, 0xffff
    s_mov_b32 s14, 0x280000
    s_mov_b32 s15, 0x20000
    s_add_u32 s16, s6, 0x0
    s_addc_u32 s17, s7, 0
    s_and_b32 s17, s17, 0xffff
    s_mov_b32 s18, 0x508000
    s_mov_b32 s19, 0x20000
    s_getpc_b64 s[20:21]
L_pc_3:
    s_add_u32 s20, s20, twr - L_pc_3
    s_addc_u32 s21, s21, 0
    s_and_b32 s21, s21, 0xffff
    s_mov_b32 s22, 0x13c0
    s_mov_b32 s23, 0x20000
    s_mov_b32 s36, 4096
    v_lshrrev_b32 v3, 3, v0
    v_and_b32 v4, 7, v0
    s_lshl_b32 s37, s2, 6
    v_and_b32 v8, 3, v0
    v_lshrrev_b32 v9, 2, v0
    v_lshlrev_b32 v7, 14, v9
    v_lshl_add_u32 v7, v8, 4, v7
    s_mov_b32 s38, s37
    buffer_load_dwordx4 v[10:13], v7, s[16:19], s38 offen
    s_add_u32 s38, s38, 0x140000
    buffer_load_dwordx4 v[14:17], v7, s[16:19], s38 offen
    s_add_u32 s38, s38, 0x140000
    buffer_load_dwordx4 v[18:21], v7, s[16:19], s38 offen
    s_add_u32 s38, s38, 0x140000
    buffer_load_dwordx4 v[22:25], v7, s[16:19], s38 offen
    s_add_u32 s38, s38, 0x140000
    v_cmp_gt_u32 vcc, 4, v0
    s_cmp_lg_u32 s3, 0
    s_cbranch_scc1 K3_no320
    s_and_saveexec_b64 s[34:35], vcc
    buffer_load_dwordx4 v[120:123], v7, s[16:19], s38 offen
    s_mov_b64 exec, s[34:35]
K3_no320:
    v_lshlrev_b32 v5, 3, v4
    buffer_load_dwordx2 v[68:69], v5, s[20:23], s36 offen offset:512
    buffer_load_dwordx2 v[70:71], v5, s[20:23], s36 offen offset:576
    buffer_load_dwordx2 v[72:73], v5, s[20:23], s36 offen offset:640
    buffer_load_dwordx2 v[74:75], v5, s[20:23], s36 offen offset:704
    buffer_load_dwordx2 v[76:77], v5, s[20:23], s36 offen offset:768
    buffer_load_dwordx2 v[78:79], v5, s[20:23], s36 offen offset:832
    buffer_load_dwordx2 v[80:81], v5, s[20:23], s36 offen offset:896
    s_cmp_ge_u32 s3, 4
    s_cbranch_scc1 K3_pre_done
    s_lshl_b32 s38, s2, 3
    s_lshl_b32 s39, s3, 1
    s_add_u32 s39, s38, s39
    s_mul_i32 s38, s39, 1280
    v_lshlrev_b32 v5, 1, v1
    buffer_load_ushort v100, v5, s[12:15], s38 offen offset:0
    buffer_load_ushort v101, v5, s[12:15], s38 offen offset:1280
    buffer_load_ushort v102, v5, s[12:15], s38 offen offset:128
    buffer_load_ushort v103, v5, s[12:15], s38 offen offset:1408
    buffer_load_ushort v104, v5, s[12:15], s38 offen offset:256
    buffer_load_ushort v105, v5, s[12:15], s38 offen offset:1536
    buffer_load_ushort v106, v5, s[12:15], s38 offen offset:384
    buffer_load_ushort v107, v5, s[12:15], s38 offen offset:1664
    buffer_load_ushort v108, v5, s[12:15], s38 offen offset:512
    buffer_load_ushort v109, v5, s[12:15], s38 offen offset:1792
    buffer_load_ushort v110, v5, s[12:15], s38 offen offset:640
    buffer_load_ushort v111, v5, s[12:15], s38 offen offset:1920
    buffer_load_ushort v112, v5, s[12:15], s38 offen offset:768
    buffer_load_ushort v113, v5, s[12:15], s38 offen offset:2048
    buffer_load_ushort v114, v5, s[12:15], s38 offen offset:896
    buffer_load_ushort v115, v5, s[12:15], s38 offen offset:2176
    buffer_load_ushort v116, v5, s[12:15], s38 offen offset:1024
    buffer_load_ushort v117, v5, s[12:15], s38 offen offset:2304
    buffer_load_ushort v118, v5, s[12:15], s38 offen offset:1152
    buffer_load_ushort v119, v5, s[12:15], s38 offen offset:2432
    v_lshlrev_b32 v5, 3, v1
    buffer_load_dwordx2 v[50:51], v5, s[20:23], 0 offen offset:0
    buffer_load_dwordx2 v[52:53], v5, s[20:23], 0 offen offset:512
    buffer_load_dwordx2 v[54:55], v5, s[20:23], 0 offen offset:1024
    buffer_load_dwordx2 v[56:57], v5, s[20:23], 0 offen offset:1536
    buffer_load_dwordx2 v[58:59], v5, s[20:23], 0 offen offset:2048
    buffer_load_dwordx2 v[60:61], v5, s[20:23], 0 offen offset:2560
    buffer_load_dwordx2 v[62:63], v5, s[20:23], 0 offen offset:3072
    buffer_load_dwordx2 v[64:65], v5, s[20:23], 0 offen offset:3584
    buffer_load_dwordx2 v[66:67], v5, s[20:23], s36 offen
K3_pre_done:
    s_add_u32 s44, s6, 0xa00000
    s_addc_u32 s45, s7, 0
    s_and_b32 s45, s45, 0xffff
    s_mov_b32 s46, 0x280000
    s_mov_b32 s47, 0x20000
    s_add_u32 s48, s6, 0xd00000
    s_addc_u32 s49, s7, 0
    s_and_b32 s49, s49, 0xffff
    s_mov_b32 s50, 0x280000
    s_mov_b32 s51, 0x20000
    s_mov_b32 s24, 0x3f3504f3
    s_mov_b32 s25, 0x3f3504f3
    s_mov_b32 s26, 0x3e9e377a
    s_mov_b32 s27, 0x3e9e377a
    s_mov_b32 s28, 0xbf4f1bbd
    s_mov_b32 s29, 0xbf4f1bbd
    s_mov_b32 s30, 0x3f737871
    s_mov_b32 s31, 0x3f737871
    s_mov_b32 s32, 0x3f167918
    s_mov_b32 s33, 0x3f167918
    s_mov_b32 s52, 0x3acccccd
    s_mov_b32 s53, 0x3acccccd
    s_mov_b32 s54, 0x44200000
    s_mov_b32 s55, 0x44200000
    s_mov_b32 s56, 0x3727c5ac
    s_mov_b32 s57, 0x3727c5ac
    v_mul_u32_u24 v5, 5248, v8
    v_sub_u32 v6, 400, v9
    v_lshl_add_u32 v6, v6, 3, v5
    v_lshl_add_u32 v5, v9, 3, v5
    v_add_u32 v7, 1920, v6
    v_cndmask_b32 v7, v7, v5, vcc
    s_cmp_ge_u32 s3, 4
    s_cbranch_scc1 K3_w4
    s_waitcnt vmcnt(36)
    s_branch K3_wj
K3_w4:
    s_waitcnt vmcnt(7)
K3_wj:
    v_cndmask_b32 v11, v11, 0, vcc
    v_cndmask_b32 v13, v13, 0, vcc
    v_pk_add_f32 v[30:31], v[10:11], v[12:13] op_sel:[0,1] op_sel_hi:[1,0] neg_lo:[0,1]
    v_pk_add_f32 v[32:33], v[10:11], v[12:13] op_sel:[0,1] op_sel_hi:[1,0] neg_hi:[1,0]
    ds_write_b64 v7, v[32:33]
    ds_write_b64 v5, v[30:31] offset:0
    v_pk_add_f32 v[34:35], v[14:15], v[16:17] op_sel:[0,1] op_sel_hi:[1,0] neg_lo:[0,1]
    v_pk_add_f32 v[36:37], v[14:15], v[16:17] op_sel:[0,1] op_sel_hi:[1,0] neg_hi:[1,0]
    ds_write_b64 v6, v[36:37] offset:1280
    ds_write_b64 v5, v[34:35] offset:640
    v_pk_add_f32 v[38:39], v[18:19], v[20:21] op_sel:[0,1] op_sel_hi:[1,0] neg_lo:[0,1]
    v_pk_add_f32 v[40:41], v[18:19], v[20:21] op_sel:[0,1] op_sel_hi:[1,0] neg_hi:[1,0]
    ds_write_b64 v6, v[40:41] offset:640
    ds_write_b64 v5, v[38:39] offset:1280
    v_pk_add_f32 v[42:43], v[22:23], v[24:25] op_sel:[0,1] op_sel_hi:[1,0] neg_lo:[0,1]
    v_pk_add_f32 v[44:45], v[22:23], v[24:25] op_sel:[0,1] op_sel_hi:[1,0] neg_hi:[1,0]
    ds_write_b64 v6, v[44:45] offset:0
    ds_write_b64 v5, v[42:43] offset:1920
    s_cmp_lg_u32 s3, 0
    s_cbranch_scc1 K3_no320b
    s_and_saveexec_b64 s[34:35], vcc
    v_mov_b32 v121, v122
    ds_write_b64 v5, v[120:121] offset:2560
    s_mov_b64 exec, s[34:35]
K3_no320b:
    v_mul_u32_u24 v6, 205, v3
    v_lshrrev_b32 v6, 11, v6
    v_mul_u32_u24 v7, 10, v6
    v_sub_u32 v7, v3, v7
    v_mul_u32_u24 v8, 10, v4
    v_add_u32 v7, v7, v8
    v_lshlrev_b32 v7, 3, v7
    v_mul_u32_u24 v6, 5248, v6
    v_add_u32 v7, v7, v6
    v_mul_u32_u24 v5, 576, v3
    v_lshl_add_u32 v6, v4, 6, v5
    v_lshl_add_u32 v5, v4, 3, v5
    s_waitcnt lgkmcnt(0)
    s_barrier
    ds_read_b64 v[10:11], v7 offset:0
    ds_read_b64 v[12:13], v7 offset:640
    ds_read_b64 v[14:15], v7 offset:1280
    ds_read_b64 v[16:17], v7 offset:1920
    ds_read_b64 v[18:19], v7 offset:2560
    ds_read_b64 v[20:21], v7 offset:3200
    ds_read_b64 v[22:23], v7 offset:3840
    ds_read_b64 v[24:25], v7 offset:4480
    s_waitcnt lgkmcnt(0)
    v_pk_add_f32 v[30:31], v[10:11], v[18:19]
    v_pk_add_f32 v[38:39], v[10:11], v[18:19] neg_lo:[0,1] neg_hi:[0,1]
    v_pk_add_f32 v[32:33], v[12:13], v[20:21]
    v_pk_add_f32 v[40:41], v[12:13], v[20:21] neg_lo:[0,1] neg_hi:[0,1]
    v_pk_add_f32 v[34:35], v[14:15], v[22:23]
    v_pk_add_f32 v[42:43], v[14:15], v[22:23] neg_lo:[0,1] neg_hi:[0,1]
    v_pk_add_f32 v[36:37], v[16:17], v[24:25]
    v_pk_add_f32 v[44:45], v[16:17], v[24:25] neg_lo:[0,1] neg_hi:[0,1]
    v_pk_add_f32 v[10:11], v[30:31], v[34:35]
    v_pk_add_f32 v[12:13], v[30:31], v[34:35] neg_lo:[0,1] neg_hi:[0,1]
    v_pk_add_f32 v[14:15], v[32:33], v[36:37]
    v_pk_add_f32 v[16:17], v[32:33], v[36:37] neg_lo:[0,1] neg_hi:[0,1]
    v_pk_add_f32 v[18:19], v[40:41], v[40:41] op_sel:[0,1] op_sel_hi:[1,0] neg_lo:[0,1]
    v_pk_add_f32 v[20:21], v[44:45], v[44:45] op_sel:[0,1] op_sel_hi:[1,0] neg_lo:[1,1] neg_hi:[1,0]
    v_pk_add_f32 v[22:23], v[38:39], v[42:43] op_sel:[0,1] op_sel_hi:[1,0] neg_lo:[0,1]
    v_pk_add_f32 v[24:25], v[38:39], v[42:43] op_sel:[0,1] op_sel_hi:[1,0] neg_hi:[0,1]
    v_pk_add_f32 v[40:41], v[18:19], v[20:21]
    v_pk_add_f32 v[44:45], v[18:19], v[20:21] neg_lo:[0,1] neg_hi:[0,1]
    v_pk_add_f32 v[30:31], v[10:11], v[14:15]
    v_pk_add_f32 v[38:39], v[10:11], v[14:15] neg_lo:[0,1] neg_hi:[0,1]
    v_pk_add_f32 v[34:35], v[12:13], v[16:17] op_sel:[0,1] op_sel_hi:[1,0] neg_lo:[0,1]
    v_pk_add_f32 v[42:43], v[12:13], v[16:17] op_sel:[0,1] op_sel_hi:[1,0] neg_hi:[0,1]
    v_pk_fma_f32 v[32:33], v[40:41], s[24:25], v[22:23]
    v_pk_fma_f32 v[40:41], v[40:41], s[24:25], v[22:23] neg_lo:[1,0,0] neg_hi:[1,0,0]
    v_pk_fma_f32 v[36:37], v[44:45], s[24:25], v[24:25] op_sel:[1,0,0] op_sel_hi:[0,1,1] neg_lo:[1,0,0]
    v_pk_fma_f32 v[44:45], v[44:45], s[24:25], v[24:25] op_sel:[1,0,0] op_sel_hi:[0,1,1] neg_hi:[1,0,0]
    s_cmp_ge_u32 s3, 4
    s_cbranch_scc1 K3_w4b
    s_waitcnt vmcnt(29)
    s_branch K3_wjb
K3_w4b:
    s_waitcnt vmcnt(0)
K3_wjb:
    v_pk_mul_f32 v[12:13], v[32:33], v[68:69] op_sel:[0,0] op_sel_hi:[1,0]
    v_pk_fma_f32 v[32:33], v[32:33], v[68:69], v[12:13] op_sel:[1,1,0] op_sel_hi:[0,1,1] neg_hi:[1,0,0]
    v_pk_mul_f32 v[14:15], v[34:35], v[70:71] op_sel:[0,0] op_sel_hi:[1,0]
    v_pk_fma_f32 v[34:35], v[34:35], v[70:71], v[14:15] op_sel:[1,1,0] op_sel_hi:[0,1,1] neg_hi:[1,0,0]
    v_pk_mul_f32 v[16:17], v[36:37], v[72:73] op_sel:[0,0] op_sel_hi:[1,0]
    v_pk_fma_f32 v[36:37], v[36:37], v[72:73], v[16:17] op_sel:[1,1,0] op_sel_hi:[0,1,1] neg_hi:[1,0,0]
    v_pk_mul_f32 v[18:19], v[38:39], v[74:75] op_sel:[0,0] op_sel_hi:[1,0]
    v_pk_fma_f32 v[38:39], v[38:39], v[74:75], v[18:19] op_sel:[1,1,0] op_sel_hi:[0,1,1] neg_hi:[1,0,0]
    v_pk_mul_f32 v[20:21], v[40:41], v[76:77] op_sel:[0,0] op_sel_hi:[1,0]
    v_pk_fma_f32 v[40:41], v[40:41], v[76:77], v[20:21] op_sel:[1,1,0] op_sel_hi:[0,1,1] neg_hi:[1,0,0]
    v_pk_mul_f32 v[22:23], v[42:43], v[78:79] op_sel:[0,0] op_sel_hi:[1,0]
    v_pk_fma_f32 v[42:43], v[42:43], v[78:79], v[22:23] op_sel:[1,1,0] op_sel_hi:[0,1,1] neg_hi:[1,0,0]
    v_pk_mul_f32 v[24:25], v[44:45], v[80:81] op_sel:[0,0] op_sel_hi:[1,0]
    v_pk_fma_f32 v[44:45], v[44:45], v[80:81], v[24:25] op_sel:[1,1,0] op_sel_hi:[0,1,1] neg_hi:[1,0,0]
    ds_write_b128 v6, v[30:33] offset:23040
    ds_write_b128 v6, v[34:37] offset:23056
    ds_write_b128 v6, v[38:41] offset:23072
    ds_write_b128 v6, v[42:45] offset:23088
    s_waitcnt lgkmcnt(0)
    s_barrier
    ds_read_b64 v[10:11], v5 offset:23040
    ds_read_b64 v[12:13], v5 offset:23104
    ds_read_b64 v[14:15], v5 offset:23168
    ds_read_b64 v[16:17], v5 offset:23232
    ds_read_b64 v[18:19], v5 offset:23296
    ds_read_b64 v[20:21], v5 offset:23360
    ds_read_b64 v[22:23], v5 offset:23424
    ds_read_b64 v[24:25], v5 offset:23488
    s_waitcnt lgkmcnt(0)
    v_pk_add_f32 v[30:31], v[10:11], v[18:19]
    v_pk_add_f32 v[38:39], v[10:11], v[18:19] neg_lo:[0,1] neg_hi:[0,1]
    v_pk_add_f32 v[32:33], v[12:13], v[20:21]
    v_pk_add_f32 v[40:41], v[12:13], v[20:21] neg_lo:[0,1] neg_hi:[0,1]
    v_pk_add_f32 v[34:35], v[14:15], v[22:23]
    v_pk_add_f32 v[42:43], v[14:15], v[22:23] neg_lo:[0,1] neg_hi:[0,1]
    v_pk_add_f32 v[36:37], v[16:17], v[24:25]
    v_pk_add_f32 v[44:45], v[16:17], v[24:25] neg_lo:[0,1] neg_hi:[0,1]
    v_pk_add_f32 v[10:11], v[30:31], v[34:35]
    v_pk_add_f32 v[12:13], v[30:31], v[34:35] neg_lo:[0,1] neg_hi:[0,1]
    v_pk_add_f32 v[14:15], v[32:33], v[36:37]
    v_pk_add_f32 v[16:17], v[32:33], v[36:37] neg_lo:[0,1] neg_hi:[0,1]
    v_pk_add_f32 v[18:19], v[40:41], v[40:41] op_sel:[0,1] op_sel_hi:[1,0] neg_lo:[0,1]
    v_pk_add_f32 v[20:21], v[44:45], v[44:45] op_sel:[0,1] op_sel_hi:[1,0] neg_lo:[1,1] neg_hi:[1,0]
    v_pk_add_f32 v[22:23], v[38:39], v[42:43] op_sel:[0,1] op_sel_hi:[1,0] neg_lo:[0,1]
    v_pk_add_f32 v[24:25], v[38:39], v[42:43] op_sel:[0,1] op_sel_hi:[1,0] neg_hi:[0,1]
    v_pk_add_f32 v[40:41], v[18:19], v[20:21]
    v_pk_add_f32 v[44:45], v[18:19], v[20:21] neg_lo:[0,1] neg_hi:[0,1]
    v_pk_add_f32 v[30:31], v[10:11], v[14:15]
    v_pk_add_f32 v[38:39], v[10:11], v[14:15] neg_lo:[0,1] neg_hi:[0,1]
    v_pk_add_f32 v[34:35], v[12:13], v[16:17] op_sel:[0,1] op_sel_hi:[1,0] neg_lo:[0,1]
    v_pk_add_f32 v[42:43], v[12:13], v[16:17] op_sel:[0,1] op_sel_hi:[1,0] neg_hi:[0,1]
    v_pk_fma_f32 v[32:33], v[40:41], s[24:25], v[22:23]
    v_pk_fma_f32 v[40:41], v[40:41], s[24:25], v[22:23] neg_lo:[1,0,0] neg_hi:[1,0,0]
    v_pk_fma_f32 v[36:37], v[44:45], s[24:25], v[24:25] op_sel:[1,0,0] op_sel_hi:[0,1,1] neg_lo:[1,0,0]
    v_pk_fma_f32 v[44:45], v[44:45], s[24:25], v[24:25] op_sel:[1,0,0] op_sel_hi:[0,1,1] neg_hi:[1,0,0]
    ds_write_b64 v5, v[30:31] offset:0
    ds_write_b64 v5, v[32:33] offset:64
    ds_write_b64 v5, v[34:35] offset:128
    ds_write_b64 v5, v[36:37] offset:192
    ds_write_b64 v5, v[38:39] offset:256
    ds_write_b64 v5, v[40:41] offset:320
    ds_write_b64 v5, v[42:43] offset:384
    ds_write_b64 v5, v[44:45] offset:448
    s_waitcnt lgkmcnt(0)
    s_barrier
    s_cmp_ge_u32 s3, 4
    s_cbranch_scc1 K3_end
    s_mul_i32 s40, s3, 5760
    v_lshlrev_b32 v5, 3, v1
    v_add_u32 v5, s40, v5
    ds_read_b64 v[10:11], v5 offset:0
    ds_read_b64 v[12:13], v5 offset:576
    ds_read_b64 v[14:15], v5 offset:1152
    ds_read_b64 v[16:17], v5 offset:1728
    ds_read_b64 v[18:19], v5 offset:2304
    ds_read_b64 v[20:21], v5 offset:2880
    ds_read_b64 v[22:23], v5 offset:3456
    ds_read_b64 v[24:25], v5 offset:4032
    ds_read_b64 v[26:27], v5 offset:4608
    ds_read_b64 v[28:29], v5 offset:5184
    s_waitcnt vmcnt(0) lgkmcnt(0)
    v_pk_mul_f32 v[32:33], v[12:13], v[50:51] op_sel:[0,0] op_sel_hi:[1,0]
    v_pk_fma_f32 v[12:13], v[12:13], v[50:51], v[32:33] op_sel:[1,1,0] op_sel_hi:[0,1,1] neg_hi:[1,0,0]
    v_pk_mul_f32 v[34:35], v[14:15], v[52:53] op_sel:[0,0] op_sel_hi:[1,0]
    v_pk_fma_f32 v[14:15], v[14:15], v[52:53], v[34:35] op_sel:[1,1,0] op_sel_hi:[0,1,1] neg_hi:[1,0,0]
    v_pk_mul_f32 v[36:37], v[16:17], v[54:55] op_sel:[0,0] op_sel_hi:[1,0]
    v_pk_fma_f32 v[16:17], v[16:17], v[54:55], v[36:37] op_sel:[1,1,0] op_sel_hi:[0,1,1] neg_hi:[1,0,0]
    v_pk_mul_f32 v[38:39], v[18:19], v[56:57] op_sel:[0,0] op_sel_hi:[1,0]
    v_pk_fma_f32 v[18:19], v[18:19], v[56:57], v[38:39] op_sel:[1,1,0] op_sel_hi:[0,1,1] neg_hi:[1,0,0]
    v_pk_mul_f32 v[40:41], v[20:21], v[58:59] op_sel:[0,0] op_sel_hi:[1,0]
    v_pk_fma_f32 v[20:21], v[20:21], v[58:59], v[40:41] op_sel:[1,1,0] op_sel_hi:[0,1,1] neg_hi:[1,0,0]
    v_pk_mul_f32 v[42:43], v[22:23], v[60:61] op_sel:[0,0] op_sel_hi:[1,0]
    v_pk_fma_f32 v[22:23], v[22:23], v[60:61], v[42:43] op_sel:[1,1,0] op_sel_hi:[0,1,1] neg_hi:[1,0,0]
    v_pk_mul_f32 v[44:45], v[24:25], v[62:63] op_sel:[0,0] op_sel_hi:[1,0]
    v_pk_fma_f32 v[24:25], v[24:25], v[62:63], v[44:45] op_sel:[1,1,0] op_sel_hi:[0,1,1] neg_hi:[1,0,0]
    v_pk_mul_f32 v[46:47], v[26:27], v[64:65] op_sel:[0,0] op_sel_hi:[1,0]
    v_pk_fma_f32 v[26:27], v[26:27], v[64:65], v[46:47] op_sel:[1,1,0] op_sel_hi:[0,1,1] neg_hi:[1,0,0]
    v_pk_mul_f32 v[48:49], v[28:29], v[66:67] op_sel:[0,0] op_sel_hi:[1,0]
    v_pk_fma_f32 v[28:29], v[28:29], v[66:67], v[48:49] op_sel:[1,1,0] op_sel_hi:[0,1,1] neg_hi:[1,0,0]
    v_pk_add_f32 v[30:31], v[10:11], v[20:21]
    v_pk_add_f32 v[40:41], v[10:11], v[20:21] neg_lo:[0,1] neg_hi:[0,1]
    v_pk_add_f32 v[32:33], v[14:15], v[24:25]
    v_pk_add_f32 v[42:43], v[14:15], v[24:25] neg_lo:[0,1] neg_hi:[0,1]
    v_pk_add_f32 v[34:35], v[18:19], v[28:29]
    v_pk_add_f32 v[44:45], v[18:19], v[28:29] neg_lo:[0,1] neg_hi:[0,1]
    v_pk_add_f32 v[36:37], v[22:23], v[12:13]
    v_pk_add_f32 v[46:47], v[22:23], v[12:13] neg_lo:[0,1] neg_hi:[0,1]
    v_pk_add_f32 v[38:39], v[26:27], v[16:17]
    v_pk_add_f32 v[48:49], v[26:27], v[16:17] neg_lo:[0,1] neg_hi:[0,1]
    v_pk_add_f32 v[10:11], v[32:33], v[38:39]
    v_pk_add_f32 v[12:13], v[34:35], v[36:37]
    v_pk_add_f32 v[14:15], v[32:33], v[38:39] neg_lo:[0,1] neg_hi:[0,1]
    v_pk_add_f32 v[16:17], v[34:35], v[36:37] neg_lo:[0,1] neg_hi:[0,1]
    v_pk_fma_f32 v[20:21], v[10:11], s[26:27], v[30:31]
    v_pk_fma_f32 v[22:23], v[10:11], s[28:29], v[30:31]
    v_pk_mul_f32 v[24:25], v[14:15], s[30:31]
    v_pk_mul_f32 v[26:27], v[14:15], s[32:33]
    v_pk_add_f32 v[18:19], v[10:11], v[12:13]
    v_pk_fma_f32 v[20:21], v[12:13], s[28:29], v[20:21]
    v_pk_fma_f32 v[22:23], v[12:13], s[26:27], v[22:23]
    v_pk_fma_f32 v[24:25], v[16:17], s[32:33], v[24:25]
    v_pk_fma_f32 v[26:27], v[16:17], s[30:31], v[26:27] neg_lo:[1,0,0] neg_hi:[1,0,0]
    v_pk_add_f32 v[30:31], v[30:31], v[18:19]
    v_pk_add_f32 v[32:33], v[20:21], v[24:25] op_sel:[0,1] op_sel_hi:[1,0] neg_lo:[0,1]
    v_pk_add_f32 v[38:39], v[20:21], v[24:25] op_sel:[0,1] op_sel_hi:[1,0] neg_hi:[0,1]
    v_pk_add_f32 v[34:35], v[22:23], v[26:27] op_sel:[0,1] op_sel_hi:[1,0] neg_lo:[0,1]
    v_pk_add_f32 v[36:37], v[22:23], v[26:27] op_sel:[0,1] op_sel_hi:[1,0] neg_hi:[0,1]
    v_pk_add_f32 v[10:11], v[42:43], v[48:49]
    v_pk_add_f32 v[12:13], v[44:45], v[46:47]
    v_pk_add_f32 v[14:15], v[42:43], v[48:49] neg_lo:[0,1] neg_hi:[0,1]
    v_pk_add_f32 v[16:17], v[44:45], v[46:47] neg_lo:[0,1] neg_hi:[0,1]
    v_pk_fma_f32 v[20:21], v[10:11], s[26:27], v[40:41]
    v_pk_fma_f32 v[22:23], v[10:11], s[28:29], v[40:41]
    v_pk_mul_f32 v[24:25], v[14:15], s[30:31]
    v_pk_mul_f32 v[26:27], v[14:15], s[32:33]
    v_pk_add_f32 v[18:19], v[10:11], v[12:13]
    v_pk_fma_f32 v[20:21], v[12:13], s[28:29], v[20:21]
    v_pk_fma_f32 v[22:23], v[12:13], s[26:27], v[22:23]
    v_pk_fma_f32 v[24:25], v[16:17], s[32:33], v[24:25]
    v_pk_fma_f32 v[26:27], v[16:17], s[30:31], v[26:27] neg_lo:[1,0,0] neg_hi:[1,0,0]
    v_pk_add_f32 v[40:41], v[40:41], v[18:19]
    v_pk_add_f32 v[42:43], v[20:21], v[24:25] op_sel:[0,1] op_sel_hi:[1,0] neg_lo:[0,1]
    v_pk_add_f32 v[48:49], v[20:21], v[24:25] op_sel:[0,1] op_sel_hi:[1,0] neg_hi:[0,1]
    v_pk_add_f32 v[44:45], v[22:23], v[26:27] op_sel:[0,1] op_sel_hi:[1,0] neg_lo:[0,1]
    v_pk_add_f32 v[46:47], v[22:23], v[26:27] op_sel:[0,1] op_sel_hi:[1,0] neg_hi:[0,1]
    v_lshlrev_b32 v5, 2, v1
    s_lshr_b32 s40, s39, 1
    s_mul_i32 s40, s40, 2560
    v_cvt_pk_bf16_f32 v96, v30, v31
    v_lshlrev_b32 v100, 16, v100
    v_lshlrev_b32 v101, 16, v101
    v_lshlrev_b32 v30, 16, v96
    v_and_b32 v31, 0xffff0000, v96
    v_pk_add_f32 v[100:101], v[100:101], v[30:31]
    v_cvt_pk_bf16_f32 v30, v100, v101
    v_lshlrev_b32 v100, 16, v30
    v_and_b32 v101, 0xffff0000, v30
    buffer_store_dword v30, v5, s[44:47], s40 offen offset:0 sc1
    v_cvt_pk_bf16_f32 v96, v42, v43
    v_lshlrev_b32 v102, 16, v102
    v_lshlrev_b32 v103, 16, v103
    v_lshlrev_b32 v42, 16, v96
    v_and_b32 v43, 0xffff0000, v96
    v_pk_add_f32 v[102:103], v[102:103], v[42:43]
    v_cvt_pk_bf16_f32 v42, v102, v103
    v_lshlrev_b32 v102, 16, v42
    v_and_b32 v103, 0xffff0000, v42
    buffer_store_dword v42, v5, s[44:47], s40 offen offset:256 sc1
    v_cvt_pk_bf16_f32 v96, v34, v35
    v_lshlrev_b32 v104, 16, v104
    v_lshlrev_b32 v105, 16, v105
    v_lshlrev_b32 v34, 16, v96
    v_and_b32 v35, 0xffff0000, v96
    v_pk_add_f32 v[104:105], v[104:105], v[34:35]
    v_cvt_pk_bf16_f32 v34, v104, v105
    v_lshlrev_b32 v104, 16, v34
    v_and_b32 v105, 0xffff0000, v34
    buffer_store_dword v34, v5, s[44:47], s40 offen offset:512 sc1
    v_cvt_pk_bf16_f32 v96, v46, v47
    v_lshlrev_b32 v106, 16, v106
    v_lshlrev_b32 v107, 16, v107
    v_lshlrev_b32 v46, 16, v96
    v_and_b32 v47, 0xffff0000, v96
    v_pk_add_f32 v[106:107], v[106:107], v[46:47]
    v_cvt_pk_bf16_f32 v46, v106, v107
    v_lshlrev_b32 v106, 16, v46
    v_and_b32 v107, 0xffff0000, v46
    buffer_store_dword v46, v5, s[44:47], s40 offen offset:768 sc1
    v_cvt_pk_bf16_f32 v96, v38, v39
    v_lshlrev_b32 v108, 16, v108
    v_lshlrev_b32 v109, 16, v109
    v_lshlrev_b32 v38, 16, v96
    v_and_b32 v39, 0xffff0000, v96
    v_pk_add_f32 v[108:109], v[108:109], v[38:39]
    v_cvt_pk_bf16_f32 v38, v108, v109
    v_lshlrev_b32 v108, 16, v38
    v_and_b32 v109, 0xffff0000, v38
    buffer_store_dword v38, v5, s[44:47], s40 offen offset:1024 sc1
    v_cvt_pk_bf16_f32 v96, v40, v41
    v_lshlrev_b32 v110, 16, v110
    v_lshlrev_b32 v111, 16, v111
    v_lshlrev_b32 v40, 16, v96
    v_and_b32 v41, 0xffff0000, v96
    v_pk_add_f32 v[110:111], v[110:111], v[40:41]
    v_cvt_pk_bf16_f32 v40, v110, v111
    v_lshlrev_b32 v110, 16, v40
    v_and_b32 v111, 0xffff0000, v40
    buffer_store_dword v40, v5, s[44:47], s40 offen offset:1280 sc1
    v_cvt_pk_bf16_f32 v96, v32, v33
    v_lshlrev_b32 v112, 16, v112
    v_lshlrev_b32 v113, 16, v113
    v_lshlrev_b32 v32, 16, v96
    v_and_b32 v33, 0xffff0000, v96
    v_pk_add_f32 v[112:113], v[112:113], v[32:33]
    v_cvt_pk_bf16_f32 v32, v112, v113
    v_lshlrev_b32 v112, 16, v32
    v_and_b32 v113, 0xffff0000, v32
    buffer_store_dword v32, v5, s[44:47], s40 offen offset:1536 sc1
    v_cvt_pk_bf16_f32 v96, v44, v45
    v_lshlrev_b32 v114, 16, v114
    v_lshlrev_b32 v115, 16, v115
    v_lshlrev_b32 v44, 16, v96
    v_and_b32 v45, 0xffff0000, v96
    v_pk_add_f32 v[114:115], v[114:115], v[44:45]
    v_cvt_pk_bf16_f32 v44, v114, v115
    v_lshlrev_b32 v114, 16, v44
    v_and_b32 v115, 0xffff0000, v44
    buffer_store_dword v44, v5, s[44:47], s40 offen offset:1792 sc1
    v_cvt_pk_bf16_f32 v96, v36, v37
    v_lshlrev_b32 v116, 16, v116
    v_lshlrev_b32 v117, 16, v117
    v_lshlrev_b32 v36, 16, v96
    v_and_b32 v37, 0xffff0000, v96
    v_pk_add_f32 v[116:117], v[116:117], v[36:37]
    v_cvt_pk_bf16_f32 v36, v116, v117
    v_lshlrev_b32 v116, 16, v36
    v_and_b32 v117, 0xffff0000, v36
    buffer_store_dword v36, v5, s[44:47], s40 offen offset:2048 sc1
    v_cvt_pk_bf16_f32 v96, v48, v49
    v_lshlrev_b32 v118, 16, v118
    v_lshlrev_b32 v119, 16, v119
    v_lshlrev_b32 v48, 16, v96
    v_and_b32 v49, 0xffff0000, v96
    v_pk_add_f32 v[118:119], v[118:119], v[48:49]
    v_cvt_pk_bf16_f32 v48, v118, v119
    v_lshlrev_b32 v118, 16, v48
    v_and_b32 v119, 0xffff0000, v48
    buffer_store_dword v48, v5, s[44:47], s40 offen offset:2304 sc1
    v_pk_add_f32 v[82:83], v[100:101], v[102:103]
    v_pk_add_f32 v[82:83], v[82:83], v[104:105]
    v_pk_add_f32 v[82:83], v[82:83], v[106:107]
    v_pk_add_f32 v[82:83], v[82:83], v[108:109]
    v_pk_add_f32 v[82:83], v[82:83], v[110:111]
    v_pk_add_f32 v[82:83], v[82:83], v[112:113]
    v_pk_add_f32 v[82:83], v[82:83], v[114:115]
    v_pk_add_f32 v[82:83], v[82:83], v[116:117]
    v_pk_add_f32 v[82:83], v[82:83], v[118:119]
    s_nop 1
    v_add_f32_dpp v82, v82, v82 quad_perm:[1,0,3,2] row_mask:0xf bank_mask:0xf
    v_add_f32_dpp v83, v83, v83 quad_perm:[1,0,3,2] row_mask:0xf bank_mask:0xf
    s_nop 1
    v_add_f32_dpp v82, v82, v82 quad_perm:[2,3,0,1] row_mask:0xf bank_mask:0xf
    v_add_f32_dpp v83, v83, v83 quad_perm:[2,3,0,1] row_mask:0xf bank_mask:0xf
    s_nop 1
    v_add_f32_dpp v82, v82, v82 row_half_mirror row_mask:0xf bank_mask:0xf
    v_add_f32_dpp v83, v83, v83 row_half_mirror row_mask:0xf bank_mask:0xf
    s_nop 1
    v_add_f32_dpp v82, v82, v82 row_mirror row_mask:0xf bank_mask:0xf
    v_add_f32_dpp v83, v83, v83 row_mirror row_mask:0xf bank_mask:0xf
    v_mov_b32 v94, v82
    v_mov_b32 v95, v83
    s_nop 1
    v_permlane16_swap_b32 v82, v94
    v_permlane16_swap_b32 v83, v95
    s_nop 0
    v_add_f32 v82, v82, v94
    v_add_f32 v83, v83, v95
    v_mov_b32 v94, v82
    v_mov_b32 v95, v83
    s_nop 1
    v_permlane32_swap_b32 v82, v94
    v_permlane32_swap_b32 v83, v95
    s_nop 0
    v_add_f32 v82, v82, v94
    v_add_f32 v83, v83, v95
    v_pk_mul_f32 v[84:85], v[82:83], s[52:53]
    v_pk_fma_f32 v[94:95], v[84:85], s[54:55], v[82:83] neg_lo:[1,0,0] neg_hi:[1,0,0]
    v_pk_fma_f32 v[84:85], v[94:95], s[52:53], v[84:85]
    v_pk_add_f32 v[90:91], v[100:101], v[84:85] neg_lo:[0,1] neg_hi:[0,1]
    v_pk_mul_f32 v[82:83], v[90:91], v[90:91]
    v_pk_add_f32 v[90:91], v[102:103], v[84:85] neg_lo:[0,1] neg_hi:[0,1]
    v_pk_fma_f32 v[82:83], v[90:91], v[90:91], v[82:83]
    v_pk_add_f32 v[90:91], v[104:105], v[84:85] neg_lo:[0,1] neg_hi:[0,1]
    v_pk_fma_f32 v[82:83], v[90:91], v[90:91], v[82:83]
    v_pk_add_f32 v[90:91], v[106:107], v[84:85] neg_lo:[0,1] neg_hi:[0,1]
    v_pk_fma_f32 v[82:83], v[90:91], v[90:91], v[82:83]
    v_pk_add_f32 v[90:91], v[108:109], v[84:85] neg_lo:[0,1] neg_hi:[0,1]
    v_pk_fma_f32 v[82:83], v[90:91], v[90:91], v[82:83]
    v_pk_add_f32 v[90:91], v[110:111], v[84:85] neg_lo:[0,1] neg_hi:[0,1]
    v_pk_fma_f32 v[82:83], v[90:91], v[90:91], v[82:83]
    v_pk_add_f32 v[90:91], v[112:113], v[84:85] neg_lo:[0,1] neg_hi:[0,1]
    v_pk_fma_f32 v[82:83], v[90:91], v[90:91], v[82:83]
    v_pk_add_f32 v[90:91], v[114:115], v[84:85] neg_lo:[0,1] neg_hi:[0,1]
    v_pk_fma_f32 v[82:83], v[90:91], v[90:91], v[82:83]
    v_pk_add_f32 v[90:91], v[116:117], v[84:85] neg_lo:[0,1] neg_hi:[0,1]
    v_pk_fma_f32 v[82:83], v[90:91], v[90:91], v[82:83]
    v_pk_add_f32 v[90:91], v[118:119], v[84:85] neg_lo:[0,1] neg_hi:[0,1]
    v_pk_fma_f32 v[82:83], v[90:91], v[90:91], v[82:83]
    s_nop 1
    v_add_f32_dpp v82, v82, v82 quad_perm:[1,0,3,2] row_mask:0xf bank_mask:0xf
    v_add_f32_dpp v83, v83, v83 quad_perm:[1,0,3,2] row_mask:0xf bank_mask:0xf
    s_nop 1
    v_add_f32_dpp v82, v82, v82 quad_perm:[2,3,0,1] row_mask:0xf bank_mask:0xf
    v_add_f32_dpp v83, v83, v83 quad_perm:[2,3,0,1] row_mask:0xf bank_mask:0xf
    s_nop 1
    v_add_f32_dpp v82, v82, v82 row_half_mirror row_mask:0xf bank_mask:0xf
    v_add_f32_dpp v83, v83, v83 row_half_mirror row_mask:0xf bank_mask:0xf
    s_nop 1
    v_add_f32_dpp v82, v82, v82 row_mirror row_mask:0xf bank_mask:0xf
    v_add_f32_dpp v83, v83, v83 row_mirror row_mask:0xf bank_mask:0xf
    v_mov_b32 v94, v82
    v_mov_b32 v95, v83
    s_nop 1
    v_permlane16_swap_b32 v82, v94
    v_permlane16_swap_b32 v83, v95
    s_nop 0
    v_add_f32 v82, v82, v94
    v_add_f32 v83, v83, v95
    v_mov_b32 v94, v82
    v_mov_b32 v95, v83
    s_nop 1
    v_permlane32_swap_b32 v82, v94
    v_permlane32_swap_b32 v83, v95
    s_nop 0
    v_add_f32 v82, v82, v94
    v_add_f32 v83, v83, v95
    v_pk_mul_f32 v[86:87], v[82:83], s[52:53]
    v_pk_fma_f32 v[94:95], v[86:87], s[54:55], v[82:83] neg_lo:[1,0,0] neg_hi:[1,0,0]
    v_pk_fma_f32 v[86:87], v[94:95], s[52:53], v[86:87]
    v_cvt_pk_bf16_f32 v96, v84, v85
    v_lshlrev_b32 v84, 16, v96
    v_and_b32 v85, 0xffff0000, v96
    v_cvt_pk_bf16_f32 v96, v86, v87
    v_lshlrev_b32 v86, 16, v96
    v_and_b32 v87, 0xffff0000, v96
    v_pk_add_f32 v[86:87], v[86:87], s[56:57]
    v_cvt_pk_bf16_f32 v96, v86, v87
    v_lshlrev_b32 v86, 16, v96
    v_and_b32 v87, 0xffff0000, v96
    v_sqrt_f32 v86, v86
    v_sqrt_f32 v87, v87
    s_nop 0
    v_cvt_pk_bf16_f32 v96, v86, v87
    v_lshlrev_b32 v86, 16, v96
    v_and_b32 v87, 0xffff0000, v96
    v_rcp_f32 v88, v86
    v_rcp_f32 v89, v87
    s_nop 0
    v_pk_add_f32 v[90:91], v[100:101], v[84:85] neg_lo:[0,1] neg_hi:[0,1]
    v_cvt_pk_bf16_f32 v96, v90, v91
    v_lshlrev_b32 v90, 16, v96
    v_and_b32 v91, 0xffff0000, v96
    v_pk_mul_f32 v[92:93], v[90:91], v[88:89]
    v_pk_fma_f32 v[90:91], v[92:93], v[86:87], v[90:91] neg_lo:[1,0,0] neg_hi:[1,0,0]
    v_pk_fma_f32 v[92:93], v[90:91], v[88:89], v[92:93]
    v_cvt_pk_bf16_f32 v100, v92, v93
    v_pk_add_f32 v[90:91], v[102:103], v[84:85] neg_lo:[0,1] neg_hi:[0,1]
    v_cvt_pk_bf16_f32 v96, v90, v91
    v_lshlrev_b32 v90, 16, v96
    v_and_b32 v91, 0xffff0000, v96
    v_pk_mul_f32 v[92:93], v[90:91], v[88:89]
    v_pk_fma_f32 v[90:91], v[92:93], v[86:87], v[90:91] neg_lo:[1,0,0] neg_hi:[1,0,0]
    v_pk_fma_f32 v[92:93], v[90:91], v[88:89], v[92:93]
    v_cvt_pk_bf16_f32 v102, v92, v93
    v_pk_add_f32 v[90:91], v[104:105], v[84:85] neg_lo:[0,1] neg_hi:[0,1]
    v_cvt_pk_bf16_f32 v96, v90, v91
    v_lshlrev_b32 v90, 16, v96
    v_and_b32 v91, 0xffff0000, v96
    v_pk_mul_f32 v[92:93], v[90:91], v[88:89]
    v_pk_fma_f32 v[90:91], v[92:93], v[86:87], v[90:91] neg_lo:[1,0,0] neg_hi:[1,0,0]
    v_pk_fma_f32 v[92:93], v[90:91], v[88:89], v[92:93]
    v_cvt_pk_bf16_f32 v104, v92, v93
    v_pk_add_f32 v[90:91], v[106:107], v[84:85] neg_lo:[0,1] neg_hi:[0,1]
    v_cvt_pk_bf16_f32 v96, v90, v91
    v_lshlrev_b32 v90, 16, v96
    v_and_b32 v91, 0xffff0000, v96
    v_pk_mul_f32 v[92:93], v[90:91], v[88:89]
    v_pk_fma_f32 v[90:91], v[92:93], v[86:87], v[90:91] neg_lo:[1,0,0] neg_hi:[1,0,0]
    v_pk_fma_f32 v[92:93], v[90:91], v[88:89], v[92:93]
    v_cvt_pk_bf16_f32 v106, v92, v93
    v_pk_add_f32 v[90:91], v[108:109], v[84:85] neg_lo:[0,1] neg_hi:[0,1]
    v_cvt_pk_bf16_f32 v96, v90, v91
    v_lshlrev_b32 v90, 16, v96
    v_and_b32 v91, 0xffff0000, v96
    v_pk_mul_f32 v[92:93], v[90:91], v[88:89]
    v_pk_fma_f32 v[90:91], v[92:93], v[86:87], v[90:91] neg_lo:[1,0,0] neg_hi:[1,0,0]
    v_pk_fma_f32 v[92:93], v[90:91], v[88:89], v[92:93]
    v_cvt_pk_bf16_f32 v108, v92, v93
    v_pk_add_f32 v[90:91], v[110:111], v[84:85] neg_lo:[0,1] neg_hi:[0,1]
    v_cvt_pk_bf16_f32 v96, v90, v91
    v_lshlrev_b32 v90, 16, v96
    v_and_b32 v91, 0xffff0000, v96
    v_pk_mul_f32 v[92:93], v[90:91], v[88:89]
    v_pk_fma_f32 v[90:91], v[92:93], v[86:87], v[90:91] neg_lo:[1,0,0] neg_hi:[1,0,0]
    v_pk_fma_f32 v[92:93], v[90:91], v[88:89], v[92:93]
    v_cvt_pk_bf16_f32 v110, v92, v93
    v_pk_add_f32 v[90:91], v[112:113], v[84:85] neg_lo:[0,1] neg_hi:[0,1]
    v_cvt_pk_bf16_f32 v96, v90, v91
    v_lshlrev_b32 v90, 16, v96
    v_and_b32 v91, 0xffff0000, v96
    v_pk_mul_f32 v[92:93], v[90:91], v[88:89]
    v_pk_fma_f32 v[90:91], v[92:93], v[86:87], v[90:91] neg_lo:[1,0,0] neg_hi:[1,0,0]
    v_pk_fma_f32 v[92:93], v[90:91], v[88:89], v[92:93]
    v_cvt_pk_bf16_f32 v112, v92, v93
    v_pk_add_f32 v[90:91], v[114:115], v[84:85] neg_lo:[0,1] neg_hi:[0,1]
    v_cvt_pk_bf16_f32 v96, v90, v91
    v_lshlrev_b32 v90, 16, v96
    v_and_b32 v91, 0xffff0000, v96
    v_pk_mul_f32 v[92:93], v[90:91], v[88:89]
    v_pk_fma_f32 v[90:91], v[92:93], v[86:87], v[90:91] neg_lo:[1,0,0] neg_hi:[1,0,0]
    v_pk_fma_f32 v[92:93], v[90:91], v[88:89], v[92:93]
    v_cvt_pk_bf16_f32 v114, v92, v93
    v_pk_add_f32 v[90:91], v[116:117], v[84:85] neg_lo:[0,1] neg_hi:[0,1]
    v_cvt_pk_bf16_f32 v96, v90, v91
    v_lshlrev_b32 v90, 16, v96
    v_and_b32 v91, 0xffff0000, v96
    v_pk_mul_f32 v[92:93], v[90:91], v[88:89]
    v_pk_fma_f32 v[90:91], v[92:93], v[86:87], v[90:91] neg_lo:[1,0,0] neg_hi:[1,0,0]
    v_pk_fma_f32 v[92:93], v[90:91], v[88:89], v[92:93]
    v_cvt_pk_bf16_f32 v116, v92, v93
    v_pk_add_f32 v[90:91], v[118:119], v[84:85] neg_lo:[0,1] neg_hi:[0,1]
    v_cvt_pk_bf16_f32 v96, v90, v91
    v_lshlrev_b32 v90, 16, v96
    v_and_b32 v91, 0xffff0000, v96
    v_pk_mul_f32 v[92:93], v[90:91], v[88:89]
    v_pk_fma_f32 v[90:91], v[92:93], v[86:87], v[90:91] neg_lo:[1,0,0] neg_hi:[1,0,0]
    v_pk_fma_f32 v[92:93], v[90:91], v[88:89], v[92:93]
    v_cvt_pk_bf16_f32 v118, v92, v93
    v_lshrrev_b32 v6, 4, v1
    v_lshlrev_b32 v6, 10, v6
    v_lshrrev_b32 v7, 3, v1
    v_and_b32 v7, 1, v7
    v_lshl_add_u32 v6, v7, 9, v6
    v_and_b32 v7, 7, v1
    v_lshl_add_u32 v6, v7, 1, v6
    s_lshr_b32 s40, s39, 5
    s_mul_i32 s40, s40, 40960
    s_and_b32 s41, s39, 31
    s_lshl_b32 s41, s41, 4
    s_add_u32 s40, s40, s41
    buffer_store_short v100, v6, s[48:51], s40 offen
    buffer_store_short_d16_hi v100, v6, s[48:51], s40 offen offset:16
    s_add_u32 s40, s40, 4096
    buffer_store_short v102, v6, s[48:51], s40 offen
    buffer_store_short_d16_hi v102, v6, s[48:51], s40 offen offset:16
    s_add_u32 s40, s40, 4096
    buffer_store_short v104, v6, s[48:51], s40 offen
    buffer_store_short_d16_hi v104, v6, s[48:51], s40 offen offset:16
    s_add_u32 s40, s40, 4096
    buffer_store_short v106, v6, s[48:51], s40 offen
    buffer_store_short_d16_hi v106, v6, s[48:51], s40 offen offset:16
    s_add_u32 s40, s40, 4096
    buffer_store_short v108, v6, s[48:51], s40 offen
    buffer_store_short_d16_hi v108, v6, s[48:51], s40 offen offset:16
    s_add_u32 s40, s40, 4096
    buffer_store_short v110, v6, s[48:51], s40 offen
    buffer_store_short_d16_hi v110, v6, s[48:51], s40 offen offset:16
    s_add_u32 s40, s40, 4096
    buffer_store_short v112, v6, s[48:51], s40 offen
    buffer_store_short_d16_hi v112, v6, s[48:51], s40 offen offset:16
    s_add_u32 s40, s40, 4096
    buffer_store_short v114, v6, s[48:51], s40 offen
    buffer_store_short_d16_hi v114, v6, s[48:51], s40 offen offset:16
    s_add_u32 s40, s40, 4096
    buffer_store_short v116, v6, s[48:51], s40 offen
    buffer_store_short_d16_hi v116, v6, s[48:51], s40 offen offset:16
    s_add_u32 s40, s40, 4096
    buffer_store_short v118, v6, s[48:51], s40 offen
    buffer_store_short_d16_hi v118, v6, s[48:51], s40 offen offset:16
K3_end:
    s_endpgm
.p2align 8
.globl k4_kernel
.type k4_kernel,@function
k4_kernel:
    s_load_dwordx2 s[4:5], s[0:1], 40
    s_load_dwordx2 s[6:7], s[0:1], 80
    v_lshrrev_b32 v2, 6, v0
    v_and_b32 v1, 63, v0
    s_nop 0
    v_readfirstlane_b32 s3, v2
    s_waitcnt lgkmcnt(0)
    s_cmp_ge_u32 s2, 256
    s_cbranch_scc1 K4_end
    s_add_u32 s12, s6, 0xd00000
    s_addc_u32 s13, s7, 0
    s_and_b32 s13, s13, 0xffff
    s_mov_b32 s14, 0x280000
    s_mov_b32 s15, 0x20000
    s_add_u32 s16, s6, 0x1800000
    s_addc_u32 s17, s7, 0
    s_and_b32 s17, s17, 0xffff
    s_mov_b32 s18, 0x1e0000
    s_mov_b32 s19, 0x20000
    s_and_b32 s8, s2, 3
    s_lshl_b32 s8, s8, 2
    s_lshr_b32 s9, s2, 3
    s_and_b32 s10, s9, 3
    s_add_u32 s8, s8, s10
    s_lshr_b32 s9, s9, 2
    s_lshr_b32 s10, s2, 2
    s_and_b32 s10, s10, 1
    s_lshl_b32 s10, s10, 3
    s_add_u32 s9, s9, s10
    s_lshl_b32 s8, s8, 2
    s_add_u32 s8, s8, s3
    s_mul_i32 s10, s8, 40960
    s_mul_i32 s11, s9, 122880
    s_lshl_b32 s28, s3, 11
    v_lshlrev_b32 v2, 4, v1
    s_add_u32 s29, s28, 0
    s_add_u32 s30, s29, s11
    s_mov_b32 m0, s29
    s_nop 0
    buffer_load_dwordx4 v2, s[16:19], s30 offen lds
    buffer_load_dwordx4 v2, s[16:19], s30 offen offset:1024 lds
    s_add_u32 s29, s28, 40960
    s_add_u32 s30, s29, s11
    s_mov_b32 m0, s29
    s_nop 0
    buffer_load_dwordx4 v2, s[16:19], s30 offen lds
    buffer_load_dwordx4 v2, s[16:19], s30 offen offset:1024 lds
    s_add_u32 s29, s28, 81920
    s_add_u32 s30, s29, s11
    s_mov_b32 m0, s29
    s_nop 0
    buffer_load_dwordx4 v2, s[16:19], s30 offen lds
    buffer_load_dwordx4 v2, s[16:19], s30 offen offset:1024 lds
    s_add_u32 s31, s10, 0
    buffer_load_dwordx4 v[64:67], v2, s[12:15], s31 offen offset:0
    buffer_load_dwordx4 v[68:71], v2, s[12:15], s31 offen offset:1024
    buffer_load_dwordx4 v[72:75], v2, s[12:15], s31 offen offset:2048
    buffer_load_dwordx4 v[76:79], v2, s[12:15], s31 offen offset:3072
    s_add_u32 s31, s10, 4096
    buffer_load_dwordx4 v[80:83], v2, s[12:15], s31 offen offset:0
    buffer_load_dwordx4 v[84:87], v2, s[12:15], s31 offen offset:1024
    buffer_load_dwordx4 v[88:91], v2, s[12:15], s31 offen offset:2048
    buffer_load_dwordx4 v[92:95], v2, s[12:15], s31 offen offset:3072
    s_add_u32 s29, s28, 8192
    s_add_u32 s30, s29, s11
    s_mov_b32 m0, s29
    s_nop 0
    buffer_load_dwordx4 v2, s[16:19], s30 offen lds
    buffer_load_dwordx4 v2, s[16:19], s30 offen offset:1024 lds
    s_add_u32 s29, s28, 49152
    s_add_u32 s30, s29, s11
    s_mov_b32 m0, s29
    s_nop 0
    buffer_load_dwordx4 v2, s[16:19], s30 offen lds
    buffer_load_dwordx4 v2, s[16:19], s30 offen offset:1024 lds
    s_add_u32 s29, s28, 90112
    s_add_u32 s30, s29, s11
    s_mov_b32 m0, s29
    s_nop 0
    buffer_load_dwordx4 v2, s[16:19], s30 offen lds
    buffer_load_dwordx4 v2, s[16:19], s30 offen offset:1024 lds
    s_add_u32 s31, s10, 8192
    buffer_load_dwordx4 v[96:99], v2, s[12:15], s31 offen offset:0
    buffer_load_dwordx4 v[100:103], v2, s[12:15], s31 offen offset:1024
    buffer_load_dwordx4 v[104:107], v2, s[12:15], s31 offen offset:2048
    buffer_load_dwordx4 v[108:111], v2, s[12:15], s31 offen offset:3072
    s_add_u32 s31, s10, 12288
    buffer_load_dwordx4 v[112:115], v2, s[12:15], s31 offen offset:0
    buffer_load_dwordx4 v[116:119], v2, s[12:15], s31 offen offset:1024
    buffer_load_dwordx4 v[120:123], v2, s[12:15], s31 offen offset:2048
    buffer_load_dwordx4 v[124:127], v2, s[12:15], s31 offen offset:3072
    s_add_u32 s20, s6, 0x1000000
    s_addc_u32 s21, s7, 0
    s_and_b32 s21, s21, 0xffff
    s_mov_b32 s22, 0x600000
    s_mov_b32 s23, 0x20000
    s_add_u32 s24, s4, 0x0
    s_addc_u32 s25, s5, 0
    s_and_b32 s25, s25, 0xffff
    s_mov_b32 s26, 0xc00
    s_mov_b32 s27, 0x20000
    v_add_u32 v3, 40960, v2
    v_add_u32 v4, 81920, v2
    v_mov_b32 v16, 0
    v_mov_b32 v17, 0
    v_mov_b32 v18, 0
    v_mov_b32 v19, 0
    v_mov_b32 v20, 0
    v_mov_b32 v21, 0
    v_mov_b32 v22, 0
    v_mov_b32 v23, 0
    v_mov_b32 v24, 0
    v_mov_b32 v25, 0
    v_mov_b32 v26, 0
    v_mov_b32 v27, 0
    v_mov_b32 v28, 0
    v_mov_b32 v29, 0
    v_mov_b32 v30, 0
    v_mov_b32 v31, 0
    v_mov_b32 v32, 0
    v_mov_b32 v33, 0
    v_mov_b32 v34, 0
    v_mov_b32 v35, 0
    v_mov_b32 v36, 0
    v_mov_b32 v37, 0
    v_mov_b32 v38, 0
    v_mov_b32 v39, 0
    v_mov_b32 v40, 0
    v_mov_b32 v41, 0
    v_mov_b32 v42, 0
    v_mov_b32 v43, 0
    v_mov_b32 v44, 0
    v_mov_b32 v45, 0
    v_mov_b32 v46, 0
    v_mov_b32 v47, 0
    v_mov_b32 v48, 0
    v_mov_b32 v49, 0
    v_mov_b32 v50, 0
    v_mov_b32 v51, 0
    v_mov_b32 v52, 0
    v_mov_b32 v53, 0
    v_mov_b32 v54, 0
    v_mov_b32 v55, 0
    v_mov_b32 v56, 0
    v_mov_b32 v57, 0
    v_mov_b32 v58, 0
    v_mov_b32 v59, 0
    v_mov_b32 v60, 0
    v_mov_b32 v61, 0
    v_mov_b32 v62, 0
    v_mov_b32 v63, 0
    s_waitcnt vmcnt(14)
    s_barrier
    ds_read_b128 v[224:227], v2 offset:0
    ds_read_b128 v[228:231], v3 offset:0
    ds_read_b128 v[232:235], v4 offset:0
    ds_read_b128 v[236:239], v2 offset:1024
    ds_read_b128 v[240:243], v3 offset:1024
    ds_read_b128 v[244:247], v4 offset:1024
    s_waitcnt lgkmcnt(3)
    v_mfma_f32_32x32x16_bf16 v[16:31], v[224:227], v[64:67], v[16:31]
    s_add_u32 s29, s28, 16384
    s_add_u32 s30, s29, s11
    s_mov_b32 m0, s29
    s_nop 0
    buffer_load_dwordx4 v2, s[16:19], s30 offen lds
    v_mfma_f32_32x32x16_bf16 v[32:47], v[228:231], v[64:67], v[32:47]
    buffer_load_dwordx4 v2, s[16:19], s30 offen offset:1024 lds
    v_mfma_f32_32x32x16_bf16 v[48:63], v[232:235], v[64:67], v[48:63]
    ds_read_b128 v[224:227], v2 offset:2048
    ds_read_b128 v[228:231], v3 offset:2048
    ds_read_b128 v[232:235], v4 offset:2048
    s_waitcnt lgkmcnt(3)
    v_mfma_f32_32x32x16_bf16 v[16:31], v[236:239], v[68:71], v[16:31]
    s_add_u32 s29, s28, 57344
    s_add_u32 s30, s29, s11
    s_mov_b32 m0, s29
    s_nop 0
    buffer_load_dwordx4 v2, s[16:19], s30 offen lds
    v_mfma_f32_32x32x16_bf16 v[32:47], v[240:243], v[68:71], v[32:47]
    buffer_load_dwordx4 v2, s[16:19], s30 offen offset:1024 lds
    v_mfma_f32_32x32x16_bf16 v[48:63], v[244:247], v[68:71], v[48:63]
    ds_read_b128 v[236:239], v2 offset:3072
    ds_read_b128 v[240:243], v3 offset:3072
    ds_read_b128 v[244:247], v4 offset:3072
    s_waitcnt lgkmcnt(3)
    v_mfma_f32_32x32x16_bf16 v[16:31], v[224:227], v[72:75], v[16:31]
    s_add_u32 s29, s28, 98304
    s_add_u32 s30, s29, s11
    s_mov_b32 m0, s29
    s_nop 0
    buffer_load_dwordx4 v2, s[16:19], s30 offen lds
    v_mfma_f32_32x32x16_bf16 v[32:47], v[228:231], v[72:75], v[32:47]
    buffer_load_dwordx4 v2, s[16:19], s30 offen offset:1024 lds
    v_mfma_f32_32x32x16_bf16 v[48:63], v[232:235], v[72:75], v[48:63]
    ds_read_b128 v[224:227], v2 offset:4096
    ds_read_b128 v[228:231], v3 offset:4096
    ds_read_b128 v[232:235], v4 offset:4096
    s_waitcnt lgkmcnt(3)
    v_mfma_f32_32x32x16_bf16 v[16:31], v[236:239], v[76:79], v[16:31]
    s_add_u32 s31, s10, 16384
    buffer_load_dwordx4 v[128:131], v2, s[12:15], s31 offen offset:0
    v_mfma_f32_32x32x16_bf16 v[32:47], v[240:243], v[76:79], v[32:47]
    buffer_load_dwordx4 v[132:135], v2, s[12:15], s31 offen offset:1024
    v_mfma_f32_32x32x16_bf16 v[48:63], v[244:247], v[76:79], v[48:63]
    ds_read_b128 v[236:239], v2 offset:5120
    ds_read_b128 v[240:243], v3 offset:5120
    ds_read_b128 v[244:247], v4 offset:5120
    s_waitcnt lgkmcnt(3)
    v_mfma_f32_32x32x16_bf16 v[16:31], v[224:227], v[80:83], v[16:31]
    buffer_load_dwordx4 v[136:139], v2, s[12:15], s31 offen offset:2048
    v_mfma_f32_32x32x16_bf16 v[32:47], v[228:231], v[80:83], v[32:47]
    buffer_load_dwordx4 v[140:143], v2, s[12:15], s31 offen offset:3072
    v_mfma_f32_32x32x16_bf16 v[48:63], v[232:235], v[80:83], v[48:63]
    ds_read_b128 v[224:227], v2 offset:6144
    ds_read_b128 v[228:231], v3 offset:6144
    ds_read_b128 v[232:235], v4 offset:6144
    s_waitcnt lgkmcnt(3)
    v_mfma_f32_32x32x16_bf16 v[16:31], v[236:239], v[84:87], v[16:31]
    s_add_u32 s31, s10, 20480
    buffer_load_dwordx4 v[144:147], v2, s[12:15], s31 offen offset:0
    v_mfma_f32_32x32x16_bf16 v[32:47], v[240:243], v[84:87], v[32:47]
    buffer_load_dwordx4 v[148:151], v2, s[12:15], s31 offen offset:1024
    v_mfma_f32_32x32x16_bf16 v[48:63], v[244:247], v[84:87], v[48:63]
    ds_read_b128 v[236:239], v2 offset:7168
    ds_read_b128 v[240:243], v3 offset:7168
    ds_read_b128 v[244:247], v4 offset:7168
    s_waitcnt lgkmcnt(3)
    v_mfma_f32_32x32x16_bf16 v[16:31], v[224:227], v[88:91], v[16:31]
    buffer_load_dwordx4 v[152:155], v2, s[12:15], s31 offen offset:2048
    v_mfma_f32_32x32x16_bf16 v[32:47], v[228:231], v[88:91], v[32:47]
    buffer_load_dwordx4 v[156:159], v2, s[12:15], s31 offen offset:3072
    v_mfma_f32_32x32x16_bf16 v[48:63], v[232:235], v[88:91], v[48:63]
    s_waitcnt lgkmcnt(0)
    v_mfma_f32_32x32x16_bf16 v[16:31], v[236:239], v[92:95], v[16:31]
    v_mfma_f32_32x32x16_bf16 v[32:47], v[240:243], v[92:95], v[32:47]
    v_mfma_f32_32x32x16_bf16 v[48:63], v[244:247], v[92:95], v[48:63]
    s_waitcnt vmcnt(14)
    s_barrier
    ds_read_b128 v[224:227], v2 offset:8192
    ds_read_b128 v[228:231], v3 offset:8192
    ds_read_b128 v[232:235], v4 offset:8192
    ds_read_b128 v[236:239], v2 offset:9216
    ds_read_b128 v[240:243], v3 offset:9216
    ds_read_b128 v[244:247], v4 offset:9216
    s_waitcnt lgkmcnt(3)
    v_mfma_f32_32x32x16_bf16 v[16:31], v[224:227], v[96:99], v[16:31]
    s_add_u32 s29, s28, 24576
    s_add_u32 s30, s29, s11
    s_mov_b32 m0, s29
    s_nop 0
    buffer_load_dwordx4 v2, s[16:19], s30 offen lds
    v_mfma_f32_32x32x16_bf16 v[32:47], v[228:231], v[96:99], v[32:47]
    buffer_load_dwordx4 v2, s[16:19], s30 offen offset:1024 lds
    v_mfma_f32_32x32x16_bf16 v[48:63], v[232:235], v[96:99], v[48:63]
    ds_read_b128 v[224:227], v2 offset:10240
    ds_read_b128 v[228:231], v3 offset:10240
    ds_read_b128 v[232:235], v4 offset:10240
    s_waitcnt lgkmcnt(3)
    v_mfma_f32_32x32x16_bf16 v[16:31], v[236:239], v[100:103], v[16:31]
    s_add_u32 s29, s28, 65536
    s_add_u32 s30, s29, s11
    s_mov_b32 m0, s29
    s_nop 0
    buffer_load_dwordx4 v2, s[16:19], s30 offen lds
    v_mfma_f32_32x32x16_bf16 v[32:47], v[240:243], v[100:103], v[32:47]
    buffer_load_dwordx4 v2, s[16:19], s30 offen offset:1024 lds
    v_mfma_f32_32x32x16_bf16 v[48:63], v[244:247], v[100:103], v[48:63]
    ds_read_b128 v[236:239], v2 offset:11264
    ds_read_b128 v[240:243], v3 offset:11264
    ds_read_b128 v[244:247], v4 offset:11264
    s_waitcnt lgkmcnt(3)
    v_mfma_f32_32x32x16_bf16 v[16:31], v[224:227], v[104:107], v[16:31]
    s_add_u32 s29, s28, 106496
    s_add_u32 s30, s29, s11
    s_mov_b32 m0, s29
    s_nop 0
    buffer_load_dwordx4 v2, s[16:19], s30 offen lds
    v_mfma_f32_32x32x16_bf16 v[32:47], v[228:231], v[104:107], v[32:47]
    buffer_load_dwordx4 v2, s[16:19], s30 offen offset:1024 lds
    v_mfma_f32_32x32x16_bf16 v[48:63], v[232:235], v[104:107], v[48:63]
    ds_read_b128 v[224:227], v2 offset:12288
    ds_read_b128 v[228:231], v3 offset:12288
    ds_read_b128 v[232:235], v4 offset:12288
    s_waitcnt lgkmcnt(3)
    v_mfma_f32_32x32x16_bf16 v[16:31], v[236:239], v[108:111], v[16:31]
    s_add_u32 s31, s10, 24576
    buffer_load_dwordx4 v[160:163], v2, s[12:15], s31 offen offset:0
    v_mfma_f32_32x32x16_bf16 v[32:47], v[240:243], v[108:111], v[32:47]
    buffer_load_dwordx4 v[164:167], v2, s[12:15], s31 offen offset:1024
    v_mfma_f32_32x32x16_bf16 v[48:63], v[244:247], v[108:111], v[48:63]
    ds_read_b128 v[236:239], v2 offset:13312
    ds_read_b128 v[240:243], v3 offset:13312
    ds_read_b128 v[244:247], v4 offset:13312
    s_waitcnt lgkmcnt(3)
    v_mfma_f32_32x32x16_bf16 v[16:31], v[224:227], v[112:115], v[16:31]
    buffer_load_dwordx4 v[168:171], v2, s[12:15], s31 offen offset:2048
    v_mfma_f32_32x32x16_bf16 v[32:47], v[228:231], v[112:115], v[32:47]
    buffer_load_dwordx4 v[172:175], v2, s[12:15], s31 offen offset:3072
    v_mfma_f32_32x32x16_bf16 v[48:63], v[232:235], v[112:115], v[48:63]
    ds_read_b128 v[224:227], v2 offset:14336
    ds_read_b128 v[228:231], v3 offset:14336
    ds_read_b128 v[232:235], v4 offset:14336
    s_waitcnt lgkmcnt(3)
    v_mfma_f32_32x32x16_bf16 v[16:31], v[236:239], v[116:119], v[16:31]
    s_add_u32 s31, s10, 28672
    buffer_load_dwordx4 v[176:179], v2, s[12:15], s31 offen offset:0
    v_mfma_f32_32x32x16_bf16 v[32:47], v[240:243], v[116:119], v[32:47]
    buffer_load_dwordx4 v[180:183], v2, s[12:15], s31 offen offset:1024
    v_mfma_f32_32x32x16_bf16 v[48:63], v[244:247], v[116:119], v[48:63]
    ds_read_b128 v[236:239], v2 offset:15360
    ds_read_b128 v[240:243], v3 offset:15360
    ds_read_b128 v[244:247], v4 offset:15360
    s_waitcnt lgkmcnt(3)
    v_mfma_f32_32x32x16_bf16 v[16:31], v[224:227], v[120:123], v[16:31]
    buffer_load_dwordx4 v[184:187], v2, s[12:15], s31 offen offset:2048
    v_mfma_f32_32x32x16_bf16 v[32:47], v[228:231], v[120:123], v[32:47]
    buffer_load_dwordx4 v[188:191], v2, s[12:15], s31 offen offset:3072
    v_mfma_f32_32x32x16_bf16 v[48:63], v[232:235], v[120:123], v[48:63]
    s_waitcnt lgkmcnt(0)
    v_mfma_f32_32x32x16_bf16 v[16:31], v[236:239], v[124:127], v[16:31]
    v_mfma_f32_32x32x16_bf16 v[32:47], v[240:243], v[124:127], v[32:47]
    v_mfma_f32_32x32x16_bf16 v[48:63], v[244:247], v[124:127], v[48:63]
    s_waitcnt vmcnt(14)
    s_barrier
    ds_read_b128 v[224:227], v2 offset:16384
    ds_read_b128 v[228:231], v3 offset:16384
    ds_read_b128 v[232:235], v4 offset:16384
    ds_read_b128 v[236:239], v2 offset:17408
    ds_read_b128 v[240:243], v3 offset:17408
    ds_read_b128 v[244:247], v4 offset:17408
    s_waitcnt lgkmcnt(3)
    v_mfma_f32_32x32x16_bf16 v[16:31], v[224:227], v[128:131], v[16:31]
    s_add_u32 s29, s28, 32768
    s_add_u32 s30, s29, s11
    s_mov_b32 m0, s29
    s_nop 0
    buffer_load_dwordx4 v2, s[16:19], s30 offen lds
    v_mfma_f32_32x32x16_bf16 v[32:47], v[228:231], v[128:131], v[32:47]
    buffer_load_dwordx4 v2, s[16:19], s30 offen offset:1024 lds
    v_mfma_f32_32x32x16_bf16 v[48:63], v[232:235], v[128:131], v[48:63]
    ds_read_b128 v[224:227], v2 offset:18432
    ds_read_b128 v[228:231], v3 offset:18432
    ds_read_b128 v[232:235], v4 offset:18432
    s_waitcnt lgkmcnt(3)
    v_mfma_f32_32x32x16_bf16 v[16:31], v[236:239], v[132:135], v[16:31]
    s_add_u32 s29, s28, 73728
    s_add_u32 s30, s29, s11
    s_mov_b32 m0, s29
    s_nop 0
    buffer_load_dwordx4 v2, s[16:19], s30 offen lds
    v_mfma_f32_32x32x16_bf16 v[32:47], v[240:243], v[132:135], v[32:47]
    buffer_load_dwordx4 v2, s[16:19], s30 offen offset:1024 lds
    v_mfma_f32_32x32x16_bf16 v[48:63], v[244:247], v[132:135], v[48:63]
    ds_read_b128 v[236:239], v2 offset:19456
    ds_read_b128 v[240:243], v3 offset:19456
    ds_read_b128 v[244:247], v4 offset:19456
    s_waitcnt lgkmcnt(3)
    v_mfma_f32_32x32x16_bf16 v[16:31], v[224:227], v[136:139], v[16:31]
    s_add_u32 s29, s28, 114688
    s_add_u32 s30, s29, s11
    s_mov_b32 m0, s29
    s_nop 0
    buffer_load_dwordx4 v2, s[16:19], s30 offen lds
    v_mfma_f32_32x32x16_bf16 v[32:47], v[228:231], v[136:139], v[32:47]
    buffer_load_dwordx4 v2, s[16:19], s30 offen offset:1024 lds
    v_mfma_f32_32x32x16_bf16 v[48:63], v[232:235], v[136:139], v[48:63]
    ds_read_b128 v[224:227], v2 offset:20480
    ds_read_b128 v[228:231], v3 offset:20480
    ds_read_b128 v[232:235], v4 offset:20480
    s_waitcnt lgkmcnt(3)
    v_mfma_f32_32x32x16_bf16 v[16:31], v[236:239], v[140:143], v[16:31]
    s_add_u32 s31, s10, 32768
    buffer_load_dwordx4 v[192:195], v2, s[12:15], s31 offen offset:0
    v_mfma_f32_32x32x16_bf16 v[32:47], v[240:243], v[140:143], v[32:47]
    buffer_load_dwordx4 v[196:199], v2, s[12:15], s31 offen offset:1024
    v_mfma_f32_32x32x16_bf16 v[48:63], v[244:247], v[140:143], v[48:63]
    ds_read_b128 v[236:239], v2 offset:21504
    ds_read_b128 v[240:243], v3 offset:21504
    ds_read_b128 v[244:247], v4 offset:21504
    s_waitcnt lgkmcnt(3)
    v_mfma_f32_32x32x16_bf16 v[16:31], v[224:227], v[144:147], v[16:31]
    buffer_load_dwordx4 v[200:203], v2, s[12:15], s31 offen offset:2048
    v_mfma_f32_32x32x16_bf16 v[32:47], v[228:231], v[144:147], v[32:47]
    buffer_load_dwordx4 v[204:207], v2, s[12:15], s31 offen offset:3072
    v_mfma_f32_32x32x16_bf16 v[48:63], v[232:235], v[144:147], v[48:63]
    ds_read_b128 v[224:227], v2 offset:22528
    ds_read_b128 v[228:231], v3 offset:22528
    ds_read_b128 v[232:235], v4 offset:22528
    s_waitcnt lgkmcnt(3)
    v_mfma_f32_32x32x16_bf16 v[16:31], v[236:239], v[148:151], v[16:31]
    s_add_u32 s31, s10, 36864
    buffer_load_dwordx4 v[208:211], v2, s[12:15], s31 offen offset:0
    v_mfma_f32_32x32x16_bf16 v[32:47], v[240:243], v[148:151], v[32:47]
    buffer_load_dwordx4 v[212:215], v2, s[12:15], s31 offen offset:1024
    v_mfma_f32_32x32x16_bf16 v[48:63], v[244:247], v[148:151], v[48:63]
    ds_read_b128 v[236:239], v2 offset:23552
    ds_read_b128 v[240:243], v3 offset:23552
    ds_read_b128 v[244:247], v4 offset:23552
    s_waitcnt lgkmcnt(3)
    v_mfma_f32_32x32x16_bf16 v[16:31], v[224:227], v[152:155], v[16:31]
    buffer_load_dwordx4 v[216:219], v2, s[12:15], s31 offen offset:2048
    v_mfma_f32_32x32x16_bf16 v[32:47], v[228:231], v[152:155], v[32:47]
    buffer_load_dwordx4 v[220:223], v2, s[12:15], s31 offen offset:3072
    v_mfma_f32_32x32x16_bf16 v[48:63], v[232:235], v[152:155], v[48:63]
    s_waitcnt lgkmcnt(0)
    v_mfma_f32_32x32x16_bf16 v[16:31], v[236:239], v[156:159], v[16:31]
    v_mfma_f32_32x32x16_bf16 v[32:47], v[240:243], v[156:159], v[32:47]
    v_mfma_f32_32x32x16_bf16 v[48:63], v[244:247], v[156:159], v[48:63]
    s_waitcnt vmcnt(14)
    s_barrier
    ds_read_b128 v[224:227], v2 offset:24576
    ds_read_b128 v[228:231], v3 offset:24576
    ds_read_b128 v[232:235], v4 offset:24576
    ds_read_b128 v[236:239], v2 offset:25600
    ds_read_b128 v[240:243], v3 offset:25600
    ds_read_b128 v[244:247], v4 offset:25600
    s_waitcnt lgkmcnt(3)
    v_mfma_f32_32x32x16_bf16 v[16:31], v[224:227], v[160:163], v[16:31]
    v_lshrrev_b32 v5, 5, v1
    v_lshlrev_b32 v5, 3, v5
    s_mul_i32 s32, s9, 192
    buffer_load_dwordx2 v[64:65], v5, s[24:27], s32 offen offset:0
    v_mfma_f32_32x32x16_bf16 v[32:47], v[228:231], v[160:163], v[32:47]
    buffer_load_dwordx2 v[66:67], v5, s[24:27], s32 offen offset:16
    v_mfma_f32_32x32x16_bf16 v[48:63], v[232:235], v[160:163], v[48:63]
    ds_read_b128 v[224:227], v2 offset:26624
    ds_read_b128 v[228:231], v3 offset:26624
    ds_read_b128 v[232:235], v4 offset:26624
    s_waitcnt lgkmcnt(3)
    v_mfma_f32_32x32x16_bf16 v[16:31], v[236:239], v[164:167], v[16:31]
    buffer_load_dwordx2 v[68:69], v5, s[24:27], s32 offen offset:32
    v_mfma_f32_32x32x16_bf16 v[32:47], v[240:243], v[164:167], v[32:47]
    buffer_load_dwordx2 v[70:71], v5, s[24:27], s32 offen offset:48
    v_mfma_f32_32x32x16_bf16 v[48:63], v[244:247], v[164:167], v[48:63]
    ds_read_b128 v[236:239], v2 offset:27648
    ds_read_b128 v[240:243], v3 offset:27648
    ds_read_b128 v[244:247], v4 offset:27648
    s_waitcnt lgkmcnt(3)
    v_mfma_f32_32x32x16_bf16 v[16:31], v[224:227], v[168:171], v[16:31]
    buffer_load_dwordx2 v[72:73], v5, s[24:27], s32 offen offset:64
    v_mfma_f32_32x32x16_bf16 v[32:47], v[228:231], v[168:171], v[32:47]
    buffer_load_dwordx2 v[74:75], v5, s[24:27], s32 offen offset:80
    v_mfma_f32_32x32x16_bf16 v[48:63], v[232:235], v[168:171], v[48:63]
    ds_read_b128 v[224:227], v2 offset:28672
    ds_read_b128 v[228:231], v3 offset:28672
    ds_read_b128 v[232:235], v4 offset:28672
    s_waitcnt lgkmcnt(3)
    v_mfma_f32_32x32x16_bf16 v[16:31], v[236:239], v[172:175], v[16:31]
    buffer_load_dwordx2 v[76:77], v5, s[24:27], s32 offen offset:96
    v_mfma_f32_32x32x16_bf16 v[32:47], v[240:243], v[172:175], v[32:47]
    buffer_load_dwordx2 v[78:79], v5, s[24:27], s32 offen offset:112
    v_mfma_f32_32x32x16_bf16 v[48:63], v[244:247], v[172:175], v[48:63]
    ds_read_b128 v[236:239], v2 offset:29696
    ds_read_b128 v[240:243], v3 offset:29696
    ds_read_b128 v[244:247], v4 offset:29696
    s_waitcnt lgkmcnt(3)
    v_mfma_f32_32x32x16_bf16 v[16:31], v[224:227], v[176:179], v[16:31]
    buffer_load_dwordx2 v[80:81], v5, s[24:27], s32 offen offset:128
    v_mfma_f32_32x32x16_bf16 v[32:47], v[228:231], v[176:179], v[32:47]
    buffer_load_dwordx2 v[82:83], v5, s[24:27], s32 offen offset:144
    v_mfma_f32_32x32x16_bf16 v[48:63], v[232:235], v[176:179], v[48:63]
    ds_read_b128 v[224:227], v2 offset:30720
    ds_read_b128 v[228:231], v3 offset:30720
    ds_read_b128 v[232:235], v4 offset:30720
    s_waitcnt lgkmcnt(3)
    v_mfma_f32_32x32x16_bf16 v[16:31], v[236:239], v[180:183], v[16:31]
    buffer_load_dwordx2 v[84:85], v5, s[24:27], s32 offen offset:160
    v_mfma_f32_32x32x16_bf16 v[32:47], v[240:243], v[180:183], v[32:47]
    buffer_load_dwordx2 v[86:87], v5, s[24:27], s32 offen offset:176
    v_mfma_f32_32x32x16_bf16 v[48:63], v[244:247], v[180:183], v[48:63]
    ds_read_b128 v[236:239], v2 offset:31744
    ds_read_b128 v[240:243], v3 offset:31744
    ds_read_b128 v[244:247], v4 offset:31744
    s_waitcnt lgkmcnt(3)
    v_mfma_f32_32x32x16_bf16 v[16:31], v[224:227], v[184:187], v[16:31]
    v_mfma_f32_32x32x16_bf16 v[32:47], v[228:231], v[184:187], v[32:47]
    v_mfma_f32_32x32x16_bf16 v[48:63], v[232:235], v[184:187], v[48:63]
    s_waitcnt lgkmcnt(0)
    v_mfma_f32_32x32x16_bf16 v[16:31], v[236:239], v[188:191], v[16:31]
    v_mfma_f32_32x32x16_bf16 v[32:47], v[240:243], v[188:191], v[32:47]
    v_mfma_f32_32x32x16_bf16 v[48:63], v[244:247], v[188:191], v[48:63]
    s_waitcnt vmcnt(12)
    s_barrier
    ds_read_b128 v[224:227], v2 offset:32768
    ds_read_b128 v[228:231], v3 offset:32768
    ds_read_b128 v[232:235], v4 offset:32768
    ds_read_b128 v[236:239], v2 offset:33792
    ds_read_b128 v[240:243], v3 offset:33792
    ds_read_b128 v[244:247], v4 offset:33792
    s_waitcnt lgkmcnt(3)
    v_mfma_f32_32x32x16_bf16 v[16:31], v[224:227], v[192:195], v[16:31]
    v_mfma_f32_32x32x16_bf16 v[32:47], v[228:231], v[192:195], v[32:47]
    v_mfma_f32_32x32x16_bf16 v[48:63], v[232:235], v[192:195], v[48:63]
    ds_read_b128 v[224:227], v2 offset:34816
    ds_read_b128 v[228:231], v3 offset:34816
    ds_read_b128 v[232:235], v4 offset:34816
    s_waitcnt lgkmcnt(3)
    v_mfma_f32_32x32x16_bf16 v[16:31], v[236:239], v[196:199], v[16:31]
    v_mfma_f32_32x32x16_bf16 v[32:47], v[240:243], v[196:199], v[32:47]
    v_mfma_f32_32x32x16_bf16 v[48:63], v[244:247], v[196:199], v[48:63]
    ds_read_b128 v[236:239], v2 offset:35840
    ds_read_b128 v[240:243], v3 offset:35840
    ds_read_b128 v[244:247], v4 offset:35840
    s_waitcnt lgkmcnt(3)
    v_mfma_f32_32x32x16_bf16 v[16:31], v[224:227], v[200:203], v[16:31]
    v_mfma_f32_32x32x16_bf16 v[32:47], v[228:231], v[200:203], v[32:47]
    v_mfma_f32_32x32x16_bf16 v[48:63], v[232:235], v[200:203], v[48:63]
    ds_read_b128 v[224:227], v2 offset:36864
    ds_read_b128 v[228:231], v3 offset:36864
    ds_read_b128 v[232:235], v4 offset:36864
    s_waitcnt lgkmcnt(3)
    v_mfma_f32_32x32x16_bf16 v[16:31], v[236:239], v[204:207], v[16:31]
    v_mfma_f32_32x32x16_bf16 v[32:47], v[240:243], v[204:207], v[32:47]
    v_mfma_f32_32x32x16_bf16 v[48:63], v[244:247], v[204:207], v[48:63]
    ds_read_b128 v[236:239], v2 offset:37888
    ds_read_b128 v[240:243], v3 offset:37888
    ds_read_b128 v[244:247], v4 offset:37888
    s_waitcnt lgkmcnt(3)
    v_mfma_f32_32x32x16_bf16 v[16:31], v[224:227], v[208:211], v[16:31]
    v_mfma_f32_32x32x16_bf16 v[32:47], v[228:231], v[208:211], v[32:47]
    v_mfma_f32_32x32x16_bf16 v[48:63], v[232:235], v[208:211], v[48:63]
    ds_read_b128 v[224:227], v2 offset:38912
    ds_read_b128 v[228:231], v3 offset:38912
    ds_read_b128 v[232:235], v4 offset:38912
    s_waitcnt lgkmcnt(3)
    v_mfma_f32_32x32x16_bf16 v[16:31], v[236:239], v[212:215], v[16:31]
    v_mfma_f32_32x32x16_bf16 v[32:47], v[240:243], v[212:215], v[32:47]
    v_mfma_f32_32x32x16_bf16 v[48:63], v[244:247], v[212:215], v[48:63]
    ds_read_b128 v[236:239], v2 offset:39936
    ds_read_b128 v[240:243], v3 offset:39936
    ds_read_b128 v[244:247], v4 offset:39936
    s_waitcnt lgkmcnt(3)
    v_mfma_f32_32x32x16_bf16 v[16:31], v[224:227], v[216:219], v[16:31]
    v_mfma_f32_32x32x16_bf16 v[32:47], v[228:231], v[216:219], v[32:47]
    v_mfma_f32_32x32x16_bf16 v[48:63], v[232:235], v[216:219], v[48:63]
    s_waitcnt lgkmcnt(0)
    v_mfma_f32_32x32x16_bf16 v[16:31], v[236:239], v[220:223], v[16:31]
    v_mfma_f32_32x32x16_bf16 v[32:47], v[240:243], v[220:223], v[32:47]
    v_mfma_f32_32x32x16_bf16 v[48:63], v[244:247], v[220:223], v[48:63]
    v_lshrrev_b32 v9, 4, v1
    v_and_b32 v9, 1, v9
    v_mul_u32_u24 v9, 49152, v9
    v_and_b32 v10, 15, v1
    v_lshl_add_u32 v9, v10, 4, v9
    v_lshrrev_b32 v10, 5, v1
    v_lshl_add_u32 v9, v10, 8, v9
    s_mul_i32 s32, s8, 96
    s_mul_i32 s33, s9, 3
    s_add_u32 s32, s32, s33
    s_lshl_b32 s32, s32, 10
    s_waitcnt vmcnt(0)
    s_nop 15
    v_cvt_pk_bf16_f32 v8, v16, v17
    v_lshlrev_b32 v16, 16, v8
    v_and_b32 v17, 0xffff0000, v8
    v_lshlrev_b32 v6, 16, v64
    v_and_b32 v7, 0xffff0000, v64
    v_pk_add_f32 v[16:17], v[16:17], v[6:7]
    v_cvt_pk_bf16_f32 v8, v16, v17
    v_lshlrev_b32 v16, 16, v8
    v_and_b32 v17, 0xffff0000, v8
    v_max_f32 v16, 0, v16
    v_max_f32 v17, 0, v17
    v_pk_mul_f32 v[16:17], v[16:17], v[16:17]
    v_cvt_pk_bf16_f32 v100, v16, v17
    v_cvt_pk_bf16_f32 v8, v18, v19
    v_lshlrev_b32 v18, 16, v8
    v_and_b32 v19, 0xffff0000, v8
    v_lshlrev_b32 v6, 16, v65
    v_and_b32 v7, 0xffff0000, v65
    v_pk_add_f32 v[18:19], v[18:19], v[6:7]
    v_cvt_pk_bf16_f32 v8, v18, v19
    v_lshlrev_b32 v18, 16, v8
    v_and_b32 v19, 0xffff0000, v8
    v_max_f32 v18, 0, v18
    v_max_f32 v19, 0, v19
    v_pk_mul_f32 v[18:19], v[18:19], v[18:19]
    v_cvt_pk_bf16_f32 v101, v18, v19
    v_cvt_pk_bf16_f32 v8, v20, v21
    v_lshlrev_b32 v20, 16, v8
    v_and_b32 v21, 0xffff0000, v8
    v_lshlrev_b32 v6, 16, v66
    v_and_b32 v7, 0xffff0000, v66
    v_pk_add_f32 v[20:21], v[20:21], v[6:7]
    v_cvt_pk_bf16_f32 v8, v20, v21
    v_lshlrev_b32 v20, 16, v8
    v_and_b32 v21, 0xffff0000, v8
    v_max_f32 v20, 0, v20
    v_max_f32 v21, 0, v21
    v_pk_mul_f32 v[20:21], v[20:21], v[20:21]
    v_cvt_pk_bf16_f32 v102, v20, v21
    v_cvt_pk_bf16_f32 v8, v22, v23
    v_lshlrev_b32 v22, 16, v8
    v_and_b32 v23, 0xffff0000, v8
    v_lshlrev_b32 v6, 16, v67
    v_and_b32 v7, 0xffff0000, v67
    v_pk_add_f32 v[22:23], v[22:23], v[6:7]
    v_cvt_pk_bf16_f32 v8, v22, v23
    v_lshlrev_b32 v22, 16, v8
    v_and_b32 v23, 0xffff0000, v8
    v_max_f32 v22, 0, v22
    v_max_f32 v23, 0, v23
    v_pk_mul_f32 v[22:23], v[22:23], v[22:23]
    v_cvt_pk_bf16_f32 v103, v22, v23
    buffer_store_dwordx4 v[100:103], v9, s[20:23], s32 offen offset:0 sc1
    v_cvt_pk_bf16_f32 v8, v24, v25
    v_lshlrev_b32 v24, 16, v8
    v_and_b32 v25, 0xffff0000, v8
    v_lshlrev_b32 v6, 16, v68
    v_and_b32 v7, 0xffff0000, v68
    v_pk_add_f32 v[24:25], v[24:25], v[6:7]
    v_cvt_pk_bf16_f32 v8, v24, v25
    v_lshlrev_b32 v24, 16, v8
    v_and_b32 v25, 0xffff0000, v8
    v_max_f32 v24, 0, v24
    v_max_f32 v25, 0, v25
    v_pk_mul_f32 v[24:25], v[24:25], v[24:25]
    v_cvt_pk_bf16_f32 v104, v24, v25
    v_cvt_pk_bf16_f32 v8, v26, v27
    v_lshlrev_b32 v26, 16, v8
    v_and_b32 v27, 0xffff0000, v8
    v_lshlrev_b32 v6, 16, v69
    v_and_b32 v7, 0xffff0000, v69
    v_pk_add_f32 v[26:27], v[26:27], v[6:7]
    v_cvt_pk_bf16_f32 v8, v26, v27
    v_lshlrev_b32 v26, 16, v8
    v_and_b32 v27, 0xffff0000, v8
    v_max_f32 v26, 0, v26
    v_max_f32 v27, 0, v27
    v_pk_mul_f32 v[26:27], v[26:27], v[26:27]
    v_cvt_pk_bf16_f32 v105, v26, v27
    v_cvt_pk_bf16_f32 v8, v28, v29
    v_lshlrev_b32 v28, 16, v8
    v_and_b32 v29, 0xffff0000, v8
    v_lshlrev_b32 v6, 16, v70
    v_and_b32 v7, 0xffff0000, v70
    v_pk_add_f32 v[28:29], v[28:29], v[6:7]
    v_cvt_pk_bf16_f32 v8, v28, v29
    v_lshlrev_b32 v28, 16, v8
    v_and_b32 v29, 0xffff0000, v8
    v_max_f32 v28, 0, v28
    v_max_f32 v29, 0, v29
    v_pk_mul_f32 v[28:29], v[28:29], v[28:29]
    v_cvt_pk_bf16_f32 v106, v28, v29
    v_cvt_pk_bf16_f32 v8, v30, v31
    v_lshlrev_b32 v30, 16, v8
    v_and_b32 v31, 0xffff0000, v8
    v_lshlrev_b32 v6, 16, v71
    v_and_b32 v7, 0xffff0000, v71
    v_pk_add_f32 v[30:31], v[30:31], v[6:7]
    v_cvt_pk_bf16_f32 v8, v30, v31
    v_lshlrev_b32 v30, 16, v8
    v_and_b32 v31, 0xffff0000, v8
    v_max_f32 v30, 0, v30
    v_max_f32 v31, 0, v31
    v_pk_mul_f32 v[30:31], v[30:31], v[30:31]
    v_cvt_pk_bf16_f32 v107, v30, v31
    buffer_store_dwordx4 v[104:107], v9, s[20:23], s32 offen offset:512 sc1
    v_cvt_pk_bf16_f32 v8, v32, v33
    v_lshlrev_b32 v32, 16, v8
    v_and_b32 v33, 0xffff0000, v8
    v_lshlrev_b32 v6, 16, v72
    v_and_b32 v7, 0xffff0000, v72
    v_pk_add_f32 v[32:33], v[32:33], v[6:7]
    v_cvt_pk_bf16_f32 v8, v32, v33
    v_lshlrev_b32 v32, 16, v8
    v_and_b32 v33, 0xffff0000, v8
    v_max_f32 v32, 0, v32
    v_max_f32 v33, 0, v33
    v_pk_mul_f32 v[32:33], v[32:33], v[32:33]
    v_cvt_pk_bf16_f32 v108, v32, v33
    v_cvt_pk_bf16_f32 v8, v34, v35
    v_lshlrev_b32 v34, 16, v8
    v_and_b32 v35, 0xffff0000, v8
    v_lshlrev_b32 v6, 16, v73
    v_and_b32 v7, 0xffff0000, v73
    v_pk_add_f32 v[34:35], v[34:35], v[6:7]
    v_cvt_pk_bf16_f32 v8, v34, v35
    v_lshlrev_b32 v34, 16, v8
    v_and_b32 v35, 0xffff0000, v8
    v_max_f32 v34, 0, v34
    v_max_f32 v35, 0, v35
    v_pk_mul_f32 v[34:35], v[34:35], v[34:35]
    v_cvt_pk_bf16_f32 v109, v34, v35
    v_cvt_pk_bf16_f32 v8, v36, v37
    v_lshlrev_b32 v36, 16, v8
    v_and_b32 v37, 0xffff0000, v8
    v_lshlrev_b32 v6, 16, v74
    v_and_b32 v7, 0xffff0000, v74
    v_pk_add_f32 v[36:37], v[36:37], v[6:7]
    v_cvt_pk_bf16_f32 v8, v36, v37
    v_lshlrev_b32 v36, 16, v8
    v_and_b32 v37, 0xffff0000, v8
    v_max_f32 v36, 0, v36
    v_max_f32 v37, 0, v37
    v_pk_mul_f32 v[36:37], v[36:37], v[36:37]
    v_cvt_pk_bf16_f32 v110, v36, v37
    v_cvt_pk_bf16_f32 v8, v38, v39
    v_lshlrev_b32 v38, 16, v8
    v_and_b32 v39, 0xffff0000, v8
    v_lshlrev_b32 v6, 16, v75
    v_and_b32 v7, 0xffff0000, v75
    v_pk_add_f32 v[38:39], v[38:39], v[6:7]
    v_cvt_pk_bf16_f32 v8, v38, v39
    v_lshlrev_b32 v38, 16, v8
    v_and_b32 v39, 0xffff0000, v8
    v_max_f32 v38, 0, v38
    v_max_f32 v39, 0, v39
    v_pk_mul_f32 v[38:39], v[38:39], v[38:39]
    v_cvt_pk_bf16_f32 v111, v38, v39
    buffer_store_dwordx4 v[108:111], v9, s[20:23], s32 offen offset:1024 sc1
    v_cvt_pk_bf16_f32 v8, v40, v41
    v_lshlrev_b32 v40, 16, v8
    v_and_b32 v41, 0xffff0000, v8
    v_lshlrev_b32 v6, 16, v76
    v_and_b32 v7, 0xffff0000, v76
    v_pk_add_f32 v[40:41], v[40:41], v[6:7]
    v_cvt_pk_bf16_f32 v8, v40, v41
    v_lshlrev_b32 v40, 16, v8
    v_and_b32 v41, 0xffff0000, v8
    v_max_f32 v40, 0, v40
    v_max_f32 v41, 0, v41
    v_pk_mul_f32 v[40:41], v[40:41], v[40:41]
    v_cvt_pk_bf16_f32 v112, v40, v41
    v_cvt_pk_bf16_f32 v8, v42, v43
    v_lshlrev_b32 v42, 16, v8
    v_and_b32 v43, 0xffff0000, v8
    v_lshlrev_b32 v6, 16, v77
    v_and_b32 v7, 0xffff0000, v77
    v_pk_add_f32 v[42:43], v[42:43], v[6:7]
    v_cvt_pk_bf16_f32 v8, v42, v43
    v_lshlrev_b32 v42, 16, v8
    v_and_b32 v43, 0xffff0000, v8
    v_max_f32 v42, 0, v42
    v_max_f32 v43, 0, v43
    v_pk_mul_f32 v[42:43], v[42:43], v[42:43]
    v_cvt_pk_bf16_f32 v113, v42, v43
    v_cvt_pk_bf16_f32 v8, v44, v45
    v_lshlrev_b32 v44, 16, v8
    v_and_b32 v45, 0xffff0000, v8
    v_lshlrev_b32 v6, 16, v78
    v_and_b32 v7, 0xffff0000, v78
    v_pk_add_f32 v[44:45], v[44:45], v[6:7]
    v_cvt_pk_bf16_f32 v8, v44, v45
    v_lshlrev_b32 v44, 16, v8
    v_and_b32 v45, 0xffff0000, v8
    v_max_f32 v44, 0, v44
    v_max_f32 v45, 0, v45
    v_pk_mul_f32 v[44:45], v[44:45], v[44:45]
    v_cvt_pk_bf16_f32 v114, v44, v45
    v_cvt_pk_bf16_f32 v8, v46, v47
    v_lshlrev_b32 v46, 16, v8
    v_and_b32 v47, 0xffff0000, v8
    v_lshlrev_b32 v6, 16, v79
    v_and_b32 v7, 0xffff0000, v79
    v_pk_add_f32 v[46:47], v[46:47], v[6:7]
    v_cvt_pk_bf16_f32 v8, v46, v47
    v_lshlrev_b32 v46, 16, v8
    v_and_b32 v47, 0xffff0000, v8
    v_max_f32 v46, 0, v46
    v_max_f32 v47, 0, v47
    v_pk_mul_f32 v[46:47], v[46:47], v[46:47]
    v_cvt_pk_bf16_f32 v115, v46, v47
    buffer_store_dwordx4 v[112:115], v9, s[20:23], s32 offen offset:1536 sc1
    v_cvt_pk_bf16_f32 v8, v48, v49
    v_lshlrev_b32 v48, 16, v8
    v_and_b32 v49, 0xffff0000, v8
    v_lshlrev_b32 v6, 16, v80
    v_and_b32 v7, 0xffff0000, v80
    v_pk_add_f32 v[48:49], v[48:49], v[6:7]
    v_cvt_pk_bf16_f32 v8, v48, v49
    v_lshlrev_b32 v48, 16, v8
    v_and_b32 v49, 0xffff0000, v8
    v_max_f32 v48, 0, v48
    v_max_f32 v49, 0, v49
    v_pk_mul_f32 v[48:49], v[48:49], v[48:49]
    v_cvt_pk_bf16_f32 v116, v48, v49
    v_cvt_pk_bf16_f32 v8, v50, v51
    v_lshlrev_b32 v50, 16, v8
    v_and_b32 v51, 0xffff0000, v8
    v_lshlrev_b32 v6, 16, v81
    v_and_b32 v7, 0xffff0000, v81
    v_pk_add_f32 v[50:51], v[50:51], v[6:7]
    v_cvt_pk_bf16_f32 v8, v50, v51
    v_lshlrev_b32 v50, 16, v8
    v_and_b32 v51, 0xffff0000, v8
    v_max_f32 v50, 0, v50
    v_max_f32 v51, 0, v51
    v_pk_mul_f32 v[50:51], v[50:51], v[50:51]
    v_cvt_pk_bf16_f32 v117, v50, v51
    v_cvt_pk_bf16_f32 v8, v52, v53
    v_lshlrev_b32 v52, 16, v8
    v_and_b32 v53, 0xffff0000, v8
    v_lshlrev_b32 v6, 16, v82
    v_and_b32 v7, 0xffff0000, v82
    v_pk_add_f32 v[52:53], v[52:53], v[6:7]
    v_cvt_pk_bf16_f32 v8, v52, v53
    v_lshlrev_b32 v52, 16, v8
    v_and_b32 v53, 0xffff0000, v8
    v_max_f32 v52, 0, v52
    v_max_f32 v53, 0, v53
    v_pk_mul_f32 v[52:53], v[52:53], v[52:53]
    v_cvt_pk_bf16_f32 v118, v52, v53
    v_cvt_pk_bf16_f32 v8, v54, v55
    v_lshlrev_b32 v54, 16, v8
    v_and_b32 v55, 0xffff0000, v8
    v_lshlrev_b32 v6, 16, v83
    v_and_b32 v7, 0xffff0000, v83
    v_pk_add_f32 v[54:55], v[54:55], v[6:7]
    v_cvt_pk_bf16_f32 v8, v54, v55
    v_lshlrev_b32 v54, 16, v8
    v_and_b32 v55, 0xffff0000, v8
    v_max_f32 v54, 0, v54
    v_max_f32 v55, 0, v55
    v_pk_mul_f32 v[54:55], v[54:55], v[54:55]
    v_cvt_pk_bf16_f32 v119, v54, v55
    buffer_store_dwordx4 v[116:119], v9, s[20:23], s32 offen offset:2048 sc1
    v_cvt_pk_bf16_f32 v8, v56, v57
    v_lshlrev_b32 v56, 16, v8
    v_and_b32 v57, 0xffff0000, v8
    v_lshlrev_b32 v6, 16, v84
    v_and_b32 v7, 0xffff0000, v84
    v_pk_add_f32 v[56:57], v[56:57], v[6:7]
    v_cvt_pk_bf16_f32 v8, v56, v57
    v_lshlrev_b32 v56, 16, v8
    v_and_b32 v57, 0xffff0000, v8
    v_max_f32 v56, 0, v56
    v_max_f32 v57, 0, v57
    v_pk_mul_f32 v[56:57], v[56:57], v[56:57]
    v_cvt_pk_bf16_f32 v120, v56, v57
    v_cvt_pk_bf16_f32 v8, v58, v59
    v_lshlrev_b32 v58, 16, v8
    v_and_b32 v59, 0xffff0000, v8
    v_lshlrev_b32 v6, 16, v85
    v_and_b32 v7, 0xffff0000, v85
    v_pk_add_f32 v[58:59], v[58:59], v[6:7]
    v_cvt_pk_bf16_f32 v8, v58, v59
    v_lshlrev_b32 v58, 16, v8
    v_and_b32 v59, 0xffff0000, v8
    v_max_f32 v58, 0, v58
    v_max_f32 v59, 0, v59
    v_pk_mul_f32 v[58:59], v[58:59], v[58:59]
    v_cvt_pk_bf16_f32 v121, v58, v59
    v_cvt_pk_bf16_f32 v8, v60, v61
    v_lshlrev_b32 v60, 16, v8
    v_and_b32 v61, 0xffff0000, v8
    v_lshlrev_b32 v6, 16, v86
    v_and_b32 v7, 0xffff0000, v86
    v_pk_add_f32 v[60:61], v[60:61], v[6:7]
    v_cvt_pk_bf16_f32 v8, v60, v61
    v_lshlrev_b32 v60, 16, v8
    v_and_b32 v61, 0xffff0000, v8
    v_max_f32 v60, 0, v60
    v_max_f32 v61, 0, v61
    v_pk_mul_f32 v[60:61], v[60:61], v[60:61]
    v_cvt_pk_bf16_f32 v122, v60, v61
    v_cvt_pk_bf16_f32 v8, v62, v63
    v_lshlrev_b32 v62, 16, v8
    v_and_b32 v63, 0xffff0000, v8
    v_lshlrev_b32 v6, 16, v87
    v_and_b32 v7, 0xffff0000, v87
    v_pk_add_f32 v[62:63], v[62:63], v[6:7]
    v_cvt_pk_bf16_f32 v8, v62, v63
    v_lshlrev_b32 v62, 16, v8
    v_and_b32 v63, 0xffff0000, v8
    v_max_f32 v62, 0, v62
    v_max_f32 v63, 0, v63
    v_pk_mul_f32 v[62:63], v[62:63], v[62:63]
    v_cvt_pk_bf16_f32 v123, v62, v63
    buffer_store_dwordx4 v[120:123], v9, s[20:23], s32 offen offset:2560 sc1
K4_end:
    s_endpgm
.p2align 8
.globl k5_kernel
.type k5_kernel,@function
k5_kernel:
    s_load_dwordx4 s[4:7], s[0:1], 56
    s_load_dwordx2 s[8:9], s[0:1], 80
    v_lshrrev_b32 v2, 6, v0
    v_and_b32 v1, 63, v0
    s_nop 0
    v_readfirstlane_b32 s3, v2
    s_waitcnt lgkmcnt(0)
    s_cmp_ge_u32 s2, 256
    s_cbranch_scc1 K5_end
    s_add_u32 s12, s8, 0x1000000
    s_addc_u32 s13, s9, 0
    s_and_b32 s13, s13, 0xffff
    s_mov_b32 s14, 0x600000
    s_mov_b32 s15, 0x20000
    s_add_u32 s16, s8, 0x1a00000
    s_addc_u32 s17, s9, 0
    s_and_b32 s17, s17, 0xffff
    s_mov_b32 s18, 0x1e0000
    s_mov_b32 s19, 0x20000
    s_add_u32 s36, s8, 0xa00000
    s_addc_u32 s37, s9, 0
    s_and_b32 s37, s37, 0xffff
    s_mov_b32 s38, 0x280000
    s_mov_b32 s39, 0x20000
    s_and_b32 s8, s2, 3
    s_lshl_b32 s8, s8, 3
    s_lshr_b32 s9, s2, 3
    s_and_b32 s10, s9, 7
    s_add_u32 s8, s8, s10
    s_lshr_b32 s9, s9, 3
    s_lshr_b32 s10, s2, 2
    s_and_b32 s10, s10, 1
    s_lshl_b32 s10, s10, 2
    s_add_u32 s9, s9, s10
    s_lshl_b32 s8, s8, 2
    s_add_u32 s8, s8, s3
    s_mul_i32 s10, s8, 49152
    s_mul_i32 s11, s9, 245760
    s_mul_i32 s28, s3, 5120
    v_lshlrev_b32 v2, 4, v1
    s_add_u32 s29, s28, 0
    s_add_u32 s30, s28, 0
    s_add_u32 s30, s30, s11
    s_mov_b32 m0, s29
    s_nop 0
    buffer_load_dwordx4 v2, s[16:19], s30 offen lds
    buffer_load_dwordx4 v2, s[16:19], s30 offen offset:1024 lds
    buffer_load_dwordx4 v2, s[16:19], s30 offen offset:2048 lds
    buffer_load_dwordx4 v2, s[16:19], s30 offen offset:3072 lds
    s_add_u32 s29, s29, 4096
    s_add_u32 s30, s30, 4096
    s_mov_b32 m0, s29
    s_nop 0
    buffer_load_dwordx4 v2, s[16:19], s30 offen lds
    s_add_u32 s31, s10, 0
    buffer_load_dwordx4 v[76:79], v2, s[12:15], s31 offen offset:0
    buffer_load_dwordx4 v[80:83], v2, s[12:15], s31 offen offset:1024
    buffer_load_dwordx4 v[84:87], v2, s[12:15], s31 offen offset:2048
    buffer_load_dwordx4 v[88:91], v2, s[12:15], s31 offen offset:3072
    s_add_u32 s29, s28, 20480
    s_add_u32 s30, s28, 20480
    s_add_u32 s30, s30, s11
    s_mov_b32 m0, s29
    s_nop 0
    buffer_load_dwordx4 v2, s[16:19], s30 offen lds
    buffer_load_dwordx4 v2, s[16:19], s30 offen offset:1024 lds
    buffer_load_dwordx4 v2, s[16:19], s30 offen offset:2048 lds
    buffer_load_dwordx4 v2, s[16:19], s30 offen offset:3072 lds
    s_add_u32 s29, s29, 4096
    s_add_u32 s30, s30, 4096
    s_mov_b32 m0, s29
    s_nop 0
    buffer_load_dwordx4 v2, s[16:19], s30 offen lds
    s_add_u32 s31, s10, 4096
    buffer_load_dwordx4 v[92:95], v2, s[12:15], s31 offen offset:0
    buffer_load_dwordx4 v[96:99], v2, s[12:15], s31 offen offset:1024
    buffer_load_dwordx4 v[100:103], v2, s[12:15], s31 offen offset:2048
    buffer_load_dwordx4 v[104:107], v2, s[12:15], s31 offen offset:3072
    s_add_u32 s29, s28, 40960
    s_add_u32 s30, s28, 40960
    s_add_u32 s30, s30, s11
    s_mov_b32 m0, s29
    s_nop 0
    buffer_load_dwordx4 v2, s[16:19], s30 offen lds
    buffer_load_dwordx4 v2, s[16:19], s30 offen offset:1024 lds
    buffer_load_dwordx4 v2, s[16:19], s30 offen offset:2048 lds
    buffer_load_dwordx4 v2, s[16:19], s30 offen offset:3072 lds
    s_add_u32 s29, s29, 4096
    s_add_u32 s30, s30, 4096
    s_mov_b32 m0, s29
    s_nop 0
    buffer_load_dwordx4 v2, s[16:19], s30 offen lds
    s_add_u32 s31, s10, 8192
    buffer_load_dwordx4 v[108:111], v2, s[12:15], s31 offen offset:0
    buffer_load_dwordx4 v[112:115], v2, s[12:15], s31 offen offset:1024
    buffer_load_dwordx4 v[116:119], v2, s[12:15], s31 offen offset:2048
    buffer_load_dwordx4 v[120:123], v2, s[12:15], s31 offen offset:3072
    s_add_u32 s29, s28, 61440
    s_add_u32 s30, s28, 61440
    s_add_u32 s30, s30, s11
    s_mov_b32 m0, s29
    s_nop 0
    buffer_load_dwordx4 v2, s[16:19], s30 offen lds
    buffer_load_dwordx4 v2, s[16:19], s30 offen offset:1024 lds
    buffer_load_dwordx4 v2, s[16:19], s30 offen offset:2048 lds
    buffer_load_dwordx4 v2, s[16:19], s30 offen offset:3072 lds
    s_add_u32 s29, s29, 4096
    s_add_u32 s30, s30, 4096
    s_mov_b32 m0, s29
    s_nop 0
    buffer_load_dwordx4 v2, s[16:19], s30 offen lds
    s_add_u32 s31, s10, 12288
    buffer_load_dwordx4 v[124:127], v2, s[12:15], s31 offen offset:0
    buffer_load_dwordx4 v[128:131], v2, s[12:15], s31 offen offset:1024
    buffer_load_dwordx4 v[132:135], v2, s[12:15], s31 offen offset:2048
    buffer_load_dwordx4 v[136:139], v2, s[12:15], s31 offen offset:3072
    s_add_u32 s20, s6, 0x0
    s_addc_u32 s21, s7, 0
    s_and_b32 s21, s21, 0xffff
    s_mov_b32 s22, 0x280000
    s_mov_b32 s23, 0x20000
    s_add_u32 s24, s4, 0x0
    s_addc_u32 s25, s5, 0
    s_and_b32 s25, s25, 0xffff
    s_mov_b32 s26, 0x500
    s_mov_b32 s27, 0x20000
    v_add_u32 v3, 61440, v2
    v_mov_b32 v16, 0
    v_mov_b32 v17, 0
    v_mov_b32 v18, 0
    v_mov_b32 v19, 0
    v_mov_b32 v20, 0
    v_mov_b32 v21, 0
    v_mov_b32 v22, 0
    v_mov_b32 v23, 0
    v_mov_b32 v24, 0
    v_mov_b32 v25, 0
    v_mov_b32 v26, 0
    v_mov_b32 v27, 0
    v_mov_b32 v28, 0
    v_mov_b32 v29, 0
    v_mov_b32 v30, 0
    v_mov_b32 v31, 0
    v_mov_b32 v32, 0
    v_mov_b32 v33, 0
    v_mov_b32 v34, 0
    v_mov_b32 v35, 0
    s_waitcnt vmcnt(27)
    s_barrier
    ds_read_b128 v[36:39], v2 offset:0
    ds_read_b128 v[40:43], v2 offset:1024
    ds_read_b128 v[44:47], v2 offset:2048
    ds_read_b128 v[48:51], v2 offset:3072
    ds_read_b128 v[52:55], v2 offset:4096
    ds_read_b128 v[56:59], v2 offset:5120
    ds_read_b128 v[60:63], v2 offset:6144
    ds_read_b128 v[64:67], v2 offset:7168
    ds_read_b128 v[68:71], v2 offset:8192
    ds_read_b128 v[72:75], v2 offset:9216
    s_waitcnt lgkmcnt(5)
    v_mfma_f32_16x16x32_bf16 v[16:19], v[36:39], v[76:79], v[16:19]
    v_mfma_f32_16x16x32_bf16 v[20:23], v[40:43], v[76:79], v[20:23]
    s_add_u32 s29, s28, 81920
    s_add_u32 s30, s28, 81920
    s_add_u32 s30, s30, s11
    s_mov_b32 m0, s29
    s_nop 0
    buffer_load_dwordx4 v2, s[16:19], s30 offen lds
    v_mfma_f32_16x16x32_bf16 v[24:27], v[44:47], v[76:79], v[24:27]
    v_mfma_f32_16x16x32_bf16 v[28:31], v[48:51], v[76:79], v[28:31]
    buffer_load_dwordx4 v2, s[16:19], s30 offen offset:1024 lds
    v_mfma_f32_16x16x32_bf16 v[32:35], v[52:55], v[76:79], v[32:35]
    buffer_load_dwordx4 v2, s[16:19], s30 offen offset:2048 lds
    ds_read_b128 v[36:39], v2 offset:10240
    ds_read_b128 v[40:43], v2 offset:11264
    ds_read_b128 v[44:47], v2 offset:12288
    ds_read_b128 v[48:51], v2 offset:13312
    ds_read_b128 v[52:55], v2 offset:14336
    s_waitcnt lgkmcnt(5)
    v_mfma_f32_16x16x32_bf16 v[16:19], v[56:59], v[80:83], v[16:19]
    v_mfma_f32_16x16x32_bf16 v[20:23], v[60:63], v[80:83], v[20:23]
    buffer_load_dwordx4 v2, s[16:19], s30 offen offset:3072 lds
    v_mfma_f32_16x16x32_bf16 v[24:27], v[64:67], v[80:83], v[24:27]
    v_mfma_f32_16x16x32_bf16 v[28:31], v[68:71], v[80:83], v[28:31]
    s_add_u32 s29, s29, 4096
    s_add_u32 s30, s30, 4096
    s_mov_b32 m0, s29
    s_nop 0
    buffer_load_dwordx4 v2, s[16:19], s30 offen lds
    v_mfma_f32_16x16x32_bf16 v[32:35], v[72:75], v[80:83], v[32:35]
    s_add_u32 s31, s10, 16384
    buffer_load_dwordx4 v[140:143], v2, s[12:15], s31 offen offset:0
    ds_read_b128 v[56:59], v2 offset:15360
    ds_read_b128 v[60:63], v2 offset:16384
    ds_read_b128 v[64:67], v2 offset:17408
    ds_read_b128 v[68:71], v2 offset:18432
    ds_read_b128 v[72:75], v2 offset:19456
    s_waitcnt lgkmcnt(5)
    v_mfma_f32_16x16x32_bf16 v[16:19], v[36:39], v[84:87], v[16:19]
    v_mfma_f32_16x16x32_bf16 v[20:23], v[40:43], v[84:87], v[20:23]
    buffer_load_dwordx4 v[144:147], v2, s[12:15], s31 offen offset:1024
    v_mfma_f32_16x16x32_bf16 v[24:27], v[44:47], v[84:87], v[24:27]
    v_mfma_f32_16x16x32_bf16 v[28:31], v[48:51], v[84:87], v[28:31]
    buffer_load_dwordx4 v[148:151], v2, s[12:15], s31 offen offset:2048
    v_mfma_f32_16x16x32_bf16 v[32:35], v[52:55], v[84:87], v[32:35]
    buffer_load_dwordx4 v[152:155], v2, s[12:15], s31 offen offset:3072
    s_waitcnt lgkmcnt(0)
    v_mfma_f32_16x16x32_bf16 v[16:19], v[56:59], v[88:91], v[16:19]
    v_mfma_f32_16x16x32_bf16 v[20:23], v[60:63], v[88:91], v[20:23]
    v_mfma_f32_16x16x32_bf16 v[24:27], v[64:67], v[88:91], v[24:27]
    v_mfma_f32_16x16x32_bf16 v[28:31], v[68:71], v[88:91], v[28:31]
    v_mfma_f32_16x16x32_bf16 v[32:35], v[72:75], v[88:91], v[32:35]
    s_waitcnt vmcnt(27)
    s_barrier
    ds_read_b128 v[36:39], v2 offset:20480
    ds_read_b128 v[40:43], v2 offset:21504
    ds_read_b128 v[44:47], v2 offset:22528
    ds_read_b128 v[48:51], v2 offset:23552
    ds_read_b128 v[52:55], v2 offset:24576
    ds_read_b128 v[56:59], v2 offset:25600
    ds_read_b128 v[60:63], v2 offset:26624
    ds_read_b128 v[64:67], v2 offset:27648
    ds_read_b128 v[68:71], v2 offset:28672
    ds_read_b128 v[72:75], v2 offset:29696
    s_waitcnt lgkmcnt(5)
    v_mfma_f32_16x16x32_bf16 v[16:19], v[36:39], v[92:95], v[16:19]
    v_mfma_f32_16x16x32_bf16 v[20:23], v[40:43], v[92:95], v[20:23]
    s_add_u32 s29, s28, 102400
    s_add_u32 s30, s28, 102400
    s_add_u32 s30, s30, s11
    s_mov_b32 m0, s29
    s_nop 0
    buffer_load_dwordx4 v2, s[16:19], s30 offen lds
    v_mfma_f32_16x16x32_bf16 v[24:27], v[44:47], v[92:95], v[24:27]
    v_mfma_f32_16x16x32_bf16 v[28:31], v[48:51], v[92:95], v[28:31]
    buffer_load_dwordx4 v2, s[16:19], s30 offen offset:1024 lds
    v_mfma_f32_16x16x32_bf16 v[32:35], v[52:55], v[92:95], v[32:35]
    buffer_load_dwordx4 v2, s[16:19], s30 offen offset:2048 lds
    ds_read_b128 v[36:39], v2 offset:30720
    ds_read_b128 v[40:43], v2 offset:31744
    ds_read_b128 v[44:47], v2 offset:32768
    ds_read_b128 v[48:51], v2 offset:33792
    ds_read_b128 v[52:55], v2 offset:34816
    s_waitcnt lgkmcnt(5)
    v_mfma_f32_16x16x32_bf16 v[16:19], v[56:59], v[96:99], v[16:19]
    v_mfma_f32_16x16x32_bf16 v[20:23], v[60:63], v[96:99], v[20:23]
    buffer_load_dwordx4 v2, s[16:19], s30 offen offset:3072 lds
    v_mfma_f32_16x16x32_bf16 v[24:27], v[64:67], v[96:99], v[24:27]
    v_mfma_f32_16x16x32_bf16 v[28:31], v[68:71], v[96:99], v[28:31]
    s_add_u32 s29, s29, 4096
    s_add_u32 s30, s30, 4096
    s_mov_b32 m0, s29
    s_nop 0
    buffer_load_dwordx4 v2, s[16:19], s30 offen lds
    v_mfma_f32_16x16x32_bf16 v[32:35], v[72:75], v[96:99], v[32:35]
    s_add_u32 s31, s10, 20480
    buffer_load_dwordx4 v[156:159], v2, s[12:15], s31 offen offset:0
    ds_read_b128 v[56:59], v2 offset:35840
    ds_read_b128 v[60:63], v2 offset:36864
    ds_read_b128 v[64:67], v2 offset:37888
    ds_read_b128 v[68:71], v2 offset:38912
    ds_read_b128 v[72:75], v2 offset:39936
    s_waitcnt lgkmcnt(5)
    v_mfma_f32_16x16x32_bf16 v[16:19], v[36:39], v[100:103], v[16:19]
    v_mfma_f32_16x16x32_bf16 v[20:23], v[40:43], v[100:103], v[20:23]
    buffer_load_dwordx4 v[160:163], v2, s[12:15], s31 offen offset:1024
    v_mfma_f32_16x16x32_bf16 v[24:27], v[44:47], v[100:103], v[24:27]
    v_mfma_f32_16x16x32_bf16 v[28:31], v[48:51], v[100:103], v[28:31]
    buffer_load_dwordx4 v[164:167], v2, s[12:15], s31 offen offset:2048
    v_mfma_f32_16x16x32_bf16 v[32:35], v[52:55], v[100:103], v[32:35]
    buffer_load_dwordx4 v[168:171], v2, s[12:15], s31 offen offset:3072
    s_waitcnt lgkmcnt(0)
    v_mfma_f32_16x16x32_bf16 v[16:19], v[56:59], v[104:107], v[16:19]
    v_mfma_f32_16x16x32_bf16 v[20:23], v[60:63], v[104:107], v[20:23]
    v_mfma_f32_16x16x32_bf16 v[24:27], v[64:67], v[104:107], v[24:27]
    v_mfma_f32_16x16x32_bf16 v[28:31], v[68:71], v[104:107], v[28:31]
    v_mfma_f32_16x16x32_bf16 v[32:35], v[72:75], v[104:107], v[32:35]
    s_waitcnt vmcnt(27)
    s_barrier
    ds_read_b128 v[36:39], v2 offset:40960
    ds_read_b128 v[40:43], v2 offset:41984
    ds_read_b128 v[44:47], v2 offset:43008
    ds_read_b128 v[48:51], v2 offset:44032
    ds_read_b128 v[52:55], v2 offset:45056
    ds_read_b128 v[56:59], v2 offset:46080
    ds_read_b128 v[60:63], v2 offset:47104
    ds_read_b128 v[64:67], v2 offset:48128
    ds_read_b128 v[68:71], v2 offset:49152
    ds_read_b128 v[72:75], v2 offset:50176
    s_waitcnt lgkmcnt(5)
    v_mfma_f32_16x16x32_bf16 v[16:19], v[36:39], v[108:111], v[16:19]
    v_mfma_f32_16x16x32_bf16 v[20:23], v[40:43], v[108:111], v[20:23]
    s_add_u32 s29, s28, 0
    s_add_u32 s30, s28, 122880
    s_add_u32 s30, s30, s11
    s_mov_b32 m0, s29
    s_nop 0
    buffer_load_dwordx4 v2, s[16:19], s30 offen lds
    v_mfma_f32_16x16x32_bf16 v[24:27], v[44:47], v[108:111], v[24:27]
    v_mfma_f32_16x16x32_bf16 v[28:31], v[48:51], v[108:111], v[28:31]
    buffer_load_dwordx4 v2, s[16:19], s30 offen offset:1024 lds
    v_mfma_f32_16x16x32_bf16 v[32:35], v[52:55], v[108:111], v[32:35]
    buffer_load_dwordx4 v2, s[16:19], s30 offen offset:2048 lds
    ds_read_b128 v[36:39], v2 offset:51200
    ds_read_b128 v[40:43], v2 offset:52224
    ds_read_b128 v[44:47], v2 offset:53248
    ds_read_b128 v[48:51], v2 offset:54272
    ds_read_b128 v[52:55], v2 offset:55296
    s_waitcnt lgkmcnt(5)
    v_mfma_f32_16x16x32_bf16 v[16:19], v[56:59], v[112:115], v[16:19]
    v_mfma_f32_16x16x32_bf16 v[20:23], v[60:63], v[112:115], v[20:23]
    buffer_load_dwordx4 v2, s[16:19], s30 offen offset:3072 lds
    v_mfma_f32_16x16x32_bf16 v[24:27], v[64:67], v[112:115], v[24:27]
    v_mfma_f32_16x16x32_bf16 v[28:31], v[68:71], v[112:115], v[28:31]
    s_add_u32 s29, s29, 4096
    s_add_u32 s30, s30, 4096
    s_mov_b32 m0, s29
    s_nop 0
    buffer_load_dwordx4 v2, s[16:19], s30 offen lds
    v_mfma_f32_16x16x32_bf16 v[32:35], v[72:75], v[112:115], v[32:35]
    s_add_u32 s31, s10, 24576
    buffer_load_dwordx4 v[76:79], v2, s[12:15], s31 offen offset:0
    ds_read_b128 v[56:59], v2 offset:56320
    ds_read_b128 v[60:63], v2 offset:57344
    ds_read_b128 v[64:67], v2 offset:58368
    ds_read_b128 v[68:71], v2 offset:59392
    ds_read_b128 v[72:75], v2 offset:60416
    s_waitcnt lgkmcnt(5)
    v_mfma_f32_16x16x32_bf16 v[16:19], v[36:39], v[116:119], v[16:19]
    v_mfma_f32_16x16x32_bf16 v[20:23], v[40:43], v[116:119], v[20:23]
    buffer_load_dwordx4 v[80:83], v2, s[12:15], s31 offen offset:1024
    v_mfma_f32_16x16x32_bf16 v[24:27], v[44:47], v[116:119], v[24:27]
    v_mfma_f32_16x16x32_bf16 v[28:31], v[48:51], v[116:119], v[28:31]
    buffer_load_dwordx4 v[84:87], v2, s[12:15], s31 offen offset:2048
    v_mfma_f32_16x16x32_bf16 v[32:35], v[52:55], v[116:119], v[32:35]
    buffer_load_dwordx4 v[88:91], v2, s[12:15], s31 offen offset:3072
    s_waitcnt lgkmcnt(0)
    v_mfma_f32_16x16x32_bf16 v[16:19], v[56:59], v[120:123], v[16:19]
    v_mfma_f32_16x16x32_bf16 v[20:23], v[60:63], v[120:123], v[20:23]
    v_mfma_f32_16x16x32_bf16 v[24:27], v[64:67], v[120:123], v[24:27]
    v_mfma_f32_16x16x32_bf16 v[28:31], v[68:71], v[120:123], v[28:31]
    v_mfma_f32_16x16x32_bf16 v[32:35], v[72:75], v[120:123], v[32:35]
    s_waitcnt vmcnt(27)
    s_barrier
    ds_read_b128 v[36:39], v3 offset:0
    ds_read_b128 v[40:43], v3 offset:1024
    ds_read_b128 v[44:47], v3 offset:2048
    ds_read_b128 v[48:51], v3 offset:3072
    ds_read_b128 v[52:55], v3 offset:4096
    ds_read_b128 v[56:59], v3 offset:5120
    ds_read_b128 v[60:63], v3 offset:6144
    ds_read_b128 v[64:67], v3 offset:7168
    ds_read_b128 v[68:71], v3 offset:8192
    ds_read_b128 v[72:75], v3 offset:9216
    s_waitcnt lgkmcnt(5)
    v_mfma_f32_16x16x32_bf16 v[16:19], v[36:39], v[124:127], v[16:19]
    v_mfma_f32_16x16x32_bf16 v[20:23], v[40:43], v[124:127], v[20:23]
    s_add_u32 s29, s28, 20480
    s_add_u32 s30, s28, 143360
    s_add_u32 s30, s30, s11
    s_mov_b32 m0, s29
    s_nop 0
    buffer_load_dwordx4 v2, s[16:19], s30 offen lds
    v_mfma_f32_16x16x32_bf16 v[24:27], v[44:47], v[124:127], v[24:27]
    v_mfma_f32_16x16x32_bf16 v[28:31], v[48:51], v[124:127], v[28:31]
    buffer_load_dwordx4 v2, s[16:19], s30 offen offset:1024 lds
    v_mfma_f32_16x16x32_bf16 v[32:35], v[52:55], v[124:127], v[32:35]
    buffer_load_dwordx4 v2, s[16:19], s30 offen offset:2048 lds
    ds_read_b128 v[36:39], v3 offset:10240
    ds_read_b128 v[40:43], v3 offset:11264
    ds_read_b128 v[44:47], v3 offset:12288
    ds_read_b128 v[48:51], v3 offset:13312
    ds_read_b128 v[52:55], v3 offset:14336
    s_waitcnt lgkmcnt(5)
    v_mfma_f32_16x16x32_bf16 v[16:19], v[56:59], v[128:131], v[16:19]
    v_mfma_f32_16x16x32_bf16 v[20:23], v[60:63], v[128:131], v[20:23]
    buffer_load_dwordx4 v2, s[16:19], s30 offen offset:3072 lds
    v_mfma_f32_16x16x32_bf16 v[24:27], v[64:67], v[128:131], v[24:27]
    v_mfma_f32_16x16x32_bf16 v[28:31], v[68:71], v[128:131], v[28:31]
    s_add_u32 s29, s29, 4096
    s_add_u32 s30, s30, 4096
    s_mov_b32 m0, s29
    s_nop 0
    buffer_load_dwordx4 v2, s[16:19], s30 offen lds
    v_mfma_f32_16x16x32_bf16 v[32:35], v[72:75], v[128:131], v[32:35]
    s_add_u32 s31, s10, 28672
    buffer_load_dwordx4 v[92:95], v2, s[12:15], s31 offen offset:0
    ds_read_b128 v[56:59], v3 offset:15360
    ds_read_b128 v[60:63], v3 offset:16384
    ds_read_b128 v[64:67], v3 offset:17408
    ds_read_b128 v[68:71], v3 offset:18432
    ds_read_b128 v[72:75], v3 offset:19456
    s_waitcnt lgkmcnt(5)
    v_mfma_f32_16x16x32_bf16 v[16:19], v[36:39], v[132:135], v[16:19]
    v_mfma_f32_16x16x32_bf16 v[20:23], v[40:43], v[132:135], v[20:23]
    buffer_load_dwordx4 v[96:99], v2, s[12:15], s31 offen offset:1024
    v_mfma_f32_16x16x32_bf16 v[24:27], v[44:47], v[132:135], v[24:27]
    v_mfma_f32_16x16x32_bf16 v[28:31], v[48:51], v[132:135], v[28:31]
    buffer_load_dwordx4 v[100:103], v2, s[12:15], s31 offen offset:2048
    v_mfma_f32_16x16x32_bf16 v[32:35], v[52:55], v[132:135], v[32:35]
    buffer_load_dwordx4 v[104:107], v2, s[12:15], s31 offen offset:3072
    s_waitcnt lgkmcnt(0)
    v_mfma_f32_16x16x32_bf16 v[16:19], v[56:59], v[136:139], v[16:19]
    v_mfma_f32_16x16x32_bf16 v[20:23], v[60:63], v[136:139], v[20:23]
    v_mfma_f32_16x16x32_bf16 v[24:27], v[64:67], v[136:139], v[24:27]
    v_mfma_f32_16x16x32_bf16 v[28:31], v[68:71], v[136:139], v[28:31]
    v_mfma_f32_16x16x32_bf16 v[32:35], v[72:75], v[136:139], v[32:35]
    s_waitcnt vmcnt(27)
    s_barrier
    ds_read_b128 v[36:39], v3 offset:20480
    ds_read_b128 v[40:43], v3 offset:21504
    ds_read_b128 v[44:47], v3 offset:22528
    ds_read_b128 v[48:51], v3 offset:23552
    ds_read_b128 v[52:55], v3 offset:24576
    ds_read_b128 v[56:59], v3 offset:25600
    ds_read_b128 v[60:63], v3 offset:26624
    ds_read_b128 v[64:67], v3 offset:27648
    ds_read_b128 v[68:71], v3 offset:28672
    ds_read_b128 v[72:75], v3 offset:29696
    s_waitcnt lgkmcnt(5)
    v_mfma_f32_16x16x32_bf16 v[16:19], v[36:39], v[140:143], v[16:19]
    v_mfma_f32_16x16x32_bf16 v[20:23], v[40:43], v[140:143], v[20:23]
    s_add_u32 s29, s28, 40960
    s_add_u32 s30, s28, 163840
    s_add_u32 s30, s30, s11
    s_mov_b32 m0, s29
    s_nop 0
    buffer_load_dwordx4 v2, s[16:19], s30 offen lds
    v_mfma_f32_16x16x32_bf16 v[24:27], v[44:47], v[140:143], v[24:27]
    v_mfma_f32_16x16x32_bf16 v[28:31], v[48:51], v[140:143], v[28:31]
    buffer_load_dwordx4 v2, s[16:19], s30 offen offset:1024 lds
    v_mfma_f32_16x16x32_bf16 v[32:35], v[52:55], v[140:143], v[32:35]
    buffer_load_dwordx4 v2, s[16:19], s30 offen offset:2048 lds
    ds_read_b128 v[36:39], v3 offset:30720
    ds_read_b128 v[40:43], v3 offset:31744
    ds_read_b128 v[44:47], v3 offset:32768
    ds_read_b128 v[48:51], v3 offset:33792
    ds_read_b128 v[52:55], v3 offset:34816
    s_waitcnt lgkmcnt(5)
    v_mfma_f32_16x16x32_bf16 v[16:19], v[56:59], v[144:147], v[16:19]
    v_mfma_f32_16x16x32_bf16 v[20:23], v[60:63], v[144:147], v[20:23]
    buffer_load_dwordx4 v2, s[16:19], s30 offen offset:3072 lds
    v_mfma_f32_16x16x32_bf16 v[24:27], v[64:67], v[144:147], v[24:27]
    v_mfma_f32_16x16x32_bf16 v[28:31], v[68:71], v[144:147], v[28:31]
    s_add_u32 s29, s29, 4096
    s_add_u32 s30, s30, 4096
    s_mov_b32 m0, s29
    s_nop 0
    buffer_load_dwordx4 v2, s[16:19], s30 offen lds
    v_mfma_f32_16x16x32_bf16 v[32:35], v[72:75], v[144:147], v[32:35]
    s_add_u32 s31, s10, 32768
    buffer_load_dwordx4 v[108:111], v2, s[12:15], s31 offen offset:0
    ds_read_b128 v[56:59], v3 offset:35840
    ds_read_b128 v[60:63], v3 offset:36864
    ds_read_b128 v[64:67], v3 offset:37888
    ds_read_b128 v[68:71], v3 offset:38912
    ds_read_b128 v[72:75], v3 offset:39936
    s_waitcnt lgkmcnt(5)
    v_mfma_f32_16x16x32_bf16 v[16:19], v[36:39], v[148:151], v[16:19]
    v_mfma_f32_16x16x32_bf16 v[20:23], v[40:43], v[148:151], v[20:23]
    buffer_load_dwordx4 v[112:115], v2, s[12:15], s31 offen offset:1024
    v_mfma_f32_16x16x32_bf16 v[24:27], v[44:47], v[148:151], v[24:27]
    v_mfma_f32_16x16x32_bf16 v[28:31], v[48:51], v[148:151], v[28:31]
    buffer_load_dwordx4 v[116:119], v2, s[12:15], s31 offen offset:2048
    v_mfma_f32_16x16x32_bf16 v[32:35], v[52:55], v[148:151], v[32:35]
    buffer_load_dwordx4 v[120:123], v2, s[12:15], s31 offen offset:3072
    s_waitcnt lgkmcnt(0)
    v_mfma_f32_16x16x32_bf16 v[16:19], v[56:59], v[152:155], v[16:19]
    v_mfma_f32_16x16x32_bf16 v[20:23], v[60:63], v[152:155], v[20:23]
    v_mfma_f32_16x16x32_bf16 v[24:27], v[64:67], v[152:155], v[24:27]
    v_mfma_f32_16x16x32_bf16 v[28:31], v[68:71], v[152:155], v[28:31]
    v_mfma_f32_16x16x32_bf16 v[32:35], v[72:75], v[152:155], v[32:35]
    s_waitcnt vmcnt(27)
    s_barrier
    ds_read_b128 v[36:39], v3 offset:40960
    ds_read_b128 v[40:43], v3 offset:41984
    ds_read_b128 v[44:47], v3 offset:43008
    ds_read_b128 v[48:51], v3 offset:44032
    ds_read_b128 v[52:55], v3 offset:45056
    ds_read_b128 v[56:59], v3 offset:46080
    ds_read_b128 v[60:63], v3 offset:47104
    ds_read_b128 v[64:67], v3 offset:48128
    ds_read_b128 v[68:71], v3 offset:49152
    ds_read_b128 v[72:75], v3 offset:50176
    s_waitcnt lgkmcnt(5)
    v_mfma_f32_16x16x32_bf16 v[16:19], v[36:39], v[156:159], v[16:19]
    v_mfma_f32_16x16x32_bf16 v[20:23], v[40:43], v[156:159], v[20:23]
    s_add_u32 s29, s28, 61440
    s_add_u32 s30, s28, 184320
    s_add_u32 s30, s30, s11
    s_mov_b32 m0, s29
    s_nop 0
    buffer_load_dwordx4 v2, s[16:19], s30 offen lds
    v_mfma_f32_16x16x32_bf16 v[24:27], v[44:47], v[156:159], v[24:27]
    v_mfma_f32_16x16x32_bf16 v[28:31], v[48:51], v[156:159], v[28:31]
    buffer_load_dwordx4 v2, s[16:19], s30 offen offset:1024 lds
    v_mfma_f32_16x16x32_bf16 v[32:35], v[52:55], v[156:159], v[32:35]
    buffer_load_dwordx4 v2, s[16:19], s30 offen offset:2048 lds
    ds_read_b128 v[36:39], v3 offset:51200
    ds_read_b128 v[40:43], v3 offset:52224
    ds_read_b128 v[44:47], v3 offset:53248
    ds_read_b128 v[48:51], v3 offset:54272
    ds_read_b128 v[52:55], v3 offset:55296
    s_waitcnt lgkmcnt(5)
    v_mfma_f32_16x16x32_bf16 v[16:19], v[56:59], v[160:163], v[16:19]
    v_mfma_f32_16x16x32_bf16 v[20:23], v[60:63], v[160:163], v[20:23]
    buffer_load_dwordx4 v2, s[16:19], s30 offen offset:3072 lds
    v_mfma_f32_16x16x32_bf16 v[24:27], v[64:67], v[160:163], v[24:27]
    v_mfma_f32_16x16x32_bf16 v[28:31], v[68:71], v[160:163], v[28:31]
    s_add_u32 s29, s29, 4096
    s_add_u32 s30, s30, 4096
    s_mov_b32 m0, s29
    s_nop 0
    buffer_load_dwordx4 v2, s[16:19], s30 offen lds
    v_mfma_f32_16x16x32_bf16 v[32:35], v[72:75], v[160:163], v[32:35]
    s_add_u32 s31, s10, 36864
    buffer_load_dwordx4 v[124:127], v2, s[12:15], s31 offen offset:0
    ds_read_b128 v[56:59], v3 offset:56320
    ds_read_b128 v[60:63], v3 offset:57344
    ds_read_b128 v[64:67], v3 offset:58368
    ds_read_b128 v[68:71], v3 offset:59392
    ds_read_b128 v[72:75], v3 offset:60416
    s_waitcnt lgkmcnt(5)
    v_mfma_f32_16x16x32_bf16 v[16:19], v[36:39], v[164:167], v[16:19]
    v_mfma_f32_16x16x32_bf16 v[20:23], v[40:43], v[164:167], v[20:23]
    buffer_load_dwordx4 v[128:131], v2, s[12:15], s31 offen offset:1024
    v_mfma_f32_16x16x32_bf16 v[24:27], v[44:47], v[164:167], v[24:27]
    v_mfma_f32_16x16x32_bf16 v[28:31], v[48:51], v[164:167], v[28:31]
    buffer_load_dwordx4 v[132:135], v2, s[12:15], s31 offen offset:2048
    v_mfma_f32_16x16x32_bf16 v[32:35], v[52:55], v[164:167], v[32:35]
    buffer_load_dwordx4 v[136:139], v2, s[12:15], s31 offen offset:3072
    s_waitcnt lgkmcnt(0)
    v_mfma_f32_16x16x32_bf16 v[16:19], v[56:59], v[168:171], v[16:19]
    v_mfma_f32_16x16x32_bf16 v[20:23], v[60:63], v[168:171], v[20:23]
    v_mfma_f32_16x16x32_bf16 v[24:27], v[64:67], v[168:171], v[24:27]
    v_mfma_f32_16x16x32_bf16 v[28:31], v[68:71], v[168:171], v[28:31]
    v_mfma_f32_16x16x32_bf16 v[32:35], v[72:75], v[168:171], v[32:35]
    s_waitcnt vmcnt(27)
    s_barrier
    ds_read_b128 v[36:39], v2 offset:0
    ds_read_b128 v[40:43], v2 offset:1024
    ds_read_b128 v[44:47], v2 offset:2048
    ds_read_b128 v[48:51], v2 offset:3072
    ds_read_b128 v[52:55], v2 offset:4096
    ds_read_b128 v[56:59], v2 offset:5120
    ds_read_b128 v[60:63], v2 offset:6144
    ds_read_b128 v[64:67], v2 offset:7168
    ds_read_b128 v[68:71], v2 offset:8192
    ds_read_b128 v[72:75], v2 offset:9216
    s_waitcnt lgkmcnt(5)
    v_mfma_f32_16x16x32_bf16 v[16:19], v[36:39], v[76:79], v[16:19]
    v_mfma_f32_16x16x32_bf16 v[20:23], v[40:43], v[76:79], v[20:23]
    s_add_u32 s29, s28, 81920
    s_add_u32 s30, s28, 204800
    s_add_u32 s30, s30, s11
    s_mov_b32 m0, s29
    s_nop 0
    buffer_load_dwordx4 v2, s[16:19], s30 offen lds
    v_mfma_f32_16x16x32_bf16 v[24:27], v[44:47], v[76:79], v[24:27]
    v_mfma_f32_16x16x32_bf16 v[28:31], v[48:51], v[76:79], v[28:31]
    buffer_load_dwordx4 v2, s[16:19], s30 offen offset:1024 lds
    v_mfma_f32_16x16x32_bf16 v[32:35], v[52:55], v[76:79], v[32:35]
    buffer_load_dwordx4 v2, s[16:19], s30 offen offset:2048 lds
    ds_read_b128 v[36:39], v2 offset:10240
    ds_read_b128 v[40:43], v2 offset:11264
    ds_read_b128 v[44:47], v2 offset:12288
    ds_read_b128 v[48:51], v2 offset:13312
    ds_read_b128 v[52:55], v2 offset:14336
    s_waitcnt lgkmcnt(5)
    v_mfma_f32_16x16x32_bf16 v[16:19], v[56:59], v[80:83], v[16:19]
    v_mfma_f32_16x16x32_bf16 v[20:23], v[60:63], v[80:83], v[20:23]
    buffer_load_dwordx4 v2, s[16:19], s30 offen offset:3072 lds
    v_mfma_f32_16x16x32_bf16 v[24:27], v[64:67], v[80:83], v[24:27]
    v_mfma_f32_16x16x32_bf16 v[28:31], v[68:71], v[80:83], v[28:31]
    s_add_u32 s29, s29, 4096
    s_add_u32 s30, s30, 4096
    s_mov_b32 m0, s29
    s_nop 0
    buffer_load_dwordx4 v2, s[16:19], s30 offen lds
    v_mfma_f32_16x16x32_bf16 v[32:35], v[72:75], v[80:83], v[32:35]
    s_add_u32 s31, s10, 40960
    buffer_load_dwordx4 v[140:143], v2, s[12:15], s31 offen offset:0
    ds_read_b128 v[56:59], v2 offset:15360
    ds_read_b128 v[60:63], v2 offset:16384
    ds_read_b128 v[64:67], v2 offset:17408
    ds_read_b128 v[68:71], v2 offset:18432
    ds_read_b128 v[72:75], v2 offset:19456
    s_waitcnt lgkmcnt(5)
    v_mfma_f32_16x16x32_bf16 v[16:19], v[36:39], v[84:87], v[16:19]
    v_mfma_f32_16x16x32_bf16 v[20:23], v[40:43], v[84:87], v[20:23]
    buffer_load_dwordx4 v[144:147], v2, s[12:15], s31 offen offset:1024
    v_mfma_f32_16x16x32_bf16 v[24:27], v[44:47], v[84:87], v[24:27]
    v_mfma_f32_16x16x32_bf16 v[28:31], v[48:51], v[84:87], v[28:31]
    buffer_load_dwordx4 v[148:151], v2, s[12:15], s31 offen offset:2048
    v_mfma_f32_16x16x32_bf16 v[32:35], v[52:55], v[84:87], v[32:35]
    buffer_load_dwordx4 v[152:155], v2, s[12:15], s31 offen offset:3072
    s_waitcnt lgkmcnt(0)
    v_mfma_f32_16x16x32_bf16 v[16:19], v[56:59], v[88:91], v[16:19]
    v_mfma_f32_16x16x32_bf16 v[20:23], v[60:63], v[88:91], v[20:23]
    v_mfma_f32_16x16x32_bf16 v[24:27], v[64:67], v[88:91], v[24:27]
    v_mfma_f32_16x16x32_bf16 v[28:31], v[68:71], v[88:91], v[28:31]
    v_mfma_f32_16x16x32_bf16 v[32:35], v[72:75], v[88:91], v[32:35]
    s_waitcnt vmcnt(27)
    s_barrier
    ds_read_b128 v[36:39], v2 offset:20480
    ds_read_b128 v[40:43], v2 offset:21504
    ds_read_b128 v[44:47], v2 offset:22528
    ds_read_b128 v[48:51], v2 offset:23552
    ds_read_b128 v[52:55], v2 offset:24576
    ds_read_b128 v[56:59], v2 offset:25600
    ds_read_b128 v[60:63], v2 offset:26624
    ds_read_b128 v[64:67], v2 offset:27648
    ds_read_b128 v[68:71], v2 offset:28672
    ds_read_b128 v[72:75], v2 offset:29696
    s_waitcnt lgkmcnt(5)
    v_mfma_f32_16x16x32_bf16 v[16:19], v[36:39], v[92:95], v[16:19]
    v_mfma_f32_16x16x32_bf16 v[20:23], v[40:43], v[92:95], v[20:23]
    s_add_u32 s29, s28, 102400
    s_add_u32 s30, s28, 225280
    s_add_u32 s30, s30, s11
    s_mov_b32 m0, s29
    s_nop 0
    buffer_load_dwordx4 v2, s[16:19], s30 offen lds
    v_mfma_f32_16x16x32_bf16 v[24:27], v[44:47], v[92:95], v[24:27]
    v_mfma_f32_16x16x32_bf16 v[28:31], v[48:51], v[92:95], v[28:31]
    buffer_load_dwordx4 v2, s[16:19], s30 offen offset:1024 lds
    v_mfma_f32_16x16x32_bf16 v[32:35], v[52:55], v[92:95], v[32:35]
    buffer_load_dwordx4 v2, s[16:19], s30 offen offset:2048 lds
    ds_read_b128 v[36:39], v2 offset:30720
    ds_read_b128 v[40:43], v2 offset:31744
    ds_read_b128 v[44:47], v2 offset:32768
    ds_read_b128 v[48:51], v2 offset:33792
    ds_read_b128 v[52:55], v2 offset:34816
    s_waitcnt lgkmcnt(5)
    v_mfma_f32_16x16x32_bf16 v[16:19], v[56:59], v[96:99], v[16:19]
    v_mfma_f32_16x16x32_bf16 v[20:23], v[60:63], v[96:99], v[20:23]
    buffer_load_dwordx4 v2, s[16:19], s30 offen offset:3072 lds
    v_mfma_f32_16x16x32_bf16 v[24:27], v[64:67], v[96:99], v[24:27]
    v_mfma_f32_16x16x32_bf16 v[28:31], v[68:71], v[96:99], v[28:31]
    s_add_u32 s29, s29, 4096
    s_add_u32 s30, s30, 4096
    s_mov_b32 m0, s29
    s_nop 0
    buffer_load_dwordx4 v2, s[16:19], s30 offen lds
    v_mfma_f32_16x16x32_bf16 v[32:35], v[72:75], v[96:99], v[32:35]
    s_add_u32 s31, s10, 45056
    buffer_load_dwordx4 v[156:159], v2, s[12:15], s31 offen offset:0
    ds_read_b128 v[56:59], v2 offset:35840
    ds_read_b128 v[60:63], v2 offset:36864
    ds_read_b128 v[64:67], v2 offset:37888
    ds_read_b128 v[68:71], v2 offset:38912
    ds_read_b128 v[72:75], v2 offset:39936
    s_waitcnt lgkmcnt(5)
    v_mfma_f32_16x16x32_bf16 v[16:19], v[36:39], v[100:103], v[16:19]
    v_mfma_f32_16x16x32_bf16 v[20:23], v[40:43], v[100:103], v[20:23]
    buffer_load_dwordx4 v[160:163], v2, s[12:15], s31 offen offset:1024
    v_mfma_f32_16x16x32_bf16 v[24:27], v[44:47], v[100:103], v[24:27]
    v_mfma_f32_16x16x32_bf16 v[28:31], v[48:51], v[100:103], v[28:31]
    buffer_load_dwordx4 v[164:167], v2, s[12:15], s31 offen offset:2048
    v_mfma_f32_16x16x32_bf16 v[32:35], v[52:55], v[100:103], v[32:35]
    buffer_load_dwordx4 v[168:171], v2, s[12:15], s31 offen offset:3072
    s_waitcnt lgkmcnt(0)
    v_mfma_f32_16x16x32_bf16 v[16:19], v[56:59], v[104:107], v[16:19]
    v_mfma_f32_16x16x32_bf16 v[20:23], v[60:63], v[104:107], v[20:23]
    v_mfma_f32_16x16x32_bf16 v[24:27], v[64:67], v[104:107], v[24:27]
    v_mfma_f32_16x16x32_bf16 v[28:31], v[68:71], v[104:107], v[28:31]
    v_mfma_f32_16x16x32_bf16 v[32:35], v[72:75], v[104:107], v[32:35]
    s_waitcnt vmcnt(27)
    s_barrier
    ds_read_b128 v[36:39], v2 offset:40960
    ds_read_b128 v[40:43], v2 offset:41984
    ds_read_b128 v[44:47], v2 offset:43008
    ds_read_b128 v[48:51], v2 offset:44032
    ds_read_b128 v[52:55], v2 offset:45056
    ds_read_b128 v[56:59], v2 offset:46080
    ds_read_b128 v[60:63], v2 offset:47104
    ds_read_b128 v[64:67], v2 offset:48128
    ds_read_b128 v[68:71], v2 offset:49152
    ds_read_b128 v[72:75], v2 offset:50176
    s_waitcnt lgkmcnt(5)
    v_mfma_f32_16x16x32_bf16 v[16:19], v[36:39], v[108:111], v[16:19]
    v_mfma_f32_16x16x32_bf16 v[20:23], v[40:43], v[108:111], v[20:23]
    v_and_b32 v5, 15, v1
    s_lshl_b32 s32, s8, 4
    v_add_u32 v5, s32, v5
    v_lshrrev_b32 v6, 4, v1
    v_lshrrev_b32 v7, 1, v5
    v_mul_u32_u24 v7, 2560, v7
    v_lshl_add_u32 v7, v6, 4, v7
    v_lshlrev_b32 v8, 3, v6
    v_mul_u32_u24 v9, 1280, v5
    v_add_u32 v9, v9, v8
    v_and_b32 v10, 1, v5
    v_lshlrev_b32 v10, 4, v10
    s_mul_i32 s33, s9, 320
    s_mul_i32 s34, s9, 160
    buffer_load_dwordx4 v[176:179], v7, s[36:39], s33 offen offset:0
    v_mfma_f32_16x16x32_bf16 v[24:27], v[44:47], v[108:111], v[24:27]
    v_mfma_f32_16x16x32_bf16 v[28:31], v[48:51], v[108:111], v[28:31]
    buffer_load_dwordx2 v[196:197], v8, s[24:27], s34 offen offset:0
    v_mfma_f32_16x16x32_bf16 v[32:35], v[52:55], v[108:111], v[32:35]
    buffer_load_dwordx4 v[180:183], v7, s[36:39], s33 offen offset:64
    ds_read_b128 v[36:39], v2 offset:51200
    ds_read_b128 v[40:43], v2 offset:52224
    ds_read_b128 v[44:47], v2 offset:53248
    ds_read_b128 v[48:51], v2 offset:54272
    ds_read_b128 v[52:55], v2 offset:55296
    s_waitcnt lgkmcnt(5)
    v_mfma_f32_16x16x32_bf16 v[16:19], v[56:59], v[112:115], v[16:19]
    v_mfma_f32_16x16x32_bf16 v[20:23], v[60:63], v[112:115], v[20:23]
    buffer_load_dwordx2 v[198:199], v8, s[24:27], s34 offen offset:32
    v_mfma_f32_16x16x32_bf16 v[24:27], v[64:67], v[112:115], v[24:27]
    v_mfma_f32_16x16x32_bf16 v[28:31], v[68:71], v[112:115], v[28:31]
    buffer_load_dwordx4 v[184:187], v7, s[36:39], s33 offen offset:128
    v_mfma_f32_16x16x32_bf16 v[32:35], v[72:75], v[112:115], v[32:35]
    buffer_load_dwordx2 v[200:201], v8, s[24:27], s34 offen offset:64
    ds_read_b128 v[56:59], v2 offset:56320
    ds_read_b128 v[60:63], v2 offset:57344
    ds_read_b128 v[64:67], v2 offset:58368
    ds_read_b128 v[68:71], v2 offset:59392
    ds_read_b128 v[72:75], v2 offset:60416
    s_waitcnt lgkmcnt(5)
    v_mfma_f32_16x16x32_bf16 v[16:19], v[36:39], v[116:119], v[16:19]
    v_mfma_f32_16x16x32_bf16 v[20:23], v[40:43], v[116:119], v[20:23]
    buffer_load_dwordx4 v[188:191], v7, s[36:39], s33 offen offset:192
    v_mfma_f32_16x16x32_bf16 v[24:27], v[44:47], v[116:119], v[24:27]
    v_mfma_f32_16x16x32_bf16 v[28:31], v[48:51], v[116:119], v[28:31]
    buffer_load_dwordx2 v[202:203], v8, s[24:27], s34 offen offset:96
    v_mfma_f32_16x16x32_bf16 v[32:35], v[52:55], v[116:119], v[32:35]
    buffer_load_dwordx4 v[192:195], v7, s[36:39], s33 offen offset:256
    s_waitcnt lgkmcnt(0)
    v_mfma_f32_16x16x32_bf16 v[16:19], v[56:59], v[120:123], v[16:19]
    v_mfma_f32_16x16x32_bf16 v[20:23], v[60:63], v[120:123], v[20:23]
    buffer_load_dwordx2 v[204:205], v8, s[24:27], s34 offen offset:128
    v_mfma_f32_16x16x32_bf16 v[24:27], v[64:67], v[120:123], v[24:27]
    v_mfma_f32_16x16x32_bf16 v[28:31], v[68:71], v[120:123], v[28:31]
    v_mfma_f32_16x16x32_bf16 v[32:35], v[72:75], v[120:123], v[32:35]
    s_waitcnt vmcnt(28)
    s_barrier
    ds_read_b128 v[36:39], v3 offset:0
    ds_read_b128 v[40:43], v3 offset:1024
    ds_read_b128 v[44:47], v3 offset:2048
    ds_read_b128 v[48:51], v3 offset:3072
    ds_read_b128 v[52:55], v3 offset:4096
    ds_read_b128 v[56:59], v3 offset:5120
    ds_read_b128 v[60:63], v3 offset:6144
    ds_read_b128 v[64:67], v3 offset:7168
    ds_read_b128 v[68:71], v3 offset:8192
    ds_read_b128 v[72:75], v3 offset:9216
    s_waitcnt lgkmcnt(5)
    v_mfma_f32_16x16x32_bf16 v[16:19], v[36:39], v[124:127], v[16:19]
    v_mfma_f32_16x16x32_bf16 v[20:23], v[40:43], v[124:127], v[20:23]
    v_mfma_f32_16x16x32_bf16 v[24:27], v[44:47], v[124:127], v[24:27]
    v_mfma_f32_16x16x32_bf16 v[28:31], v[48:51], v[124:127], v[28:31]
    v_mfma_f32_16x16x32_bf16 v[32:35], v[52:55], v[124:127], v[32:35]
    ds_read_b128 v[36:39], v3 offset:10240
    ds_read_b128 v[40:43], v3 offset:11264
    ds_read_b128 v[44:47], v3 offset:12288
    ds_read_b128 v[48:51], v3 offset:13312
    ds_read_b128 v[52:55], v3 offset:14336
    s_waitcnt lgkmcnt(5)
    v_mfma_f32_16x16x32_bf16 v[16:19], v[56:59], v[128:131], v[16:19]
    v_mfma_f32_16x16x32_bf16 v[20:23], v[60:63], v[128:131], v[20:23]
    v_mfma_f32_16x16x32_bf16 v[24:27], v[64:67], v[128:131], v[24:27]
    v_mfma_f32_16x16x32_bf16 v[28:31], v[68:71], v[128:131], v[28:31]
    v_mfma_f32_16x16x32_bf16 v[32:35], v[72:75], v[128:131], v[32:35]
    ds_read_b128 v[56:59], v3 offset:15360
    ds_read_b128 v[60:63], v3 offset:16384
    ds_read_b128 v[64:67], v3 offset:17408
    ds_read_b128 v[68:71], v3 offset:18432
    ds_read_b128 v[72:75], v3 offset:19456
    s_waitcnt lgkmcnt(5)
    v_mfma_f32_16x16x32_bf16 v[16:19], v[36:39], v[132:135], v[16:19]
    v_mfma_f32_16x16x32_bf16 v[20:23], v[40:43], v[132:135], v[20:23]
    v_mfma_f32_16x16x32_bf16 v[24:27], v[44:47], v[132:135], v[24:27]
    v_mfma_f32_16x16x32_bf16 v[28:31], v[48:51], v[132:135], v[28:31]
    v_mfma_f32_16x16x32_bf16 v[32:35], v[52:55], v[132:135], v[32:35]
    s_waitcnt lgkmcnt(0)
    v_mfma_f32_16x16x32_bf16 v[16:19], v[56:59], v[136:139], v[16:19]
    v_mfma_f32_16x16x32_bf16 v[20:23], v[60:63], v[136:139], v[20:23]
    v_mfma_f32_16x16x32_bf16 v[24:27], v[64:67], v[136:139], v[24:27]
    v_mfma_f32_16x16x32_bf16 v[28:31], v[68:71], v[136:139], v[28:31]
    v_mfma_f32_16x16x32_bf16 v[32:35], v[72:75], v[136:139], v[32:35]
    s_waitcnt vmcnt(19)
    s_barrier
    ds_read_b128 v[36:39], v3 offset:20480
    ds_read_b128 v[40:43], v3 offset:21504
    ds_read_b128 v[44:47], v3 offset:22528
    ds_read_b128 v[48:51], v3 offset:23552
    ds_read_b128 v[52:55], v3 offset:24576
    ds_read_b128 v[56:59], v3 offset:25600
    ds_read_b128 v[60:63], v3 offset:26624
    ds_read_b128 v[64:67], v3 offset:27648
    ds_read_b128 v[68:71], v3 offset:28672
    ds_read_b128 v[72:75], v3 offset:29696
    s_waitcnt lgkmcnt(5)
    v_mfma_f32_16x16x32_bf16 v[16:19], v[36:39], v[140:143], v[16:19]
    v_mfma_f32_16x16x32_bf16 v[20:23], v[40:43], v[140:143], v[20:23]
    v_mfma_f32_16x16x32_bf16 v[24:27], v[44:47], v[140:143], v[24:27]
    v_mfma_f32_16x16x32_bf16 v[28:31], v[48:51], v[140:143], v[28:31]
    v_mfma_f32_16x16x32_bf16 v[32:35], v[52:55], v[140:143], v[32:35]
    ds_read_b128 v[36:39], v3 offset:30720
    ds_read_b128 v[40:43], v3 offset:31744
    ds_read_b128 v[44:47], v3 offset:32768
    ds_read_b128 v[48:51], v3 offset:33792
    ds_read_b128 v[52:55], v3 offset:34816
    s_waitcnt lgkmcnt(5)
    v_mfma_f32_16x16x32_bf16 v[16:19], v[56:59], v[144:147], v[16:19]
    v_mfma_f32_16x16x32_bf16 v[20:23], v[60:63], v[144:147], v[20:23]
    v_mfma_f32_16x16x32_bf16 v[24:27], v[64:67], v[144:147], v[24:27]
    v_mfma_f32_16x16x32_bf16 v[28:31], v[68:71], v[144:147], v[28:31]
    v_mfma_f32_16x16x32_bf16 v[32:35], v[72:75], v[144:147], v[32:35]
    ds_read_b128 v[56:59], v3 offset:35840
    ds_read_b128 v[60:63], v3 offset:36864
    ds_read_b128 v[64:67], v3 offset:37888
    ds_read_b128 v[68:71], v3 offset:38912
    ds_read_b128 v[72:75], v3 offset:39936
    s_waitcnt lgkmcnt(5)
    v_mfma_f32_16x16x32_bf16 v[16:19], v[36:39], v[148:151], v[16:19]
    v_mfma_f32_16x16x32_bf16 v[20:23], v[40:43], v[148:151], v[20:23]
    v_mfma_f32_16x16x32_bf16 v[24:27], v[44:47], v[148:151], v[24:27]
    v_mfma_f32_16x16x32_bf16 v[28:31], v[48:51], v[148:151], v[28:31]
    v_mfma_f32_16x16x32_bf16 v[32:35], v[52:55], v[148:151], v[32:35]
    s_waitcnt lgkmcnt(0)
    v_mfma_f32_16x16x32_bf16 v[16:19], v[56:59], v[152:155], v[16:19]
    v_mfma_f32_16x16x32_bf16 v[20:23], v[60:63], v[152:155], v[20:23]
    v_mfma_f32_16x16x32_bf16 v[24:27], v[64:67], v[152:155], v[24:27]
    v_mfma_f32_16x16x32_bf16 v[28:31], v[68:71], v[152:155], v[28:31]
    v_mfma_f32_16x16x32_bf16 v[32:35], v[72:75], v[152:155], v[32:35]
    s_waitcnt vmcnt(10)
    s_barrier
    ds_read_b128 v[36:39], v3 offset:40960
    ds_read_b128 v[40:43], v3 offset:41984
    ds_read_b128 v[44:47], v3 offset:43008
    ds_read_b128 v[48:51], v3 offset:44032
    ds_read_b128 v[52:55], v3 offset:45056
    ds_read_b128 v[56:59], v3 offset:46080
    ds_read_b128 v[60:63], v3 offset:47104
    ds_read_b128 v[64:67], v3 offset:48128
    ds_read_b128 v[68:71], v3 offset:49152
    ds_read_b128 v[72:75], v3 offset:50176
    s_waitcnt lgkmcnt(5)
    v_mfma_f32_16x16x32_bf16 v[16:19], v[36:39], v[156:159], v[16:19]
    v_mfma_f32_16x16x32_bf16 v[20:23], v[40:43], v[156:159], v[20:23]
    v_mfma_f32_16x16x32_bf16 v[24:27], v[44:47], v[156:159], v[24:27]
    v_mfma_f32_16x16x32_bf16 v[28:31], v[48:51], v[156:159], v[28:31]
    v_mfma_f32_16x16x32_bf16 v[32:35], v[52:55], v[156:159], v[32:35]
    ds_read_b128 v[36:39], v3 offset:51200
    ds_read_b128 v[40:43], v3 offset:52224
    ds_read_b128 v[44:47], v3 offset:53248
    ds_read_b128 v[48:51], v3 offset:54272
    ds_read_b128 v[52:55], v3 offset:55296
    s_waitcnt lgkmcnt(5)
    v_mfma_f32_16x16x32_bf16 v[16:19], v[56:59], v[160:163], v[16:19]
    v_mfma_f32_16x16x32_bf16 v[20:23], v[60:63], v[160:163], v[20:23]
    v_mfma_f32_16x16x32_bf16 v[24:27], v[64:67], v[160:163], v[24:27]
    v_mfma_f32_16x16x32_bf16 v[28:31], v[68:71], v[160:163], v[28:31]
    v_mfma_f32_16x16x32_bf16 v[32:35], v[72:75], v[160:163], v[32:35]
    ds_read_b128 v[56:59], v3 offset:56320
    ds_read_b128 v[60:63], v3 offset:57344
    ds_read_b128 v[64:67], v3 offset:58368
    ds_read_b128 v[68:71], v3 offset:59392
    ds_read_b128 v[72:75], v3 offset:60416
    s_waitcnt lgkmcnt(5)
    v_mfma_f32_16x16x32_bf16 v[16:19], v[36:39], v[164:167], v[16:19]
    v_mfma_f32_16x16x32_bf16 v[20:23], v[40:43], v[164:167], v[20:23]
    v_mfma_f32_16x16x32_bf16 v[24:27], v[44:47], v[164:167], v[24:27]
    v_mfma_f32_16x16x32_bf16 v[28:31], v[48:51], v[164:167], v[28:31]
    v_mfma_f32_16x16x32_bf16 v[32:35], v[52:55], v[164:167], v[32:35]
    s_waitcnt lgkmcnt(0)
    v_mfma_f32_16x16x32_bf16 v[16:19], v[56:59], v[168:171], v[16:19]
    v_mfma_f32_16x16x32_bf16 v[20:23], v[60:63], v[168:171], v[20:23]
    v_mfma_f32_16x16x32_bf16 v[24:27], v[64:67], v[168:171], v[24:27]
    v_mfma_f32_16x16x32_bf16 v[28:31], v[68:71], v[168:171], v[28:31]
    v_mfma_f32_16x16x32_bf16 v[32:35], v[72:75], v[168:171], v[32:35]
    s_waitcnt vmcnt(0)
    s_nop 9
    v_cvt_pk_bf16_f32 v14, v16, v17
    v_lshlrev_b32 v16, 16, v14
    v_and_b32 v17, 0xffff0000, v14
    v_lshlrev_b32 v12, 16, v196
    v_and_b32 v13, 0xffff0000, v196
    v_pk_add_f32 v[16:17], v[16:17], v[12:13]
    v_cvt_pk_bf16_f32 v14, v16, v17
    v_lshlrev_b32 v16, 16, v14
    v_and_b32 v17, 0xffff0000, v14
    v_lshrrev_b32 v12, v10, v176
    v_lshrrev_b32 v13, v10, v177
    v_lshlrev_b32 v12, 16, v12
    v_lshlrev_b32 v13, 16, v13
    v_pk_add_f32 v[16:17], v[16:17], v[12:13]
    v_cvt_pk_bf16_f32 v196, v16, v17
    v_cvt_pk_bf16_f32 v14, v18, v19
    v_lshlrev_b32 v18, 16, v14
    v_and_b32 v19, 0xffff0000, v14
    v_lshlrev_b32 v12, 16, v197
    v_and_b32 v13, 0xffff0000, v197
    v_pk_add_f32 v[18:19], v[18:19], v[12:13]
    v_cvt_pk_bf16_f32 v14, v18, v19
    v_lshlrev_b32 v18, 16, v14
    v_and_b32 v19, 0xffff0000, v14
    v_lshrrev_b32 v12, v10, v178
    v_lshrrev_b32 v13, v10, v179
    v_lshlrev_b32 v12, 16, v12
    v_lshlrev_b32 v13, 16, v13
    v_pk_add_f32 v[18:19], v[18:19], v[12:13]
    v_cvt_pk_bf16_f32 v197, v18, v19
    buffer_store_dwordx2 v[196:197], v9, s[20:23], s34 offen offset:0
    v_cvt_pk_bf16_f32 v14, v20, v21
    v_lshlrev_b32 v20, 16, v14
    v_and_b32 v21, 0xffff0000, v14
    v_lshlrev_b32 v12, 16, v198
    v_and_b32 v13, 0xffff0000, v198
    v_pk_add_f32 v[20:21], v[20:21], v[12:13]
    v_cvt_pk_bf16_f32 v14, v20, v21
    v_lshlrev_b32 v20, 16, v14
    v_and_b32 v21, 0xffff0000, v14
    v_lshrrev_b32 v12, v10, v180
    v_lshrrev_b32 v13, v10, v181
    v_lshlrev_b32 v12, 16, v12
    v_lshlrev_b32 v13, 16, v13
    v_pk_add_f32 v[20:21], v[20:21], v[12:13]
    v_cvt_pk_bf16_f32 v198, v20, v21
    v_cvt_pk_bf16_f32 v14, v22, v23
    v_lshlrev_b32 v22, 16, v14
    v_and_b32 v23, 0xffff0000, v14
    v_lshlrev_b32 v12, 16, v199
    v_and_b32 v13, 0xffff0000, v199
    v_pk_add_f32 v[22:23], v[22:23], v[12:13]
    v_cvt_pk_bf16_f32 v14, v22, v23
    v_lshlrev_b32 v22, 16, v14
    v_and_b32 v23, 0xffff0000, v14
    v_lshrrev_b32 v12, v10, v182
    v_lshrrev_b32 v13, v10, v183
    v_lshlrev_b32 v12, 16, v12
    v_lshlrev_b32 v13, 16, v13
    v_pk_add_f32 v[22:23], v[22:23], v[12:13]
    v_cvt_pk_bf16_f32 v199, v22, v23
    buffer_store_dwordx2 v[198:199], v9, s[20:23], s34 offen offset:32
    v_cvt_pk_bf16_f32 v14, v24, v25
    v_lshlrev_b32 v24, 16, v14
    v_and_b32 v25, 0xffff0000, v14
    v_lshlrev_b32 v12, 16, v200
    v_and_b32 v13, 0xffff0000, v200
    v_pk_add_f32 v[24:25], v[24:25], v[12:13]
    v_cvt_pk_bf16_f32 v14, v24, v25
    v_lshlrev_b32 v24, 16, v14
    v_and_b32 v25, 0xffff0000, v14
    v_lshrrev_b32 v12, v10, v184
    v_lshrrev_b32 v13, v10, v185
    v_lshlrev_b32 v12, 16, v12
    v_lshlrev_b32 v13, 16, v13
    v_pk_add_f32 v[24:25], v[24:25], v[12:13]
    v_cvt_pk_bf16_f32 v200, v24, v25
    v_cvt_pk_bf16_f32 v14, v26, v27
    v_lshlrev_b32 v26, 16, v14
    v_and_b32 v27, 0xffff0000, v14
    v_lshlrev_b32 v12, 16, v201
    v_and_b32 v13, 0xffff0000, v201
    v_pk_add_f32 v[26:27], v[26:27], v[12:13]
    v_cvt_pk_bf16_f32 v14, v26, v27
    v_lshlrev_b32 v26, 16, v14
    v_and_b32 v27, 0xffff0000, v14
    v_lshrrev_b32 v12, v10, v186
    v_lshrrev_b32 v13, v10, v187
    v_lshlrev_b32 v12, 16, v12
    v_lshlrev_b32 v13, 16, v13
    v_pk_add_f32 v[26:27], v[26:27], v[12:13]
    v_cvt_pk_bf16_f32 v201, v26, v27
    buffer_store_dwordx2 v[200:201], v9, s[20:23], s34 offen offset:64
    v_cvt_pk_bf16_f32 v14, v28, v29
    v_lshlrev_b32 v28, 16, v14
    v_and_b32 v29, 0xffff0000, v14
    v_lshlrev_b32 v12, 16, v202
    v_and_b32 v13, 0xffff0000, v202
    v_pk_add_f32 v[28:29], v[28:29], v[12:13]
    v_cvt_pk_bf16_f32 v14, v28, v29
    v_lshlrev_b32 v28, 16, v14
    v_and_b32 v29, 0xffff0000, v14
    v_lshrrev_b32 v12, v10, v188
    v_lshrrev_b32 v13, v10, v189
    v_lshlrev_b32 v12, 16, v12
    v_lshlrev_b32 v13, 16, v13
    v_pk_add_f32 v[28:29], v[28:29], v[12:13]
    v_cvt_pk_bf16_f32 v202, v28, v29
    v_cvt_pk_bf16_f32 v14, v30, v31
    v_lshlrev_b32 v30, 16, v14
    v_and_b32 v31, 0xffff0000, v14
    v_lshlrev_b32 v12, 16, v203
    v_and_b32 v13, 0xffff0000, v203
    v_pk_add_f32 v[30:31], v[30:31], v[12:13]
    v_cvt_pk_bf16_f32 v14, v30, v31
    v_lshlrev_b32 v30, 16, v14
    v_and_b32 v31, 0xffff0000, v14
    v_lshrrev_b32 v12, v10, v190
    v_lshrrev_b32 v13, v10, v191
    v_lshlrev_b32 v12, 16, v12
    v_lshlrev_b32 v13, 16, v13
    v_pk_add_f32 v[30:31], v[30:31], v[12:13]
    v_cvt_pk_bf16_f32 v203, v30, v31
    buffer_store_dwordx2 v[202:203], v9, s[20:23], s34 offen offset:96
    v_cvt_pk_bf16_f32 v14, v32, v33
    v_lshlrev_b32 v32, 16, v14
    v_and_b32 v33, 0xffff0000, v14
    v_lshlrev_b32 v12, 16, v204
    v_and_b32 v13, 0xffff0000, v204
    v_pk_add_f32 v[32:33], v[32:33], v[12:13]
    v_cvt_pk_bf16_f32 v14, v32, v33
    v_lshlrev_b32 v32, 16, v14
    v_and_b32 v33, 0xffff0000, v14
    v_lshrrev_b32 v12, v10, v192
    v_lshrrev_b32 v13, v10, v193
    v_lshlrev_b32 v12, 16, v12
    v_lshlrev_b32 v13, 16, v13
    v_pk_add_f32 v[32:33], v[32:33], v[12:13]
    v_cvt_pk_bf16_f32 v204, v32, v33
    v_cvt_pk_bf16_f32 v14, v34, v35
    v_lshlrev_b32 v34, 16, v14
    v_and_b32 v35, 0xffff0000, v14
    v_lshlrev_b32 v12, 16, v205
    v_and_b32 v13, 0xffff0000, v205
    v_pk_add_f32 v[34:35], v[34:35], v[12:13]
    v_cvt_pk_bf16_f32 v14, v34, v35
    v_lshlrev_b32 v34, 16, v14
    v_and_b32 v35, 0xffff0000, v14
    v_lshrrev_b32 v12, v10, v194
    v_lshrrev_b32 v13, v10, v195
    v_lshlrev_b32 v12, 16, v12
    v_lshlrev_b32 v13, 16, v13
    v_pk_add_f32 v[34:35], v[34:35], v[12:13]
    v_cvt_pk_bf16_f32 v205, v34, v35
    buffer_store_dwordx2 v[204:205], v9, s[20:23], s34 offen offset:128
K5_end:
    s_endpgm
.p2align 8
.type twr,@object
twr:
    .long 0x3f800000, 0x80000000
    .long 0x3f7ffcd7, 0xbc20d8d2
    .long 0x3f7ff35e, 0xbca0d6d6
    .long 0x3f7fe394, 0xbcf13d4c
    .long 0x3f7fcd79, 0xbd20cee7
    .long 0x3f7fb10f, 0xbd48fb30
    .long 0x3f7f8e56, 0xbd712283
    .long 0x3f7f654e, 0xbd8ca1f2
    .long 0x3f7f35f9, 0xbda0af2a
    .long 0x3f7f0059, 0xbdb4b86a
    .long 0x3f7ec46d, 0xbdc8bd36
    .long 0x3f7e8238, 0xbddcbd0d
    .long 0x3f7e39bc, 0xbdf0b772
    .long 0x3f7deafa, 0xbe0255f4
    .long 0x3f7d95f4, 0xbe0c4cf7
    .long 0x3f7d3aac, 0xbe164083
    .long 0x3f7cd925, 0xbe20305b
    .long 0x3f7c7160, 0xbe2a1c3f
    .long 0x3f7c0361, 0xbe3403f1
    .long 0x3f7b8f2a, 0xbe3de731
    .long 0x3f7b14be, 0xbe47c5c2
    .long 0x3f7a9421, 0xbe519f65
    .long 0x3f7a0d54, 0xbe5b73dc
    .long 0x3f79805c, 0xbe6542e9
    .long 0x3f78ed3c, 0xbe6f0c4d
    .long 0x3f7853f8, 0xbe78cfcc
    .long 0x3f77b493, 0xbe814693
    .long 0x3f770f11, 0xbe862210
    .long 0x3f766377, 0xbe8afa3e
    .long 0x3f75b1c9, 0xbe8fcefe
    .long 0x3f74fa0b, 0xbe94a031
    .long 0x3f743c41, 0xbe996dba
    .long 0x3f737871, 0xbe9e377a
    .long 0x3f72ae9e, 0xbea2fd52
    .long 0x3f71decf, 0xbea7bf25
    .long 0x3f710908, 0xbeac7cd4
    .long 0x3f702d4f, 0xbeb13641
    .long 0x3f6f4ba8, 0xbeb5eb4f
    .long 0x3f6e641a, 0xbeba9be1
    .long 0x3f6d76aa, 0xbebf47d7
    .long 0x3f6c835e, 0xbec3ef15
    .long 0x3f6b8a3d, 0xbec8917e
    .long 0x3f6a8b4b, 0xbecd2ef3
    .long 0x3f698690, 0xbed1c759
    .long 0x3f687c12, 0xbed65a92
    .long 0x3f676bd8, 0xbedae880
    .long 0x3f6655e7, 0xbedf7108
    .long 0x3f653a48, 0xbee3f40d
    .long 0x3f641901, 0xbee87171
    .long 0x3f62f219, 0xbeece91a
    .long 0x3f61c598, 0xbef15aea
    .long 0x3f609384, 0xbef5c6c5
    .long 0x3f5f5be6, 0xbefa2c90
    .long 0x3f5e1ec5, 0xbefe8c2f
    .long 0x3f5cdc29, 0xbf0172c3
    .long 0x3f5b941a, 0xbf039c3d
    .long 0x3f5a46a0, 0xbf05c277
    .long 0x3f58f3c4, 0xbf07e565
    .long 0x3f579b8c, 0xbf0a04f8
    .long 0x3f563e03, 0xbf0c2124
    .long 0x3f54db31, 0xbf0e39da
    .long 0x3f53731f, 0xbf104f0e
    .long 0x3f5205d4, 0xbf1260b2
    .long 0x3f50935b, 0xbf146eba
    .long 0x3f800000, 0x80000000
    .long 0x3f7ff35e, 0xbca0d6d6
    .long 0x3f7fcd79, 0xbd20cee7
    .long 0x3f7f8e56, 0xbd712283
    .long 0x3f7f35f9, 0xbda0af2a
    .long 0x3f7ec46d, 0xbdc8bd36
    .long 0x3f7e39bc, 0xbdf0b772
    .long 0x3f7d95f4, 0xbe0c4cf7
    .long 0x3f7cd925, 0xbe20305b
    .long 0x3f7c0361, 0xbe3403f1
    .long 0x3f7b14be, 0xbe47c5c2
    .long 0x3f7a0d54, 0xbe5b73dc
    .long 0x3f78ed3c, 0xbe6f0c4d
    .long 0x3f77b493, 0xbe814693
    .long 0x3f766377, 0xbe8afa3e
    .long 0x3f74fa0b, 0xbe94a031
    .long 0x3f737871, 0xbe9e377a
    .long 0x3f71decf, 0xbea7bf25
    .long 0x3f702d4f, 0xbeb13641
    .long 0x3f6e641a, 0xbeba9be1
    .long 0x3f6c835e, 0xbec3ef15
    .long 0x3f6a8b4b, 0xbecd2ef3
    .long 0x3f687c12, 0xbed65a92
    .long 0x3f6655e7, 0xbedf7108
    .long 0x3f641901, 0xbee87171
    .long 0x3f61c598, 0xbef15aea
    .long 0x3f5f5be6, 0xbefa2c90
    .long 0x3f5cdc29, 0xbf0172c3
    .long 0x3f5a46a0, 0xbf05c277
    .long 0x3f579b8c, 0xbf0a04f8
    .long 0x3f54db31, 0xbf0e39da
    .long 0x3f5205d4, 0xbf1260b2
    .long 0x3f4f1bbd, 0xbf167918
    .long 0x3f4c1d35, 0xbf1a82a4
    .long 0x3f490a88, 0xbf1e7cf1
    .long 0x3f45e403, 0xbf226799
    .long 0x3f42a9f7, 0xbf26423a
    .long 0x3f3f5cb5, 0xbf2a0c73
    .long 0x3f3bfc8f, 0xbf2dc5e3
    .long 0x3f3889dc, 0xbf316e2c
    .long 0x3f3504f3, 0xbf3504f3
    .long 0x3f316e2c, 0xbf3889dc
    .long 0x3f2dc5e3, 0xbf3bfc8f
    .long 0x3f2a0c73, 0xbf3f5cb5
    .long 0x3f26423a, 0xbf42a9f7
    .long 0x3f226799, 0xbf45e403
    .long 0x3f1e7cf1, 0xbf490a88
    .long 0x3f1a82a4, 0xbf4c1d35
    .long 0x3f167918, 0xbf4f1bbd
    .long 0x3f1260b2, 0xbf5205d4
    .long 0x3f0e39da, 0xbf54db31
    .long 0x3f0a04f8, 0xbf579b8c
    .long 0x3f05c277, 0xbf5a46a0
    .long 0x3f0172c3, 0xbf5cdc29
    .long 0x3efa2c90, 0xbf5f5be6
    .long 0x3ef15aea, 0xbf61c598
    .long 0x3ee87171, 0xbf641901
    .long 0x3edf7108, 0xbf6655e7
    .long 0x3ed65a92, 0xbf687c12
    .long 0x3ecd2ef3, 0xbf6a8b4b
    .long 0x3ec3ef15, 0xbf6c835e
    .long 0x3eba9be1, 0xbf6e641a
    .long 0x3eb13641, 0xbf702d4f
    .long 0x3ea7bf25, 0xbf71decf
    .long 0x3f800000, 0x80000000
    .long 0x3f7fe394, 0xbcf13d4c
    .long 0x3f7f8e56, 0xbd712283
    .long 0x3f7f0059, 0xbdb4b86a
    .long 0x3f7e39bc, 0xbdf0b772
    .long 0x3f7d3aac, 0xbe164083
    .long 0x3f7c0361, 0xbe3403f1
    .long 0x3f7a9421, 0xbe519f65
    .long 0x3f78ed3c, 0xbe6f0c4d
    .long 0x3f770f11, 0xbe862210
    .long 0x3f74fa0b, 0xbe94a031
    .long 0x3f72ae9e, 0xbea2fd52
    .long 0x3f702d4f, 0xbeb13641
    .long 0x3f6d76aa, 0xbebf47d7
    .long 0x3f6a8b4b, 0xbecd2ef3
    .long 0x3f676bd8, 0xbedae880
    .long 0x3f641901, 0xbee87171
    .long 0x3f609384, 0xbef5c6c5
    .long 0x3f5cdc29, 0xbf0172c3
    .long 0x3f58f3c4, 0xbf07e565
    .long 0x3f54db31, 0xbf0e39da
    .long 0x3f50935b, 0xbf146eba
    .long 0x3f4c1d35, 0xbf1a82a4
    .long 0x3f4779bc, 0xbf207440
    .long 0x3f42a9f7, 0xbf26423a
    .long 0x3f3daef9, 0xbf2beb4a
    .long 0x3f3889dc, 0xbf316e2c
    .long 0x3f333bc6, 0xbf36c9a9
    .long 0x3f2dc5e3, 0xbf3bfc8f
    .long 0x3f28296a, 0xbf4105b8
    .long 0x3f226799, 0xbf45e403
    .long 0x3f1c81b9, 0xbf4a965e
    .long 0x3f167918, 0xbf4f1bbd
    .long 0x3f104f0e, 0xbf53731f
    .long 0x3f0a04f8, 0xbf579b8c
    .long 0x3f039c3d, 0xbf5b941a
    .long 0x3efa2c90, 0xbf5f5be6
    .long 0x3eece91a, 0xbf62f219
    .long 0x3edf7108, 0xbf6655e7
    .long 0x3ed1c759, 0xbf698690
    .long 0x3ec3ef15, 0xbf6c835e
    .long 0x3eb5eb4f, 0xbf6f4ba8
    .long 0x3ea7bf25, 0xbf71decf
    .long 0x3e996dba, 0xbf743c41
    .long 0x3e8afa3e, 0xbf766377
    .long 0x3e78cfcc, 0xbf7853f8
    .long 0x3e5b73dc, 0xbf7a0d54
    .long 0x3e3de731, 0xbf7b8f2a
    .long 0x3e20305b, 0xbf7cd925
    .long 0x3e0255f4, 0xbf7deafa
    .long 0x3dc8bd36, 0xbf7ec46d
    .long 0x3d8ca1f2, 0xbf7f654e
    .long 0x3d20cee7, 0xbf7fcd79
    .long 0x3c20d8d2, 0xbf7ffcd7
    .long 0xbca0d6d6, 0xbf7ff35e
    .long 0xbd48fb30, 0xbf7fb10f
    .long 0xbda0af2a, 0xbf7f35f9
    .long 0xbddcbd0d, 0xbf7e8238
    .long 0xbe0c4cf7, 0xbf7d95f4
    .long 0xbe2a1c3f, 0xbf7c7160
    .long 0xbe47c5c2, 0xbf7b14be
    .long 0xbe6542e9, 0xbf79805c
    .long 0xbe814693, 0xbf77b493
    .long 0xbe8fcefe, 0xbf75b1c9
    .long 0x3f800000, 0x80000000
    .long 0x3f7fcd79, 0xbd20cee7
    .long 0x3f7f35f9, 0xbda0af2a
    .long 0x3f7e39bc, 0xbdf0b772
    .long 0x3f7cd925, 0xbe20305b
    .long 0x3f7b14be, 0xbe47c5c2
    .long 0x3f78ed3c, 0xbe6f0c4d
    .long 0x3f766377, 0xbe8afa3e
    .long 0x3f737871, 0xbe9e377a
    .long 0x3f702d4f, 0xbeb13641
    .long 0x3f6c835e, 0xbec3ef15
    .long 0x3f687c12, 0xbed65a92
    .long 0x3f641901, 0xbee87171
    .long 0x3f5f5be6, 0xbefa2c90
    .long 0x3f5a46a0, 0xbf05c277
    .long 0x3f54db31, 0xbf0e39da
    .long 0x3f4f1bbd, 0xbf167918
    .long 0x3f490a88, 0xbf1e7cf1
    .long 0x3f42a9f7, 0xbf26423a
    .long 0x3f3bfc8f, 0xbf2dc5e3
    .long 0x3f3504f3, 0xbf3504f3
    .long 0x3f2dc5e3, 0xbf3bfc8f
    .long 0x3f26423a, 0xbf42a9f7
    .long 0x3f1e7cf1, 0xbf490a88
    .long 0x3f167918, 0xbf4f1bbd
    .long 0x3f0e39da, 0xbf54db31
    .long 0x3f05c277, 0xbf5a46a0
    .long 0x3efa2c90, 0xbf5f5be6
    .long 0x3ee87171, 0xbf641901
    .long 0x3ed65a92, 0xbf687c12
    .long 0x3ec3ef15, 0xbf6c835e
    .long 0x3eb13641, 0xbf702d4f
    .long 0x3e9e377a, 0xbf737871
    .long 0x3e8afa3e, 0xbf766377
    .long 0x3e6f0c4d, 0xbf78ed3c
    .long 0x3e47c5c2, 0xbf7b14be
    .long 0x3e20305b, 0xbf7cd925
    .long 0x3df0b772, 0xbf7e39bc
    .long 0x3da0af2a, 0xbf7f35f9
    .long 0x3d20cee7, 0xbf7fcd79
    .long 0x248d3132, 0xbf800000
    .long 0xbd20cee7, 0xbf7fcd79
    .long 0xbda0af2a, 0xbf7f35f9
    .long 0xbdf0b772, 0xbf7e39bc
    .long 0xbe20305b, 0xbf7cd925
    .long 0xbe47c5c2, 0xbf7b14be
    .long 0xbe6f0c4d, 0xbf78ed3c
    .long 0xbe8afa3e, 0xbf766377
    .long 0xbe9e377a, 0xbf737871
    .long 0xbeb13641, 0xbf702d4f
    .long 0xbec3ef15, 0xbf6c835e
    .long 0xbed65a92, 0xbf687c12
    .long 0xbee87171, 0xbf641901
    .long 0xbefa2c90, 0xbf5f5be6
    .long 0xbf05c277, 0xbf5a46a0
    .long 0xbf0e39da, 0xbf54db31
    .long 0xbf167918, 0xbf4f1bbd
    .long 0xbf1e7cf1, 0xbf490a88
    .long 0xbf26423a, 0xbf42a9f7
    .long 0xbf2dc5e3, 0xbf3bfc8f
    .long 0xbf3504f3, 0xbf3504f3
    .long 0xbf3bfc8f, 0xbf2dc5e3
    .long 0xbf42a9f7, 0xbf26423a
    .long 0xbf490a88, 0xbf1e7cf1
    .long 0x3f800000, 0x80000000
    .long 0x3f7fb10f, 0xbd48fb30
    .long 0x3f7ec46d, 0xbdc8bd36
    .long 0x3f7d3aac, 0xbe164083
    .long 0x3f7b14be, 0xbe47c5c2
    .long 0x3f7853f8, 0xbe78cfcc
    .long 0x3f74fa0b, 0xbe94a031
    .long 0x3f710908, 0xbeac7cd4
    .long 0x3f6c835e, 0xbec3ef15
    .long 0x3f676bd8, 0xbedae880
    .long 0x3f61c598, 0xbef15aea
    .long 0x3f5b941a, 0xbf039c3d
    .long 0x3f54db31, 0xbf0e39da
    .long 0x3f4d9f02, 0xbf187fc0
    .long 0x3f45e403, 0xbf226799
    .long 0x3f3daef9, 0xbf2beb4a
    .long 0x3f3504f3, 0xbf3504f3
    .long 0x3f2beb4a, 0xbf3daef9
    .long 0x3f226799, 0xbf45e403
    .long 0x3f187fc0, 0xbf4d9f02
    .long 0x3f0e39da, 0xbf54db31
    .long 0x3f039c3d, 0xbf5b941a
    .long 0x3ef15aea, 0xbf61c598
    .long 0x3edae880, 0xbf676bd8
    .long 0x3ec3ef15, 0xbf6c835e
    .long 0x3eac7cd4, 0xbf710908
    .long 0x3e94a031, 0xbf74fa0b
    .long 0x3e78cfcc, 0xbf7853f8
    .long 0x3e47c5c2, 0xbf7b14be
    .long 0x3e164083, 0xbf7d3aac
    .long 0x3dc8bd36, 0xbf7ec46d
    .long 0x3d48fb30, 0xbf7fb10f
    .long 0x248d3132, 0xbf800000
    .long 0xbd48fb30, 0xbf7fb10f
    .long 0xbdc8bd36, 0xbf7ec46d
    .long 0xbe164083, 0xbf7d3aac
    .long 0xbe47c5c2, 0xbf7b14be
    .long 0xbe78cfcc, 0xbf7853f8
    .long 0xbe94a031, 0xbf74fa0b
    .long 0xbeac7cd4, 0xbf710908
    .long 0xbec3ef15, 0xbf6c835e
    .long 0xbedae880, 0xbf676bd8
    .long 0xbef15aea, 0xbf61c598
    .long 0xbf039c3d, 0xbf5b941a
    .long 0xbf0e39da, 0xbf54db31
    .long 0xbf187fc0, 0xbf4d9f02
    .long 0xbf226799, 0xbf45e403
    .long 0xbf2beb4a, 0xbf3daef9
    .long 0xbf3504f3, 0xbf3504f3
    .long 0xbf3daef9, 0xbf2beb4a
    .long 0xbf45e403, 0xbf226799
    .long 0xbf4d9f02, 0xbf187fc0
    .long 0xbf54db31, 0xbf0e39da
    .long 0xbf5b941a, 0xbf039c3d
    .long 0xbf61c598, 0xbef15aea
    .long 0xbf676bd8, 0xbedae880
    .long 0xbf6c835e, 0xbec3ef15
    .long 0xbf710908, 0xbeac7cd4
    .long 0xbf74fa0b, 0xbe94a031
    .long 0xbf7853f8, 0xbe78cfcc
    .long 0xbf7b14be, 0xbe47c5c2
    .long 0xbf7d3aac, 0xbe164083
    .long 0xbf7ec46d, 0xbdc8bd36
    .long 0xbf7fb10f, 0xbd48fb30
    .long 0x3f800000, 0x80000000
    .long 0x3f7f8e56, 0xbd712283
    .long 0x3f7e39bc, 0xbdf0b772
    .long 0x3f7c0361, 0xbe3403f1
    .long 0x3f78ed3c, 0xbe6f0c4d
    .long 0x3f74fa0b, 0xbe94a031
    .long 0x3f702d4f, 0xbeb13641
    .long 0x3f6a8b4b, 0xbecd2ef3
    .long 0x3f641901, 0xbee87171
    .long 0x3f5cdc29, 0xbf0172c3
    .long 0x3f54db31, 0xbf0e39da
    .long 0x3f4c1d35, 0xbf1a82a4
    .long 0x3f42a9f7, 0xbf26423a
    .long 0x3f3889dc, 0xbf316e2c
    .long 0x3f2dc5e3, 0xbf3bfc8f
    .long 0x3f226799, 0xbf45e403
    .long 0x3f167918, 0xbf4f1bbd
    .long 0x3f0a04f8, 0xbf579b8c
    .long 0x3efa2c90, 0xbf5f5be6
    .long 0x3edf7108, 0xbf6655e7
    .long 0x3ec3ef15, 0xbf6c835e
    .long 0x3ea7bf25, 0xbf71decf
    .long 0x3e8afa3e, 0xbf766377
    .long 0x3e5b73dc, 0xbf7a0d54
    .long 0x3e20305b, 0xbf7cd925
    .long 0x3dc8bd36, 0xbf7ec46d
    .long 0x3d20cee7, 0xbf7fcd79
    .long 0xbca0d6d6, 0xbf7ff35e
    .long 0xbda0af2a, 0xbf7f35f9
    .long 0xbe0c4cf7, 0xbf7d95f4
    .long 0xbe47c5c2, 0xbf7b14be
    .long 0xbe814693, 0xbf77b493
    .long 0xbe9e377a, 0xbf737871
    .long 0xbeba9be1, 0xbf6e641a
    .long 0xbed65a92, 0xbf687c12
    .long 0xbef15aea, 0xbf61c598
    .long 0xbf05c277, 0xbf5a46a0
    .long 0xbf1260b2, 0xbf5205d4
    .long 0xbf1e7cf1, 0xbf490a88
    .long 0xbf2a0c73, 0xbf3f5cb5
    .long 0xbf3504f3, 0xbf3504f3
    .long 0xbf3f5cb5, 0xbf2a0c73
    .long 0xbf490a88, 0xbf1e7cf1
    .long 0xbf5205d4, 0xbf1260b2
    .long 0xbf5a46a0, 0xbf05c277
    .long 0xbf61c598, 0xbef15aea
    .long 0xbf687c12, 0xbed65a92
    .long 0xbf6e641a, 0xbeba9be1
    .long 0xbf737871, 0xbe9e377a
    .long 0xbf77b493, 0xbe814693
    .long 0xbf7b14be, 0xbe47c5c2
    .long 0xbf7d95f4, 0xbe0c4cf7
    .long 0xbf7f35f9, 0xbda0af2a
    .long 0xbf7ff35e, 0xbca0d6d6
    .long 0xbf7fcd79, 0x3d20cee7
    .long 0xbf7ec46d, 0x3dc8bd36
    .long 0xbf7cd925, 0x3e20305b
    .long 0xbf7a0d54, 0x3e5b73dc
    .long 0xbf766377, 0x3e8afa3e
    .long 0xbf71decf, 0x3ea7bf25
    .long 0xbf6c835e, 0x3ec3ef15
    .long 0xbf6655e7, 0x3edf7108
    .long 0xbf5f5be6, 0x3efa2c90
    .long 0xbf579b8c, 0x3f0a04f8
    .long 0x3f800000, 0x80000000
    .long 0x3f7f654e, 0xbd8ca1f2
    .long 0x3f7d95f4, 0xbe0c4cf7
    .long 0x3f7a9421, 0xbe519f65
    .long 0x3f766377, 0xbe8afa3e
    .long 0x3f710908, 0xbeac7cd4
    .long 0x3f6a8b4b, 0xbecd2ef3
    .long 0x3f62f219, 0xbeece91a
    .long 0x3f5a46a0, 0xbf05c277
    .long 0x3f50935b, 0xbf146eba
    .long 0x3f45e403, 0xbf226799
    .long 0x3f3a4582, 0xbf2f9c32
    .long 0x3f2dc5e3, 0xbf3bfc8f
    .long 0x3f207440, 0xbf4779bc
    .long 0x3f1260b2, 0xbf5205d4
    .long 0x3f039c3d, 0xbf5b941a
    .long 0x3ee87171, 0xbf641901
    .long 0x3ec8917e, 0xbf6b8a3d
    .long 0x3ea7bf25, 0xbf71decf
    .long 0x3e862210, 0xbf770f11
    .long 0x3e47c5c2, 0xbf7b14be
    .long 0x3e0255f4, 0xbf7deafa
    .long 0x3d712283, 0xbf7f8e56
    .long 0xbc20d8d2, 0xbf7ffcd7
    .long 0xbda0af2a, 0xbf7f35f9
    .long 0xbe164083, 0xbf7d3aac
    .long 0xbe5b73dc, 0xbf7a0d54
    .long 0xbe8fcefe, 0xbf75b1c9
    .long 0xbeb13641, 0xbf702d4f
    .long 0xbed1c759, 0xbf698690
    .long 0xbef15aea, 0xbf61c598
    .long 0xbf07e565, 0xbf58f3c4
    .long 0xbf167918, 0xbf4f1bbd
    .long 0xbf2456f1, 0xbf444969
    .long 0xbf316e2c, 0xbf3889dc
    .long 0xbf3daef9, 0xbf2beb4a
    .long 0xbf490a88, 0xbf1e7cf1
    .long 0xbf53731f, 0xbf104f0e
    .long 0xbf5cdc29, 0xbf0172c3
    .long 0xbf653a48, 0xbee3f40d
    .long 0xbf6c835e, 0xbec3ef15
    .long 0xbf72ae9e, 0xbea2fd52
    .long 0xbf77b493, 0xbe814693
    .long 0xbf7b8f2a, 0xbe3de731
    .long 0xbf7e39bc, 0xbdf0b772
    .long 0xbf7fb10f, 0xbd48fb30
    .long 0xbf7ff35e, 0x3ca0d6d6
    .long 0xbf7f0059, 0x3db4b86a
    .long 0xbf7cd925, 0x3e20305b
    .long 0xbf79805c, 0x3e6542e9
    .long 0xbf74fa0b, 0x3e94a031
    .long 0xbf6f4ba8, 0x3eb5eb4f
    .long 0xbf687c12, 0x3ed65a92
    .long 0xbf609384, 0x3ef5c6c5
    .long 0xbf579b8c, 0x3f0a04f8
    .long 0xbf4d9f02, 0x3f187fc0
    .long 0xbf42a9f7, 0x3f26423a
    .long 0xbf36c9a9, 0x3f333bc6
    .long 0xbf2a0c73, 0x3f3f5cb5
    .long 0xbf1c81b9, 0x3f4a965e
    .long 0xbf0e39da, 0x3f54db31
    .long 0xbefe8c2f, 0x3f5e1ec5
    .long 0xbedf7108, 0x3f6655e7
    .long 0xbebf47d7, 0x3f6d76aa
    .long 0x3f800000, 0x80000000
    .long 0x3f7f35f9, 0xbda0af2a
    .long 0x3f7cd925, 0xbe20305b
    .long 0x3f78ed3c, 0xbe6f0c4d
    .long 0x3f737871, 0xbe9e377a
    .long 0x3f6c835e, 0xbec3ef15
    .long 0x3f641901, 0xbee87171
    .long 0x3f5a46a0, 0xbf05c277
    .long 0x3f4f1bbd, 0xbf167918
    .long 0x3f42a9f7, 0xbf26423a
    .long 0x3f3504f3, 0xbf3504f3
    .long 0x3f26423a, 0xbf42a9f7
    .long 0x3f167918, 0xbf4f1bbd
    .long 0x3f05c277, 0xbf5a46a0
    .long 0x3ee87171, 0xbf641901
    .long 0x3ec3ef15, 0xbf6c835e
    .long 0x3e9e377a, 0xbf737871
    .long 0x3e6f0c4d, 0xbf78ed3c
    .long 0x3e20305b, 0xbf7cd925
    .long 0x3da0af2a, 0xbf7f35f9
    .long 0x248d3132, 0xbf800000
    .long 0xbda0af2a, 0xbf7f35f9
    .long 0xbe20305b, 0xbf7cd925
    .long 0xbe6f0c4d, 0xbf78ed3c
    .long 0xbe9e377a, 0xbf737871
    .long 0xbec3ef15, 0xbf6c835e
    .long 0xbee87171, 0xbf641901
    .long 0xbf05c277, 0xbf5a46a0
    .long 0xbf167918, 0xbf4f1bbd
    .long 0xbf26423a, 0xbf42a9f7
    .long 0xbf3504f3, 0xbf3504f3
    .long 0xbf42a9f7, 0xbf26423a
    .long 0xbf4f1bbd, 0xbf167918
    .long 0xbf5a46a0, 0xbf05c277
    .long 0xbf641901, 0xbee87171
    .long 0xbf6c835e, 0xbec3ef15
    .long 0xbf737871, 0xbe9e377a
    .long 0xbf78ed3c, 0xbe6f0c4d
    .long 0xbf7cd925, 0xbe20305b
    .long 0xbf7f35f9, 0xbda0af2a
    .long 0xbf800000, 0xa50d3132
    .long 0xbf7f35f9, 0x3da0af2a
    .long 0xbf7cd925, 0x3e20305b
    .long 0xbf78ed3c, 0x3e6f0c4d
    .long 0xbf737871, 0x3e9e377a
    .long 0xbf6c835e, 0x3ec3ef15
    .long 0xbf641901, 0x3ee87171
    .long 0xbf5a46a0, 0x3f05c277
    .long 0xbf4f1bbd, 0x3f167918
    .long 0xbf42a9f7, 0x3f26423a
    .long 0xbf3504f3, 0x3f3504f3
    .long 0xbf26423a, 0x3f42a9f7
    .long 0xbf167918, 0x3f4f1bbd
    .long 0xbf05c277, 0x3f5a46a0
    .long 0xbee87171, 0x3f641901
    .long 0xbec3ef15, 0x3f6c835e
    .long 0xbe9e377a, 0x3f737871
    .long 0xbe6f0c4d, 0x3f78ed3c
    .long 0xbe20305b, 0x3f7cd925
    .long 0xbda0af2a, 0x3f7f35f9
    .long 0xa553c9ca, 0x3f800000
    .long 0x3da0af2a, 0x3f7f35f9
    .long 0x3e20305b, 0x3f7cd925
    .long 0x3e6f0c4d, 0x3f78ed3c
    .long 0x3f800000, 0x80000000
    .long 0x3f7f0059, 0xbdb4b86a
    .long 0x3f7c0361, 0xbe3403f1
    .long 0x3f770f11, 0xbe862210
    .long 0x3f702d4f, 0xbeb13641
    .long 0x3f676bd8, 0xbedae880
    .long 0x3f5cdc29, 0xbf0172c3
    .long 0x3f50935b, 0xbf146eba
    .long 0x3f42a9f7, 0xbf26423a
    .long 0x3f333bc6, 0xbf36c9a9
    .long 0x3f226799, 0xbf45e403
    .long 0x3f104f0e, 0xbf53731f
    .long 0x3efa2c90, 0xbf5f5be6
    .long 0x3ed1c759, 0xbf698690
    .long 0x3ea7bf25, 0xbf71decf
    .long 0x3e78cfcc, 0xbf7853f8
    .long 0x3e20305b, 0xbf7cd925
    .long 0x3d8ca1f2, 0xbf7f654e
    .long 0xbca0d6d6, 0xbf7ff35e
    .long 0xbddcbd0d, 0xbf7e8238
    .long 0xbe47c5c2, 0xbf7b14be
    .long 0xbe8fcefe, 0xbf75b1c9
    .long 0xbeba9be1, 0xbf6e641a
    .long 0xbee3f40d, 0xbf653a48
    .long 0xbf05c277, 0xbf5a46a0
    .long 0xbf187fc0, 0xbf4d9f02
    .long 0xbf2a0c73, 0xbf3f5cb5
    .long 0xbf3a4582, 0xbf2f9c32
    .long 0xbf490a88, 0xbf1e7cf1
    .long 0xbf563e03, 0xbf0c2124
    .long 0xbf61c598, 0xbef15aea
    .long 0xbf6b8a3d, 0xbec8917e
    .long 0xbf737871, 0xbe9e377a
    .long 0xbf79805c, 0xbe6542e9
    .long 0xbf7d95f4, 0xbe0c4cf7
    .long 0xbf7fb10f, 0xbd48fb30
    .long 0xbf7fcd79, 0x3d20cee7
    .long 0xbf7deafa, 0x3e0255f4
    .long 0xbf7a0d54, 0x3e5b73dc
    .long 0xbf743c41, 0x3e996dba
    .long 0xbf6c835e, 0x3ec3ef15
    .long 0xbf62f219, 0x3eece91a
    .long 0xbf579b8c, 0x3f0a04f8
    .long 0xbf4a965e, 0x3f1c81b9
    .long 0xbf3bfc8f, 0x3f2dc5e3
    .long 0xbf2beb4a, 0x3f3daef9
    .long 0xbf1a82a4, 0x3f4c1d35
    .long 0xbf07e565, 0x3f58f3c4
    .long 0xbee87171, 0x3f641901
    .long 0xbebf47d7, 0x3f6d76aa
    .long 0xbe94a031, 0x3f74fa0b
    .long 0xbe519f65, 0x3f7a9421
    .long 0xbdf0b772, 0x3f7e39bc
    .long 0xbcf13d4c, 0x3f7fe394
    .long 0x3d712283, 0x3f7f8e56
    .long 0x3e164083, 0x3f7d3aac
    .long 0x3e6f0c4d, 0x3f78ed3c
    .long 0x3ea2fd52, 0x3f72ae9e
    .long 0x3ecd2ef3, 0x3f6a8b4b
    .long 0x3ef5c6c5, 0x3f609384
    .long 0x3f0e39da, 0x3f54db31
    .long 0x3f207440, 0x3f4779bc
    .long 0x3f316e2c, 0x3f3889dc
    .long 0x3f4105b8, 0x3f28296a
    .long 0x3f800000, 0x80000000
    .long 0x3f7ec46d, 0xbdc8bd36
    .long 0x3f7b14be, 0xbe47c5c2
    .long 0x3f74fa0b, 0xbe94a031
    .long 0x3f6c835e, 0xbec3ef15
    .long 0x3f61c598, 0xbef15aea
    .long 0x3f54db31, 0xbf0e39da
    .long 0x3f45e403, 0xbf226799
    .long 0x3f800000, 0x80000000
    .long 0x3f7b14be, 0xbe47c5c2
    .long 0x3f6c835e, 0xbec3ef15
    .long 0x3f54db31, 0xbf0e39da
    .long 0x3f3504f3, 0xbf3504f3
    .long 0x3f0e39da, 0xbf54db31
    .long 0x3ec3ef15, 0xbf6c835e
    .long 0x3e47c5c2, 0xbf7b14be
    .long 0x3f800000, 0x80000000
    .long 0x3f74fa0b, 0xbe94a031
    .long 0x3f54db31, 0xbf0e39da
    .long 0x3f226799, 0xbf45e403
    .long 0x3ec3ef15, 0xbf6c835e
    .long 0x3dc8bd36, 0xbf7ec46d
    .long 0xbe47c5c2, 0xbf7b14be
    .long 0xbef15aea, 0xbf61c598
    .long 0x3f800000, 0x80000000
    .long 0x3f6c835e, 0xbec3ef15
    .long 0x3f3504f3, 0xbf3504f3
    .long 0x3ec3ef15, 0xbf6c835e
    .long 0x248d3132, 0xbf800000
    .long 0xbec3ef15, 0xbf6c835e
    .long 0xbf3504f3, 0xbf3504f3
    .long 0xbf6c835e, 0xbec3ef15
    .long 0x3f800000, 0x80000000
    .long 0x3f61c598, 0xbef15aea
    .long 0x3f0e39da, 0xbf54db31
    .long 0x3dc8bd36, 0xbf7ec46d
    .long 0xbec3ef15, 0xbf6c835e
    .long 0xbf45e403, 0xbf226799
    .long 0xbf7b14be, 0xbe47c5c2
    .long 0xbf74fa0b, 0x3e94a031
    .long 0x3f800000, 0x80000000
    .long 0x3f54db31, 0xbf0e39da
    .long 0x3ec3ef15, 0xbf6c835e
    .long 0xbe47c5c2, 0xbf7b14be
    .long 0xbf3504f3, 0xbf3504f3
    .long 0xbf7b14be, 0xbe47c5c2
    .long 0xbf6c835e, 0x3ec3ef15
    .long 0xbf0e39da, 0x3f54db31
    .long 0x3f800000, 0x80000000
    .long 0x3f45e403, 0xbf226799
    .long 0x3e47c5c2, 0xbf7b14be
    .long 0xbef15aea, 0xbf61c598
    .long 0xbf6c835e, 0xbec3ef15
    .long 0xbf74fa0b, 0x3e94a031
    .long 0xbf0e39da, 0x3f54db31
    .long 0x3dc8bd36, 0x3f7ec46d
.size twr, 5056
.p2align 8
.type twk2,@object
twk2:
    .long 0x3f800000, 0x80000000
    .long 0x3f7fffb1, 0xbb490fc6
    .long 0x3f7ffec4, 0xbbc90f88
    .long 0x3f7ffd39, 0xbc16cb58
    .long 0x3f7ffb11, 0xbc490e90
    .long 0x3f7ff84a, 0xbc7b514b
    .long 0x3f7ff4e6, 0xbc96c9b6
    .long 0x3f7ff0e3, 0xbcafea69
    .long 0x3f7fec43, 0xbcc90ab0
    .long 0x3f7fe705, 0xbce22a7a
    .long 0x3f7fe129, 0xbcfb49ba
    .long 0x3f7fdaaf, 0xbd0a342f
    .long 0x3f7fd397, 0xbd16c32c
    .long 0x3f7fcbe2, 0xbd2351cb
    .long 0x3f7fc38f, 0xbd2fe007
    .long 0x3f7fba9e, 0xbd3c6dd5
    .long 0x3f7fb10f, 0xbd48fb30
    .long 0x3f7fa6e3, 0xbd55880e
    .long 0x3f7f9c18, 0xbd621469
    .long 0x3f7f90b1, 0xbd6ea038
    .long 0x3f7f84ab, 0xbd7b2b74
    .long 0x3f7f7808, 0xbd83db0a
    .long 0x3f7f6ac7, 0xbd8a200a
    .long 0x3f7f5ce9, 0xbd9064b4
    .long 0x3f7f4e6d, 0xbd96a905
    .long 0x3f7f3f54, 0xbd9cecf9
    .long 0x3f7f2f9d, 0xbda3308c
    .long 0x3f7f1f49, 0xbda973ba
    .long 0x3f7f0e58, 0xbdafb680
    .long 0x3f7efcc9, 0xbdb5f8da
    .long 0x3f7eea9d, 0xbdbc3ac3
    .long 0x3f7ed7d4, 0xbdc27c39
    .long 0x3f7ec46d, 0xbdc8bd36
    .long 0x3f7eb069, 0xbdcefdb7
    .long 0x3f7e9bc9, 0xbdd53db9
    .long 0x3f7e868b, 0xbddb7d37
    .long 0x3f7e70b0, 0xbde1bc2e
    .long 0x3f7e5a38, 0xbde7fa9a
    .long 0x3f7e4323, 0xbdee3876
    .long 0x3f7e2b72, 0xbdf475c0
    .long 0x3f7e1324, 0xbdfab273
    .long 0x3f7dfa38, 0xbe007745
    .long 0x3f7de0b1, 0xbe039502
    .long 0x3f7dc68c, 0xbe06b26e
    .long 0x3f7dabcc, 0xbe09cf86
    .long 0x3f7d906e, 0xbe0cec4a
    .long 0x3f7d7474, 0xbe1008b7
    .long 0x3f7d57de, 0xbe1324ca
    .long 0x3f7d3aac, 0xbe164083
    .long 0x3f7d1cdd, 0xbe195be0
    .long 0x3f7cfe73, 0xbe1c76de
    .long 0x3f7cdf6c, 0xbe1f917b
    .long 0x3f7cbfc9, 0xbe22abb6
    .long 0x3f7c9f8a, 0xbe25c58c
    .long 0x3f7c7eb0, 0xbe28defc
    .long 0x3f7c5d3a, 0xbe2bf804
    .long 0x3f7c3b28, 0xbe2f10a2
    .long 0x3f7c187a, 0xbe3228d4
    .long 0x3f7bf531, 0xbe354098
    .long 0x3f7bd14d, 0xbe3857ec
    .long 0x3f7baccd, 0xbe3b6ecf
    .long 0x3f7b87b2, 0xbe3e853e
    .long 0x3f7b61fc, 0xbe419b37
    .long 0x3f7b3bab, 0xbe44b0b9
    .long 0x3f7b14be, 0xbe47c5c2
    .long 0x3f7aed37, 0xbe4ada4f
    .long 0x3f7ac516, 0xbe4dee60
    .long 0x3f7a9c59, 0xbe5101f1
    .long 0x3f7a7302, 0xbe541501
    .long 0x3f7a4910, 0xbe57278f
    .long 0x3f7a1e84, 0xbe5a3997
    .long 0x3f79f35e, 0xbe5d4b1a
    .long 0x3f79c79d, 0xbe605c13
    .long 0x3f799b43, 0xbe636c83
    .long 0x3f796e4e, 0xbe667c66
    .long 0x3f7940c0, 0xbe698bba
    .long 0x3f791298, 0xbe6c9a7f
    .long 0x3f78e3d6, 0xbe6fa8b2
    .long 0x3f78b47b, 0xbe72b651
    .long 0x3f788486, 0xbe75c35a
    .long 0x3f7853f8, 0xbe78cfcc
    .long 0x3f7822d1, 0xbe7bdba4
    .long 0x3f77f110, 0xbe7ee6e1
    .long 0x3f77beb7, 0xbe80f8c0
    .long 0x3f778bc5, 0xbe827dc0
    .long 0x3f77583a, 0xbe840270
    .long 0x3f772417, 0xbe8586ce
    .long 0x3f76ef5b, 0xbe870ada
    .long 0x3f76ba07, 0xbe888e93
    .long 0x3f76841b, 0xbe8a11f7
    .long 0x3f764d97, 0xbe8b9507
    .long 0x3f76167a, 0xbe8d17c0
    .long 0x3f75dec6, 0xbe8e9a22
    .long 0x3f75a67b, 0xbe901c2c
    .long 0x3f756d97, 0xbe919ddd
    .long 0x3f75341d, 0xbe931f35
    .long 0x3f74fa0b, 0xbe94a031
    .long 0x3f74bf62, 0xbe9620d2
    .long 0x3f748422, 0xbe97a117
    .long 0x3f74484b, 0xbe9920fe
    .long 0x3f740bdd, 0xbe9aa086
    .long 0x3f73ced9, 0xbe9c1faf
    .long 0x3f73913f, 0xbe9d9e78
    .long 0x3f73530e, 0xbe9f1cdf
    .long 0x3f731447, 0xbea09ae5
    .long 0x3f72d4eb, 0xbea21887
    .long 0x3f7294f8, 0xbea395c5
    .long 0x3f725470, 0xbea5129f
    .long 0x3f721352, 0xbea68f12
    .long 0x3f71d19f, 0xbea80b1f
    .long 0x3f718f57, 0xbea986c4
    .long 0x3f714c7a, 0xbeab0201
    .long 0x3f710908, 0xbeac7cd4
    .long 0x3f70c501, 0xbeadf73c
    .long 0x3f708066, 0xbeaf713a
    .long 0x3f703b37, 0xbeb0eacb
    .long 0x3f6ff573, 0xbeb263ef
    .long 0x3f6faf1b, 0xbeb3dca5
    .long 0x3f6f6830, 0xbeb554ec
    .long 0x3f6f20b0, 0xbeb6ccc3
    .long 0x3f6ed89e, 0xbeb8442a
    .long 0x3f6e8ff8, 0xbeb9bb1e
    .long 0x3f6e46be, 0xbebb31a0
    .long 0x3f6dfcf2, 0xbebca7af
    .long 0x3f6db293, 0xbebe1d4a
    .long 0x3f6d67a1, 0xbebf926f
    .long 0x3f6d1c1d, 0xbec1071e
    .long 0x3f6cd007, 0xbec27b55
    .long 0x3f800000, 0x80000000
    .long 0x3f7ffec4, 0xbbc90f88
    .long 0x3f7ffb11, 0xbc490e90
    .long 0x3f7ff4e6, 0xbc96c9b6
    .long 0x3f7fec43, 0xbcc90ab0
    .long 0x3f7fe129, 0xbcfb49ba
    .long 0x3f7fd397, 0xbd16c32c
    .long 0x3f7fc38f, 0xbd2fe007
    .long 0x3f7fb10f, 0xbd48fb30
    .long 0x3f7f9c18, 0xbd621469
    .long 0x3f7f84ab, 0xbd7b2b74
    .long 0x3f7f6ac7, 0xbd8a200a
    .long 0x3f7f4e6d, 0xbd96a905
    .long 0x3f7f2f9d, 0xbda3308c
    .long 0x3f7f0e58, 0xbdafb680
    .long 0x3f7eea9d, 0xbdbc3ac3
    .long 0x3f7ec46d, 0xbdc8bd36
    .long 0x3f7e9bc9, 0xbdd53db9
    .long 0x3f7e70b0, 0xbde1bc2e
    .long 0x3f7e4323, 0xbdee3876
    .long 0x3f7e1324, 0xbdfab273
    .long 0x3f7de0b1, 0xbe039502
    .long 0x3f7dabcc, 0xbe09cf86
    .long 0x3f7d7474, 0xbe1008b7
    .long 0x3f7d3aac, 0xbe164083
    .long 0x3f7cfe73, 0xbe1c76de
    .long 0x3f7cbfc9, 0xbe22abb6
    .long 0x3f7c7eb0, 0xbe28defc
    .long 0x3f7c3b28, 0xbe2f10a2
    .long 0x3f7bf531, 0xbe354098
    .long 0x3f7baccd, 0xbe3b6ecf
    .long 0x3f7b61fc, 0xbe419b37
    .long 0x3f7b14be, 0xbe47c5c2
    .long 0x3f7ac516, 0xbe4dee60
    .long 0x3f7a7302, 0xbe541501
    .long 0x3f7a1e84, 0xbe5a3997
    .long 0x3f79c79d, 0xbe605c13
    .long 0x3f796e4e, 0xbe667c66
    .long 0x3f791298, 0xbe6c9a7f
    .long 0x3f78b47b, 0xbe72b651
    .long 0x3f7853f8, 0xbe78cfcc
    .long 0x3f77f110, 0xbe7ee6e1
    .long 0x3f778bc5, 0xbe827dc0
    .long 0x3f772417, 0xbe8586ce
    .long 0x3f76ba07, 0xbe888e93
    .long 0x3f764d97, 0xbe8b9507
    .long 0x3f75dec6, 0xbe8e9a22
    .long 0x3f756d97, 0xbe919ddd
    .long 0x3f74fa0b, 0xbe94a031
    .long 0x3f748422, 0xbe97a117
    .long 0x3f740bdd, 0xbe9aa086
    .long 0x3f73913f, 0xbe9d9e78
    .long 0x3f731447, 0xbea09ae5
    .long 0x3f7294f8, 0xbea395c5
    .long 0x3f721352, 0xbea68f12
    .long 0x3f718f57, 0xbea986c4
    .long 0x3f710908, 0xbeac7cd4
    .long 0x3f708066, 0xbeaf713a
    .long 0x3f6ff573, 0xbeb263ef
    .long 0x3f6f6830, 0xbeb554ec
    .long 0x3f6ed89e, 0xbeb8442a
    .long 0x3f6e46be, 0xbebb31a0
    .long 0x3f6db293, 0xbebe1d4a
    .long 0x3f6d1c1d, 0xbec1071e
    .long 0x3f6c835e, 0xbec3ef15
    .long 0x3f6be858, 0xbec6d529
    .long 0x3f6b4b0c, 0xbec9b953
    .long 0x3f6aab7b, 0xbecc9b8b
    .long 0x3f6a09a7, 0xbecf7bca
    .long 0x3f696591, 0xbed25a09
    .long 0x3f68bf3c, 0xbed53641
    .long 0x3f6816a8, 0xbed8106b
    .long 0x3f676bd8, 0xbedae880
    .long 0x3f66becc, 0xbeddbe79
    .long 0x3f660f88, 0xbee0924f
    .long 0x3f655e0b, 0xbee363fa
    .long 0x3f64aa59, 0xbee63375
    .long 0x3f63f473, 0xbee900b7
    .long 0x3f633c5a, 0xbeebcbbb
    .long 0x3f628210, 0xbeee9479
    .long 0x3f61c598, 0xbef15aea
    .long 0x3f6106f2, 0xbef41f07
    .long 0x3f604621, 0xbef6e0cb
    .long 0x3f5f8327, 0xbef9a02d
    .long 0x3f5ebe05, 0xbefc5d27
    .long 0x3f5df6be, 0xbeff17b2
    .long 0x3f5d2d53, 0xbf00e7e4
    .long 0x3f5c61c7, 0xbf0242b1
    .long 0x3f5b941a, 0xbf039c3d
    .long 0x3f5ac450, 0xbf04f484
    .long 0x3f59f26a, 0xbf064b82
    .long 0x3f591e6a, 0xbf07a136
    .long 0x3f584853, 0xbf08f59b
    .long 0x3f577026, 0xbf0a48ad
    .long 0x3f5695e5, 0xbf0b9a6b
    .long 0x3f55b993, 0xbf0cead0
    .long 0x3f54db31, 0xbf0e39da
    .long 0x3f53fac3, 0xbf0f8784
    .long 0x3f531849, 0xbf10d3cd
    .long 0x3f5233c6, 0xbf121eb0
    .long 0x3f514d3d, 0xbf13682a
    .long 0x3f5064af, 0xbf14b039
    .long 0x3f4f7a1f, 0xbf15f6d9
    .long 0x3f4e8d90, 0xbf173c07
    .long 0x3f4d9f02, 0xbf187fc0
    .long 0x3f4cae79, 0xbf19c200
    .long 0x3f4bbbf8, 0xbf1b02c6
    .long 0x3f4ac77f, 0xbf1c420c
    .long 0x3f49d112, 0xbf1d7fd1
    .long 0x3f48d8b3, 0xbf1ebc12
    .long 0x3f47de65, 0xbf1ff6cb
    .long 0x3f46e22a, 0xbf212ff9
    .long 0x3f45e403, 0xbf226799
    .long 0x3f44e3f5, 0xbf239da9
    .long 0x3f43e200, 0xbf24d225
    .long 0x3f42de29, 0xbf26050a
    .long 0x3f41d870, 0xbf273656
    .long 0x3f40d0da, 0xbf286605
    .long 0x3f3fc767, 0xbf299415
    .long 0x3f3ebc1b, 0xbf2ac082
    .long 0x3f3daef9, 0xbf2beb4a
    .long 0x3f3ca003, 0xbf2d1469
    .long 0x3f3b8f3b, 0xbf2e3bde
    .long 0x3f3a7ca4, 0xbf2f61a5
    .long 0x3f396842, 0xbf3085bb
    .long 0x3f385216, 0xbf31a81d
    .long 0x3f373a23, 0xbf32c8c9
    .long 0x3f36206c, 0xbf33e7bc
    .long 0x3f800000, 0x80000000
    .long 0x3f7ffd39, 0xbc16cb58
    .long 0x3f7ff4e6, 0xbc96c9b6
    .long 0x3f7fe705, 0xbce22a7a
    .long 0x3f7fd397, 0xbd16c32c
    .long 0x3f7fba9e, 0xbd3c6dd5
    .long 0x3f7f9c18, 0xbd621469
    .long 0x3f7f7808, 0xbd83db0a
    .long 0x3f7f4e6d, 0xbd96a905
    .long 0x3f7f1f49, 0xbda973ba
    .long 0x3f7eea9d, 0xbdbc3ac3
    .long 0x3f7eb069, 0xbdcefdb7
    .long 0x3f7e70b0, 0xbde1bc2e
    .long 0x3f7e2b72, 0xbdf475c0
    .long 0x3f7de0b1, 0xbe039502
    .long 0x3f7d906e, 0xbe0cec4a
    .long 0x3f7d3aac, 0xbe164083
    .long 0x3f7cdf6c, 0xbe1f917b
    .long 0x3f7c7eb0, 0xbe28defc
    .long 0x3f7c187a, 0xbe3228d4
    .long 0x3f7baccd, 0xbe3b6ecf
    .long 0x3f7b3bab, 0xbe44b0b9
    .long 0x3f7ac516, 0xbe4dee60
    .long 0x3f7a4910, 0xbe57278f
    .long 0x3f79c79d, 0xbe605c13
    .long 0x3f7940c0, 0xbe698bba
    .long 0x3f78b47b, 0xbe72b651
    .long 0x3f7822d1, 0xbe7bdba4
    .long 0x3f778bc5, 0xbe827dc0
    .long 0x3f76ef5b, 0xbe870ada
    .long 0x3f764d97, 0xbe8b9507
    .long 0x3f75a67b, 0xbe901c2c
    .long 0x3f74fa0b, 0xbe94a031
    .long 0x3f74484b, 0xbe9920fe
    .long 0x3f73913f, 0xbe9d9e78
    .long 0x3f72d4eb, 0xbea21887
    .long 0x3f721352, 0xbea68f12
    .long 0x3f714c7a, 0xbeab0201
    .long 0x3f708066, 0xbeaf713a
    .long 0x3f6faf1b, 0xbeb3dca5
    .long 0x3f6ed89e, 0xbeb8442a
    .long 0x3f6dfcf2, 0xbebca7af
    .long 0x3f6d1c1d, 0xbec1071e
    .long 0x3f6c3624, 0xbec5625c
    .long 0x3f6b4b0c, 0xbec9b953
    .long 0x3f6a5ad9, 0xbece0bea
    .long 0x3f696591, 0xbed25a09
    .long 0x3f686b39, 0xbed6a399
    .long 0x3f676bd8, 0xbedae880
    .long 0x3f666771, 0xbedf28a9
    .long 0x3f655e0b, 0xbee363fa
    .long 0x3f644fac, 0xbee79a5d
    .long 0x3f633c5a, 0xbeebcbbb
    .long 0x3f62241a, 0xbeeff7fb
    .long 0x3f6106f2, 0xbef41f07
    .long 0x3f5fe4e9, 0xbef840c8
    .long 0x3f5ebe05, 0xbefc5d27
    .long 0x3f5d924d, 0xbf003a06
    .long 0x3f5c61c7, 0xbf0242b1
    .long 0x3f5b2c79, 0xbf044889
    .long 0x3f59f26a, 0xbf064b82
    .long 0x3f58b3a1, 0xbf084b92
    .long 0x3f577026, 0xbf0a48ad
    .long 0x3f5627fe, 0xbf0c42c9
    .long 0x3f54db31, 0xbf0e39da
    .long 0x3f5389c7, 0xbf102dd5
    .long 0x3f5233c6, 0xbf121eb0
    .long 0x3f50d937, 0xbf140c5f
    .long 0x3f4f7a1f, 0xbf15f6d9
    .long 0x3f4e1689, 0xbf17de12
    .long 0x3f4cae79, 0xbf19c200
    .long 0x3f4b41fa, 0xbf1ba299
    .long 0x3f49d112, 0xbf1d7fd1
    .long 0x3f485bca, 0xbf1f599f
    .long 0x3f46e22a, 0xbf212ff9
    .long 0x3f456439, 0xbf2302d3
    .long 0x3f43e200, 0xbf24d225
    .long 0x3f425b89, 0xbf269de3
    .long 0x3f40d0da, 0xbf286605
    .long 0x3f3f41fc, 0xbf2a2a80
    .long 0x3f3daef9, 0xbf2beb4a
    .long 0x3f3c17d9, 0xbf2da859
    .long 0x3f3a7ca4, 0xbf2f61a5
    .long 0x3f38dd65, 0xbf311722
    .long 0x3f373a23, 0xbf32c8c9
    .long 0x3f3592e7, 0xbf34768f
    .long 0x3f33e7bc, 0xbf36206c
    .long 0x3f3238aa, 0xbf37c655
    .long 0x3f3085bb, 0xbf396842
    .long 0x3f2ecef7, 0xbf3b0629
    .long 0x3f2d1469, 0xbf3ca003
    .long 0x3f2b561b, 0xbf3e35c5
    .long 0x3f299415, 0xbf3fc767
    .long 0x3f27ce61, 0xbf4154e1
    .long 0x3f26050a, 0xbf42de29
    .long 0x3f24381a, 0xbf446337
    .long 0x3f226799, 0xbf45e403
    .long 0x3f209393, 0xbf476085
    .long 0x3f1ebc12, 0xbf48d8b3
    .long 0x3f1ce11f, 0xbf4a4c87
    .long 0x3f1b02c6, 0xbf4bbbf8
    .long 0x3f19210f, 0xbf4d26fd
    .long 0x3f173c07, 0xbf4e8d90
    .long 0x3f1553b7, 0xbf4fefa8
    .long 0x3f13682a, 0xbf514d3d
    .long 0x3f11796b, 0xbf52a649
    .long 0x3f0f8784, 0xbf53fac3
    .long 0x3f0d9281, 0xbf554aa4
    .long 0x3f0b9a6b, 0xbf5695e5
    .long 0x3f099f4e, 0xbf57dc7f
    .long 0x3f07a136, 0xbf591e6a
    .long 0x3f05a02c, 0xbf5a5ba0
    .long 0x3f039c3d, 0xbf5b941a
    .long 0x3f019573, 0xbf5cc7d1
    .long 0x3eff17b2, 0xbf5df6be
    .long 0x3efafef7, 0xbf5f20db
    .long 0x3ef6e0cb, 0xbf604621
    .long 0x3ef2bd43, 0xbf61668a
    .long 0x3eee9479, 0xbf628210
    .long 0x3eea6681, 0xbf6398ac
    .long 0x3ee63375, 0xbf64aa59
    .long 0x3ee1fb6a, 0xbf65b710
    .long 0x3eddbe79, 0xbf66becc
    .long 0x3ed97cb9, 0xbf67c187
    .long 0x3ed53641, 0xbf68bf3c
    .long 0x3ed0eb2a, 0xbf69b7e4
    .long 0x3ecc9b8b, 0xbf6aab7b
    .long 0x3ec8477c, 0xbf6b99fb
    .long 0x3f800000, 0x80000000
    .long 0x3f7ffb11, 0xbc490e90
    .long 0x3f7fec43, 0xbcc90ab0
    .long 0x3f7fd397, 0xbd16c32c
    .long 0x3f7fb10f, 0xbd48fb30
    .long 0x3f7f84ab, 0xbd7b2b74
    .long 0x3f7f4e6d, 0xbd96a905
    .long 0x3f7f0e58, 0xbdafb680
    .long 0x3f7ec46d, 0xbdc8bd36
    .long 0x3f7e70b0, 0xbde1bc2e
    .long 0x3f7e1324, 0xbdfab273
    .long 0x3f7dabcc, 0xbe09cf86
    .long 0x3f7d3aac, 0xbe164083
    .long 0x3f7cbfc9, 0xbe22abb6
    .long 0x3f7c3b28, 0xbe2f10a2
    .long 0x3f7baccd, 0xbe3b6ecf
    .long 0x3f7b14be, 0xbe47c5c2
    .long 0x3f7a7302, 0xbe541501
    .long 0x3f79c79d, 0xbe605c13
    .long 0x3f791298, 0xbe6c9a7f
    .long 0x3f7853f8, 0xbe78cfcc
    .long 0x3f778bc5, 0xbe827dc0
    .long 0x3f76ba07, 0xbe888e93
    .long 0x3f75dec6, 0xbe8e9a22
    .long 0x3f74fa0b, 0xbe94a031
    .long 0x3f740bdd, 0xbe9aa086
    .long 0x3f731447, 0xbea09ae5
    .long 0x3f721352, 0xbea68f12
    .long 0x3f710908, 0xbeac7cd4
    .long 0x3f6ff573, 0xbeb263ef
    .long 0x3f6ed89e, 0xbeb8442a
    .long 0x3f6db293, 0xbebe1d4a
    .long 0x3f6c835e, 0xbec3ef15
    .long 0x3f6b4b0c, 0xbec9b953
    .long 0x3f6a09a7, 0xbecf7bca
    .long 0x3f68bf3c, 0xbed53641
    .long 0x3f676bd8, 0xbedae880
    .long 0x3f660f88, 0xbee0924f
    .long 0x3f64aa59, 0xbee63375
    .long 0x3f633c5a, 0xbeebcbbb
    .long 0x3f61c598, 0xbef15aea
    .long 0x3f604621, 0xbef6e0cb
    .long 0x3f5ebe05, 0xbefc5d27
    .long 0x3f5d2d53, 0xbf00e7e4
    .long 0x3f5b941a, 0xbf039c3d
    .long 0x3f59f26a, 0xbf064b82
    .long 0x3f584853, 0xbf08f59b
    .long 0x3f5695e5, 0xbf0b9a6b
    .long 0x3f54db31, 0xbf0e39da
    .long 0x3f531849, 0xbf10d3cd
    .long 0x3f514d3d, 0xbf13682a
    .long 0x3f4f7a1f, 0xbf15f6d9
    .long 0x3f4d9f02, 0xbf187fc0
    .long 0x3f4bbbf8, 0xbf1b02c6
    .long 0x3f49d112, 0xbf1d7fd1
    .long 0x3f47de65, 0xbf1ff6cb
    .long 0x3f45e403, 0xbf226799
    .long 0x3f43e200, 0xbf24d225
    .long 0x3f41d870, 0xbf273656
    .long 0x3f3fc767, 0xbf299415
    .long 0x3f3daef9, 0xbf2beb4a
    .long 0x3f3b8f3b, 0xbf2e3bde
    .long 0x3f396842, 0xbf3085bb
    .long 0x3f373a23, 0xbf32c8c9
    .long 0x3f3504f3, 0xbf3504f3
    .long 0x3f32c8c9, 0xbf373a23
    .long 0x3f3085bb, 0xbf396842
    .long 0x3f2e3bde, 0xbf3b8f3b
    .long 0x3f2beb4a, 0xbf3daef9
    .long 0x3f299415, 0xbf3fc767
    .long 0x3f273656, 0xbf41d870
    .long 0x3f24d225, 0xbf43e200
    .long 0x3f226799, 0xbf45e403
    .long 0x3f1ff6cb, 0xbf47de65
    .long 0x3f1d7fd1, 0xbf49d112
    .long 0x3f1b02c6, 0xbf4bbbf8
    .long 0x3f187fc0, 0xbf4d9f02
    .long 0x3f15f6d9, 0xbf4f7a1f
    .long 0x3f13682a, 0xbf514d3d
    .long 0x3f10d3cd, 0xbf531849
    .long 0x3f0e39da, 0xbf54db31
    .long 0x3f0b9a6b, 0xbf5695e5
    .long 0x3f08f59b, 0xbf584853
    .long 0x3f064b82, 0xbf59f26a
    .long 0x3f039c3d, 0xbf5b941a
    .long 0x3f00e7e4, 0xbf5d2d53
    .long 0x3efc5d27, 0xbf5ebe05
    .long 0x3ef6e0cb, 0xbf604621
    .long 0x3ef15aea, 0xbf61c598
    .long 0x3eebcbbb, 0xbf633c5a
    .long 0x3ee63375, 0xbf64aa59
    .long 0x3ee0924f, 0xbf660f88
    .long 0x3edae880, 0xbf676bd8
    .long 0x3ed53641, 0xbf68bf3c
    .long 0x3ecf7bca, 0xbf6a09a7
    .long 0x3ec9b953, 0xbf6b4b0c
    .long 0x3ec3ef15, 0xbf6c835e
    .long 0x3ebe1d4a, 0xbf6db293
    .long 0x3eb8442a, 0xbf6ed89e
    .long 0x3eb263ef, 0xbf6ff573
    .long 0x3eac7cd4, 0xbf710908
    .long 0x3ea68f12, 0xbf721352
    .long 0x3ea09ae5, 0xbf731447
    .long 0x3e9aa086, 0xbf740bdd
    .long 0x3e94a031, 0xbf74fa0b
    .long 0x3e8e9a22, 0xbf75dec6
    .long 0x3e888e93, 0xbf76ba07
    .long 0x3e827dc0, 0xbf778bc5
    .long 0x3e78cfcc, 0xbf7853f8
    .long 0x3e6c9a7f, 0xbf791298
    .long 0x3e605c13, 0xbf79c79d
    .long 0x3e541501, 0xbf7a7302
    .long 0x3e47c5c2, 0xbf7b14be
    .long 0x3e3b6ecf, 0xbf7baccd
    .long 0x3e2f10a2, 0xbf7c3b28
    .long 0x3e22abb6, 0xbf7cbfc9
    .long 0x3e164083, 0xbf7d3aac
    .long 0x3e09cf86, 0xbf7dabcc
    .long 0x3dfab273, 0xbf7e1324
    .long 0x3de1bc2e, 0xbf7e70b0
    .long 0x3dc8bd36, 0xbf7ec46d
    .long 0x3dafb680, 0xbf7f0e58
    .long 0x3d96a905, 0xbf7f4e6d
    .long 0x3d7b2b74, 0xbf7f84ab
    .long 0x3d48fb30, 0xbf7fb10f
    .long 0x3d16c32c, 0xbf7fd397
    .long 0x3cc90ab0, 0xbf7fec43
    .long 0x3c490e90, 0xbf7ffb11
    .long 0x3f800000, 0x80000000
    .long 0x3f7ff84a, 0xbc7b514b
    .long 0x3f7fe129, 0xbcfb49ba
    .long 0x3f7fba9e, 0xbd3c6dd5
    .long 0x3f7f84ab, 0xbd7b2b74
    .long 0x3f7f3f54, 0xbd9cecf9
    .long 0x3f7eea9d, 0xbdbc3ac3
    .long 0x3f7e868b, 0xbddb7d37
    .long 0x3f7e1324, 0xbdfab273
    .long 0x3f7d906e, 0xbe0cec4a
    .long 0x3f7cfe73, 0xbe1c76de
    .long 0x3f7c5d3a, 0xbe2bf804
    .long 0x3f7baccd, 0xbe3b6ecf
    .long 0x3f7aed37, 0xbe4ada4f
    .long 0x3f7a1e84, 0xbe5a3997
    .long 0x3f7940c0, 0xbe698bba
    .long 0x3f7853f8, 0xbe78cfcc
    .long 0x3f77583a, 0xbe840270
    .long 0x3f764d97, 0xbe8b9507
    .long 0x3f75341d, 0xbe931f35
    .long 0x3f740bdd, 0xbe9aa086
    .long 0x3f72d4eb, 0xbea21887
    .long 0x3f718f57, 0xbea986c4
    .long 0x3f703b37, 0xbeb0eacb
    .long 0x3f6ed89e, 0xbeb8442a
    .long 0x3f6d67a1, 0xbebf926f
    .long 0x3f6be858, 0xbec6d529
    .long 0x3f6a5ad9, 0xbece0bea
    .long 0x3f68bf3c, 0xbed53641
    .long 0x3f671599, 0xbedc53c1
    .long 0x3f655e0b, 0xbee363fa
    .long 0x3f6398ac, 0xbeea6681
    .long 0x3f61c598, 0xbef15aea
    .long 0x3f5fe4e9, 0xbef840c8
    .long 0x3f5df6be, 0xbeff17b2
    .long 0x3f5bfb34, 0xbf02ef9f
    .long 0x3f59f26a, 0xbf064b82
    .long 0x3f57dc7f, 0xbf099f4e
    .long 0x3f55b993, 0xbf0cead0
    .long 0x3f5389c7, 0xbf102dd5
    .long 0x3f514d3d, 0xbf13682a
    .long 0x3f4f0417, 0xbf16999f
    .long 0x3f4cae79, 0xbf19c200
    .long 0x3f4a4c87, 0xbf1ce11f
    .long 0x3f47de65, 0xbf1ff6cb
    .long 0x3f456439, 0xbf2302d3
    .long 0x3f42de29, 0xbf26050a
    .long 0x3f404c5c, 0xbf28fd41
    .long 0x3f3daef9, 0xbf2beb4a
    .long 0x3f3b0629, 0xbf2ecef7
    .long 0x3f385216, 0xbf31a81d
    .long 0x3f3592e7, 0xbf34768f
    .long 0x3f32c8c9, 0xbf373a23
    .long 0x3f2ff3e6, 0xbf39f2ac
    .long 0x3f2d1469, 0xbf3ca003
    .long 0x3f2a2a80, 0xbf3f41fc
    .long 0x3f273656, 0xbf41d870
    .long 0x3f24381a, 0xbf446337
    .long 0x3f212ff9, 0xbf46e22a
    .long 0x3f1e1e22, 0xbf495521
    .long 0x3f1b02c6, 0xbf4bbbf8
    .long 0x3f17de12, 0xbf4e1689
    .long 0x3f14b039, 0xbf5064af
    .long 0x3f11796b, 0xbf52a649
    .long 0x3f0e39da, 0xbf54db31
    .long 0x3f0af1b7, 0xbf570348
    .long 0x3f07a136, 0xbf591e6a
    .long 0x3f044889, 0xbf5b2c79
    .long 0x3f00e7e4, 0xbf5d2d53
    .long 0x3efafef7, 0xbf5f20db
    .long 0x3ef41f07, 0xbf6106f2
    .long 0x3eed3063, 0xbf62df7b
    .long 0x3ee63375, 0xbf64aa59
    .long 0x3edf28a9, 0xbf666771
    .long 0x3ed8106b, 0xbf6816a8
    .long 0x3ed0eb2a, 0xbf69b7e4
    .long 0x3ec9b953, 0xbf6b4b0c
    .long 0x3ec27b55, 0xbf6cd007
    .long 0x3ebb31a0, 0xbf6e46be
    .long 0x3eb3dca5, 0xbf6faf1b
    .long 0x3eac7cd4, 0xbf710908
    .long 0x3ea5129f, 0xbf725470
    .long 0x3e9d9e78, 0xbf73913f
    .long 0x3e9620d2, 0xbf74bf62
    .long 0x3e8e9a22, 0xbf75dec6
    .long 0x3e870ada, 0xbf76ef5b
    .long 0x3e7ee6e1, 0xbf77f110
    .long 0x3e6fa8b2, 0xbf78e3d6
    .long 0x3e605c13, 0xbf79c79d
    .long 0x3e5101f1, 0xbf7a9c59
    .long 0x3e419b37, 0xbf7b61fc
    .long 0x3e3228d4, 0xbf7c187a
    .long 0x3e22abb6, 0xbf7cbfc9
    .long 0x3e1324ca, 0xbf7d57de
    .long 0x3e039502, 0xbf7de0b1
    .long 0x3de7fa9a, 0xbf7e5a38
    .long 0x3dc8bd36, 0xbf7ec46d
    .long 0x3da973ba, 0xbf7f1f49
    .long 0x3d8a200a, 0xbf7f6ac7
    .long 0x3d55880e, 0xbf7fa6e3
    .long 0x3d16c32c, 0xbf7fd397
    .long 0x3cafea69, 0xbf7ff0e3
    .long 0x3bc90f88, 0xbf7ffec4
    .long 0xbc16cb58, 0xbf7ffd39
    .long 0xbcc90ab0, 0xbf7fec43
    .long 0xbd2351cb, 0xbf7fcbe2
    .long 0xbd621469, 0xbf7f9c18
    .long 0xbd9064b4, 0xbf7f5ce9
    .long 0xbdafb680, 0xbf7f0e58
    .long 0xbdcefdb7, 0xbf7eb069
    .long 0xbdee3876, 0xbf7e4323
    .long 0xbe06b26e, 0xbf7dc68c
    .long 0xbe164083, 0xbf7d3aac
    .long 0xbe25c58c, 0xbf7c9f8a
    .long 0xbe354098, 0xbf7bf531
    .long 0xbe44b0b9, 0xbf7b3bab
    .long 0xbe541501, 0xbf7a7302
    .long 0xbe636c83, 0xbf799b43
    .long 0xbe72b651, 0xbf78b47b
    .long 0xbe80f8c0, 0xbf77beb7
    .long 0xbe888e93, 0xbf76ba07
    .long 0xbe901c2c, 0xbf75a67b
    .long 0xbe97a117, 0xbf748422
    .long 0xbe9f1cdf, 0xbf73530e
    .long 0xbea68f12, 0xbf721352
    .long 0xbeadf73c, 0xbf70c501
    .long 0xbeb554ec, 0xbf6f6830
    .long 0xbebca7af, 0xbf6dfcf2
    .long 0x3f800000, 0x80000000
    .long 0x3f7ff4e6, 0xbc96c9b6
    .long 0x3f7fd397, 0xbd16c32c
    .long 0x3f7f9c18, 0xbd621469
    .long 0x3f7f4e6d, 0xbd96a905
    .long 0x3f7eea9d, 0xbdbc3ac3
    .long 0x3f7e70b0, 0xbde1bc2e
    .long 0x3f7de0b1, 0xbe039502
    .long 0x3f7d3aac, 0xbe164083
    .long 0x3f7c7eb0, 0xbe28defc
    .long 0x3f7baccd, 0xbe3b6ecf
    .long 0x3f7ac516, 0xbe4dee60
    .long 0x3f79c79d, 0xbe605c13
    .long 0x3f78b47b, 0xbe72b651
    .long 0x3f778bc5, 0xbe827dc0
    .long 0x3f764d97, 0xbe8b9507
    .long 0x3f74fa0b, 0xbe94a031
    .long 0x3f73913f, 0xbe9d9e78
    .long 0x3f721352, 0xbea68f12
    .long 0x3f708066, 0xbeaf713a
    .long 0x3f6ed89e, 0xbeb8442a
    .long 0x3f6d1c1d, 0xbec1071e
    .long 0x3f6b4b0c, 0xbec9b953
    .long 0x3f696591, 0xbed25a09
    .long 0x3f676bd8, 0xbedae880
    .long 0x3f655e0b, 0xbee363fa
    .long 0x3f633c5a, 0xbeebcbbb
    .long 0x3f6106f2, 0xbef41f07
    .long 0x3f5ebe05, 0xbefc5d27
    .long 0x3f5c61c7, 0xbf0242b1
    .long 0x3f59f26a, 0xbf064b82
    .long 0x3f577026, 0xbf0a48ad
    .long 0x3f54db31, 0xbf0e39da
    .long 0x3f5233c6, 0xbf121eb0
    .long 0x3f4f7a1f, 0xbf15f6d9
    .long 0x3f4cae79, 0xbf19c200
    .long 0x3f49d112, 0xbf1d7fd1
    .long 0x3f46e22a, 0xbf212ff9
    .long 0x3f43e200, 0xbf24d225
    .long 0x3f40d0da, 0xbf286605
    .long 0x3f3daef9, 0xbf2beb4a
    .long 0x3f3a7ca4, 0xbf2f61a5
    .long 0x3f373a23, 0xbf32c8c9
    .long 0x3f33e7bc, 0xbf36206c
    .long 0x3f3085bb, 0xbf396842
    .long 0x3f2d1469, 0xbf3ca003
    .long 0x3f299415, 0xbf3fc767
    .long 0x3f26050a, 0xbf42de29
    .long 0x3f226799, 0xbf45e403
    .long 0x3f1ebc12, 0xbf48d8b3
    .long 0x3f1b02c6, 0xbf4bbbf8
    .long 0x3f173c07, 0xbf4e8d90
    .long 0x3f13682a, 0xbf514d3d
    .long 0x3f0f8784, 0xbf53fac3
    .long 0x3f0b9a6b, 0xbf5695e5
    .long 0x3f07a136, 0xbf591e6a
    .long 0x3f039c3d, 0xbf5b941a
    .long 0x3eff17b2, 0xbf5df6be
    .long 0x3ef6e0cb, 0xbf604621
    .long 0x3eee9479, 0xbf628210
    .long 0x3ee63375, 0xbf64aa59
    .long 0x3eddbe79, 0xbf66becc
    .long 0x3ed53641, 0xbf68bf3c
    .long 0x3ecc9b8b, 0xbf6aab7b
    .long 0x3ec3ef15, 0xbf6c835e
    .long 0x3ebb31a0, 0xbf6e46be
    .long 0x3eb263ef, 0xbf6ff573
    .long 0x3ea986c4, 0xbf718f57
    .long 0x3ea09ae5, 0xbf731447
    .long 0x3e97a117, 0xbf748422
    .long 0x3e8e9a22, 0xbf75dec6
    .long 0x3e8586ce, 0xbf772417
    .long 0x3e78cfcc, 0xbf7853f8
    .long 0x3e667c66, 0xbf796e4e
    .long 0x3e541501, 0xbf7a7302
    .long 0x3e419b37, 0xbf7b61fc
    .long 0x3e2f10a2, 0xbf7c3b28
    .long 0x3e1c76de, 0xbf7cfe73
    .long 0x3e09cf86, 0xbf7dabcc
    .long 0x3dee3876, 0xbf7e4323
    .long 0x3dc8bd36, 0xbf7ec46d
    .long 0x3da3308c, 0xbf7f2f9d
    .long 0x3d7b2b74, 0xbf7f84ab
    .long 0x3d2fe007, 0xbf7fc38f
    .long 0x3cc90ab0, 0xbf7fec43
    .long 0x3bc90f88, 0xbf7ffec4
    .long 0xbc490e90, 0xbf7ffb11
    .long 0xbcfb49ba, 0xbf7fe129
    .long 0xbd48fb30, 0xbf7fb10f
    .long 0xbd8a200a, 0xbf7f6ac7
    .long 0xbdafb680, 0xbf7f0e58
    .long 0xbdd53db9, 0xbf7e9bc9
    .long 0xbdfab273, 0xbf7e1324
    .long 0xbe1008b7, 0xbf7d7474
    .long 0xbe22abb6, 0xbf7cbfc9
    .long 0xbe354098, 0xbf7bf531
    .long 0xbe47c5c2, 0xbf7b14be
    .long 0xbe5a3997, 0xbf7a1e84
    .long 0xbe6c9a7f, 0xbf791298
    .long 0xbe7ee6e1, 0xbf77f110
    .long 0xbe888e93, 0xbf76ba07
    .long 0xbe919ddd, 0xbf756d97
    .long 0xbe9aa086, 0xbf740bdd
    .long 0xbea395c5, 0xbf7294f8
    .long 0xbeac7cd4, 0xbf710908
    .long 0xbeb554ec, 0xbf6f6830
    .long 0xbebe1d4a, 0xbf6db293
    .long 0xbec6d529, 0xbf6be858
    .long 0xbecf7bca, 0xbf6a09a7
    .long 0xbed8106b, 0xbf6816a8
    .long 0xbee0924f, 0xbf660f88
    .long 0xbee900b7, 0xbf63f473
    .long 0xbef15aea, 0xbf61c598
    .long 0xbef9a02d, 0xbf5f8327
    .long 0xbf00e7e4, 0xbf5d2d53
    .long 0xbf04f484, 0xbf5ac450
    .long 0xbf08f59b, 0xbf584853
    .long 0xbf0cead0, 0xbf55b993
    .long 0xbf10d3cd, 0xbf531849
    .long 0xbf14b039, 0xbf5064af
    .long 0xbf187fc0, 0xbf4d9f02
    .long 0xbf1c420c, 0xbf4ac77f
    .long 0xbf1ff6cb, 0xbf47de65
    .long 0xbf239da9, 0xbf44e3f5
    .long 0xbf273656, 0xbf41d870
    .long 0xbf2ac082, 0xbf3ebc1b
    .long 0xbf2e3bde, 0xbf3b8f3b
    .long 0xbf31a81d, 0xbf385216
    .long 0x3f800000, 0x80000000
    .long 0x3f7ff0e3, 0xbcafea69
    .long 0x3f7fc38f, 0xbd2fe007
    .long 0x3f7f7808, 0xbd83db0a
    .long 0x3f7f0e58, 0xbdafb680
    .long 0x3f7e868b, 0xbddb7d37
    .long 0x3f7de0b1, 0xbe039502
    .long 0x3f7d1cdd, 0xbe195be0
    .long 0x3f7c3b28, 0xbe2f10a2
    .long 0x3f7b3bab, 0xbe44b0b9
    .long 0x3f7a1e84, 0xbe5a3997
    .long 0x3f78e3d6, 0xbe6fa8b2
    .long 0x3f778bc5, 0xbe827dc0
    .long 0x3f76167a, 0xbe8d17c0
    .long 0x3f748422, 0xbe97a117
    .long 0x3f72d4eb, 0xbea21887
    .long 0x3f710908, 0xbeac7cd4
    .long 0x3f6f20b0, 0xbeb6ccc3
    .long 0x3f6d1c1d, 0xbec1071e
    .long 0x3f6afb8c, 0xbecb2aae
    .long 0x3f68bf3c, 0xbed53641
    .long 0x3f666771, 0xbedf28a9
    .long 0x3f63f473, 0xbee900b7
    .long 0x3f61668a, 0xbef2bd43
    .long 0x3f5ebe05, 0xbefc5d27
    .long 0x3f5bfb34, 0xbf02ef9f
    .long 0x3f591e6a, 0xbf07a136
    .long 0x3f5627fe, 0xbf0c42c9
    .long 0x3f531849, 0xbf10d3cd
    .long 0x3f4fefa8, 0xbf1553b7
    .long 0x3f4cae79, 0xbf19c200
    .long 0x3f495521, 0xbf1e1e22
    .long 0x3f45e403, 0xbf226799
    .long 0x3f425b89, 0xbf269de3
    .long 0x3f3ebc1b, 0xbf2ac082
    .long 0x3f3b0629, 0xbf2ecef7
    .long 0x3f373a23, 0xbf32c8c9
    .long 0x3f33587a, 0xbf36ad7f
    .long 0x3f2f61a5, 0xbf3a7ca4
    .long 0x3f2b561b, 0xbf3e35c5
    .long 0x3f273656, 0xbf41d870
    .long 0x3f2302d3, 0xbf456439
    .long 0x3f1ebc12, 0xbf48d8b3
    .long 0x3f1a6293, 0xbf4c3578
    .long 0x3f15f6d9, 0xbf4f7a1f
    .long 0x3f11796b, 0xbf52a649
    .long 0x3f0cead0, 0xbf55b993
    .long 0x3f084b92, 0xbf58b3a1
    .long 0x3f039c3d, 0xbf5b941a
    .long 0x3efdbabb, 0xbf5e5aa6
    .long 0x3ef41f07, 0xbf6106f2
    .long 0x3eea6681, 0xbf6398ac
    .long 0x3ee0924f, 0xbf660f88
    .long 0x3ed6a399, 0xbf686b39
    .long 0x3ecc9b8b, 0xbf6aab7b
    .long 0x3ec27b55, 0xbf6cd007
    .long 0x3eb8442a, 0xbf6ed89e
    .long 0x3eadf73c, 0xbf70c501
    .long 0x3ea395c5, 0xbf7294f8
    .long 0x3e9920fe, 0xbf74484b
    .long 0x3e8e9a22, 0xbf75dec6
    .long 0x3e840270, 0xbf77583a
    .long 0x3e72b651, 0xbf78b47b
    .long 0x3e5d4b1a, 0xbf79f35e
    .long 0x3e47c5c2, 0xbf7b14be
    .long 0x3e3228d4, 0xbf7c187a
    .long 0x3e1c76de, 0xbf7cfe73
    .long 0x3e06b26e, 0xbf7dc68c
    .long 0x3de1bc2e, 0xbf7e70b0
    .long 0x3db5f8da, 0xbf7efcc9
    .long 0x3d8a200a, 0xbf7f6ac7
    .long 0x3d3c6dd5, 0xbf7fba9e
    .long 0x3cc90ab0, 0xbf7fec43
    .long 0x3b490fc6, 0xbf7fffb1
    .long 0xbc96c9b6, 0xbf7ff4e6
    .long 0xbd2351cb, 0xbf7fcbe2
    .long 0xbd7b2b74, 0xbf7f84ab
    .long 0xbda973ba, 0xbf7f1f49
    .long 0xbdd53db9, 0xbf7e9bc9
    .long 0xbe007745, 0xbf7dfa38
    .long 0xbe164083, 0xbf7d3aac
    .long 0xbe2bf804, 0xbf7c5d3a
    .long 0xbe419b37, 0xbf7b61fc
    .long 0xbe57278f, 0xbf7a4910
    .long 0xbe6c9a7f, 0xbf791298
    .long 0xbe80f8c0, 0xbf77beb7
    .long 0xbe8b9507, 0xbf764d97
    .long 0xbe9620d2, 0xbf74bf62
    .long 0xbea09ae5, 0xbf731447
    .long 0xbeab0201, 0xbf714c7a
    .long 0xbeb554ec, 0xbf6f6830
    .long 0xbebf926f, 0xbf6d67a1
    .long 0xbec9b953, 0xbf6b4b0c
    .long 0xbed3c867, 0xbf6912ae
    .long 0xbeddbe79, 0xbf66becc
    .long 0xbee79a5d, 0xbf644fac
    .long 0xbef15aea, 0xbf61c598
    .long 0xbefafef7, 0xbf5f20db
    .long 0xbf0242b1, 0xbf5c61c7
    .long 0xbf06f686, 0xbf5988ad
    .long 0xbf0b9a6b, 0xbf5695e5
    .long 0xbf102dd5, 0xbf5389c7
    .long 0xbf14b039, 0xbf5064af
    .long 0xbf19210f, 0xbf4d26fd
    .long 0xbf1d7fd1, 0xbf49d112
    .long 0xbf21cbfb, 0xbf466354
    .long 0xbf26050a, 0xbf42de29
    .long 0xbf2a2a80, 0xbf3f41fc
    .long 0xbf2e3bde, 0xbf3b8f3b
    .long 0xbf3238aa, 0xbf37c655
    .long 0xbf36206c, 0xbf33e7bc
    .long 0xbf39f2ac, 0xbf2ff3e6
    .long 0xbf3daef9, 0xbf2beb4a
    .long 0xbf4154e1, 0xbf27ce61
    .long 0xbf44e3f5, 0xbf239da9
    .long 0xbf485bca, 0xbf1f599f
    .long 0xbf4bbbf8, 0xbf1b02c6
    .long 0xbf4f0417, 0xbf16999f
    .long 0xbf5233c6, 0xbf121eb0
    .long 0xbf554aa4, 0xbf0d9281
    .long 0xbf584853, 0xbf08f59b
    .long 0xbf5b2c79, 0xbf044889
    .long 0xbf5df6be, 0xbeff17b2
    .long 0xbf60a6cf, 0xbef58035
    .long 0xbf633c5a, 0xbeebcbbb
    .long 0xbf65b710, 0xbee1fb6a
    .long 0xbf6816a8, 0xbed8106b
    .long 0xbf6a5ad9, 0xbece0bea
    .long 0x3f800000, 0x80000000
    .long 0x3f7fec43, 0xbcc90ab0
    .long 0x3f7fb10f, 0xbd48fb30
    .long 0x3f7f4e6d, 0xbd96a905
    .long 0x3f7ec46d, 0xbdc8bd36
    .long 0x3f7e1324, 0xbdfab273
    .long 0x3f7d3aac, 0xbe164083
    .long 0x3f7c3b28, 0xbe2f10a2
    .long 0x3f7b14be, 0xbe47c5c2
    .long 0x3f79c79d, 0xbe605c13
    .long 0x3f7853f8, 0xbe78cfcc
    .long 0x3f76ba07, 0xbe888e93
    .long 0x3f74fa0b, 0xbe94a031
    .long 0x3f731447, 0xbea09ae5
    .long 0x3f710908, 0xbeac7cd4
    .long 0x3f6ed89e, 0xbeb8442a
    .long 0x3f6c835e, 0xbec3ef15
    .long 0x3f6a09a7, 0xbecf7bca
    .long 0x3f676bd8, 0xbedae880
    .long 0x3f64aa59, 0xbee63375
    .long 0x3f61c598, 0xbef15aea
    .long 0x3f5ebe05, 0xbefc5d27
    .long 0x3f5b941a, 0xbf039c3d
    .long 0x3f584853, 0xbf08f59b
    .long 0x3f54db31, 0xbf0e39da
    .long 0x3f514d3d, 0xbf13682a
    .long 0x3f4d9f02, 0xbf187fc0
    .long 0x3f49d112, 0xbf1d7fd1
    .long 0x3f45e403, 0xbf226799
    .long 0x3f41d870, 0xbf273656
    .long 0x3f3daef9, 0xbf2beb4a
    .long 0x3f396842, 0xbf3085bb
    .long 0x3f3504f3, 0xbf3504f3
    .long 0x3f3085bb, 0xbf396842
    .long 0x3f2beb4a, 0xbf3daef9
    .long 0x3f273656, 0xbf41d870
    .long 0x3f226799, 0xbf45e403
    .long 0x3f1d7fd1, 0xbf49d112
    .long 0x3f187fc0, 0xbf4d9f02
    .long 0x3f13682a, 0xbf514d3d
    .long 0x3f0e39da, 0xbf54db31
    .long 0x3f08f59b, 0xbf584853
    .long 0x3f039c3d, 0xbf5b941a
    .long 0x3efc5d27, 0xbf5ebe05
    .long 0x3ef15aea, 0xbf61c598
    .long 0x3ee63375, 0xbf64aa59
    .long 0x3edae880, 0xbf676bd8
    .long 0x3ecf7bca, 0xbf6a09a7
    .long 0x3ec3ef15, 0xbf6c835e
    .long 0x3eb8442a, 0xbf6ed89e
    .long 0x3eac7cd4, 0xbf710908
    .long 0x3ea09ae5, 0xbf731447
    .long 0x3e94a031, 0xbf74fa0b
    .long 0x3e888e93, 0xbf76ba07
    .long 0x3e78cfcc, 0xbf7853f8
    .long 0x3e605c13, 0xbf79c79d
    .long 0x3e47c5c2, 0xbf7b14be
    .long 0x3e2f10a2, 0xbf7c3b28
    .long 0x3e164083, 0xbf7d3aac
    .long 0x3dfab273, 0xbf7e1324
    .long 0x3dc8bd36, 0xbf7ec46d
    .long 0x3d96a905, 0xbf7f4e6d
    .long 0x3d48fb30, 0xbf7fb10f
    .long 0x3cc90ab0, 0xbf7fec43
    .long 0x248d3132, 0xbf800000
    .long 0xbcc90ab0, 0xbf7fec43
    .long 0xbd48fb30, 0xbf7fb10f
    .long 0xbd96a905, 0xbf7f4e6d
    .long 0xbdc8bd36, 0xbf7ec46d
    .long 0xbdfab273, 0xbf7e1324
    .long 0xbe164083, 0xbf7d3aac
    .long 0xbe2f10a2, 0xbf7c3b28
    .long 0xbe47c5c2, 0xbf7b14be
    .long 0xbe605c13, 0xbf79c79d
    .long 0xbe78cfcc, 0xbf7853f8
    .long 0xbe888e93, 0xbf76ba07
    .long 0xbe94a031, 0xbf74fa0b
    .long 0xbea09ae5, 0xbf731447
    .long 0xbeac7cd4, 0xbf710908
    .long 0xbeb8442a, 0xbf6ed89e
    .long 0xbec3ef15, 0xbf6c835e
    .long 0xbecf7bca, 0xbf6a09a7
    .long 0xbedae880, 0xbf676bd8
    .long 0xbee63375, 0xbf64aa59
    .long 0xbef15aea, 0xbf61c598
    .long 0xbefc5d27, 0xbf5ebe05
    .long 0xbf039c3d, 0xbf5b941a
    .long 0xbf08f59b, 0xbf584853
    .long 0xbf0e39da, 0xbf54db31
    .long 0xbf13682a, 0xbf514d3d
    .long 0xbf187fc0, 0xbf4d9f02
    .long 0xbf1d7fd1, 0xbf49d112
    .long 0xbf226799, 0xbf45e403
    .long 0xbf273656, 0xbf41d870
    .long 0xbf2beb4a, 0xbf3daef9
    .long 0xbf3085bb, 0xbf396842
    .long 0xbf3504f3, 0xbf3504f3
    .long 0xbf396842, 0xbf3085bb
    .long 0xbf3daef9, 0xbf2beb4a
    .long 0xbf41d870, 0xbf273656
    .long 0xbf45e403, 0xbf226799
    .long 0xbf49d112, 0xbf1d7fd1
    .long 0xbf4d9f02, 0xbf187fc0
    .long 0xbf514d3d, 0xbf13682a
    .long 0xbf54db31, 0xbf0e39da
    .long 0xbf584853, 0xbf08f59b
    .long 0xbf5b941a, 0xbf039c3d
    .long 0xbf5ebe05, 0xbefc5d27
    .long 0xbf61c598, 0xbef15aea
    .long 0xbf64aa59, 0xbee63375
    .long 0xbf676bd8, 0xbedae880
    .long 0xbf6a09a7, 0xbecf7bca
    .long 0xbf6c835e, 0xbec3ef15
    .long 0xbf6ed89e, 0xbeb8442a
    .long 0xbf710908, 0xbeac7cd4
    .long 0xbf731447, 0xbea09ae5
    .long 0xbf74fa0b, 0xbe94a031
    .long 0xbf76ba07, 0xbe888e93
    .long 0xbf7853f8, 0xbe78cfcc
    .long 0xbf79c79d, 0xbe605c13
    .long 0xbf7b14be, 0xbe47c5c2
    .long 0xbf7c3b28, 0xbe2f10a2
    .long 0xbf7d3aac, 0xbe164083
    .long 0xbf7e1324, 0xbdfab273
    .long 0xbf7ec46d, 0xbdc8bd36
    .long 0xbf7f4e6d, 0xbd96a905
    .long 0xbf7fb10f, 0xbd48fb30
    .long 0xbf7fec43, 0xbcc90ab0
    .long 0x3f800000, 0x80000000
    .long 0x3f7fe705, 0xbce22a7a
    .long 0x3f7f9c18, 0xbd621469
    .long 0x3f7f1f49, 0xbda973ba
    .long 0x3f7e70b0, 0xbde1bc2e
    .long 0x3f7d906e, 0xbe0cec4a
    .long 0x3f7c7eb0, 0xbe28defc
    .long 0x3f7b3bab, 0xbe44b0b9
    .long 0x3f79c79d, 0xbe605c13
    .long 0x3f7822d1, 0xbe7bdba4
    .long 0x3f764d97, 0xbe8b9507
    .long 0x3f74484b, 0xbe9920fe
    .long 0x3f721352, 0xbea68f12
    .long 0x3f6faf1b, 0xbeb3dca5
    .long 0x3f6d1c1d, 0xbec1071e
    .long 0x3f6a5ad9, 0xbece0bea
    .long 0x3f676bd8, 0xbedae880
    .long 0x3f644fac, 0xbee79a5d
    .long 0x3f6106f2, 0xbef41f07
    .long 0x3f5d924d, 0xbf003a06
    .long 0x3f59f26a, 0xbf064b82
    .long 0x3f5627fe, 0xbf0c42c9
    .long 0x3f5233c6, 0xbf121eb0
    .long 0x3f4e1689, 0xbf17de12
    .long 0x3f49d112, 0xbf1d7fd1
    .long 0x3f456439, 0xbf2302d3
    .long 0x3f40d0da, 0xbf286605
    .long 0x3f3c17d9, 0xbf2da859
    .long 0x3f373a23, 0xbf32c8c9
    .long 0x3f3238aa, 0xbf37c655
    .long 0x3f2d1469, 0xbf3ca003
    .long 0x3f27ce61, 0xbf4154e1
    .long 0x3f226799, 0xbf45e403
    .long 0x3f1ce11f, 0xbf4a4c87
    .long 0x3f173c07, 0xbf4e8d90
    .long 0x3f11796b, 0xbf52a649
    .long 0x3f0b9a6b, 0xbf5695e5
    .long 0x3f05a02c, 0xbf5a5ba0
    .long 0x3eff17b2, 0xbf5df6be
    .long 0x3ef2bd43, 0xbf61668a
    .long 0x3ee63375, 0xbf64aa59
    .long 0x3ed97cb9, 0xbf67c187
    .long 0x3ecc9b8b, 0xbf6aab7b
    .long 0x3ebf926f, 0xbf6d67a1
    .long 0x3eb263ef, 0xbf6ff573
    .long 0x3ea5129f, 0xbf725470
    .long 0x3e97a117, 0xbf748422
    .long 0x3e8a11f7, 0xbf76841b
    .long 0x3e78cfcc, 0xbf7853f8
    .long 0x3e5d4b1a, 0xbf79f35e
    .long 0x3e419b37, 0xbf7b61fc
    .long 0x3e25c58c, 0xbf7c9f8a
    .long 0x3e09cf86, 0xbf7dabcc
    .long 0x3ddb7d37, 0xbf7e868b
    .long 0x3da3308c, 0xbf7f2f9d
    .long 0x3d55880e, 0xbf7fa6e3
    .long 0x3cc90ab0, 0xbf7fec43
    .long 0xbb490fc6, 0xbf7fffb1
    .long 0xbcfb49ba, 0xbf7fe129
    .long 0xbd6ea038, 0xbf7f90b1
    .long 0xbdafb680, 0xbf7f0e58
    .long 0xbde7fa9a, 0xbf7e5a38
    .long 0xbe1008b7, 0xbf7d7474
    .long 0xbe2bf804, 0xbf7c5d3a
    .long 0xbe47c5c2, 0xbf7b14be
    .long 0xbe636c83, 0xbf799b43
    .long 0xbe7ee6e1, 0xbf77f110
    .long 0xbe8d17c0, 0xbf76167a
    .long 0xbe9aa086, 0xbf740bdd
    .long 0xbea80b1f, 0xbf71d19f
    .long 0xbeb554ec, 0xbf6f6830
    .long 0xbec27b55, 0xbf6cd007
    .long 0xbecf7bca, 0xbf6a09a7
    .long 0xbedc53c1, 0xbf671599
    .long 0xbee900b7, 0xbf63f473
    .long 0xbef58035, 0xbf60a6cf
    .long 0xbf00e7e4, 0xbf5d2d53
    .long 0xbf06f686, 0xbf5988ad
    .long 0xbf0cead0, 0xbf55b993
    .long 0xbf12c39a, 0xbf51c0c2
    .long 0xbf187fc0, 0xbf4d9f02
    .long 0xbf1e1e22, 0xbf495521
    .long 0xbf239da9, 0xbf44e3f5
    .long 0xbf28fd41, 0xbf404c5c
    .long 0xbf2e3bde, 0xbf3b8f3b
    .long 0xbf33587a, 0xbf36ad7f
    .long 0xbf385216, 0xbf31a81d
    .long 0xbf3d27b8, 0xbf2c800f
    .long 0xbf41d870, 0xbf273656
    .long 0xbf466354, 0xbf21cbfb
    .long 0xbf4ac77f, 0xbf1c420c
    .long 0xbf4f0417, 0xbf16999f
    .long 0xbf531849, 0xbf10d3cd
    .long 0xbf570348, 0xbf0af1b7
    .long 0xbf5ac450, 0xbf04f484
    .long 0xbf5e5aa6, 0xbefdbabb
    .long 0xbf61c598, 0xbef15aea
    .long 0xbf650479, 0xbee4cbfe
    .long 0xbf6816a8, 0xbed8106b
    .long 0xbf6afb8c, 0xbecb2aae
    .long 0xbf6db293, 0xbebe1d4a
    .long 0xbf703b37, 0xbeb0eacb
    .long 0xbf7294f8, 0xbea395c5
    .long 0xbf74bf62, 0xbe9620d2
    .long 0xbf76ba07, 0xbe888e93
    .long 0xbf788486, 0xbe75c35a
    .long 0xbf7a1e84, 0xbe5a3997
    .long 0xbf7b87b2, 0xbe3e853e
    .long 0xbf7cbfc9, 0xbe22abb6
    .long 0xbf7dc68c, 0xbe06b26e
    .long 0xbf7e9bc9, 0xbdd53db9
    .long 0xbf7f3f54, 0xbd9cecf9
    .long 0xbf7fb10f, 0xbd48fb30
    .long 0xbf7ff0e3, 0xbcafea69
    .long 0xbf7ffec4, 0x3bc90f88
    .long 0xbf7fdaaf, 0x3d0a342f
    .long 0xbf7f84ab, 0x3d7b2b74
    .long 0xbf7efcc9, 0x3db5f8da
    .long 0xbf7e4323, 0x3dee3876
    .long 0xbf7d57de, 0x3e1324ca
    .long 0xbf7c3b28, 0x3e2f10a2
    .long 0xbf7aed37, 0x3e4ada4f
    .long 0xbf796e4e, 0x3e667c66
    .long 0xbf77beb7, 0x3e80f8c0
    .long 0xbf75dec6, 0x3e8e9a22
    .long 0xbf73ced9, 0x3e9c1faf
    .long 0xbf718f57, 0x3ea986c4
    .long 0xbf6f20b0, 0x3eb6ccc3
    .long 0x3f800000, 0x80000000
    .long 0x3f7fe129, 0xbcfb49ba
    .long 0x3f7f84ab, 0xbd7b2b74
    .long 0x3f7eea9d, 0xbdbc3ac3
    .long 0x3f7e1324, 0xbdfab273
    .long 0x3f7cfe73, 0xbe1c76de
    .long 0x3f7baccd, 0xbe3b6ecf
    .long 0x3f7a1e84, 0xbe5a3997
    .long 0x3f7853f8, 0xbe78cfcc
    .long 0x3f764d97, 0xbe8b9507
    .long 0x3f740bdd, 0xbe9aa086
    .long 0x3f718f57, 0xbea986c4
    .long 0x3f6ed89e, 0xbeb8442a
    .long 0x3f6be858, 0xbec6d529
    .long 0x3f68bf3c, 0xbed53641
    .long 0x3f655e0b, 0xbee363fa
    .long 0x3f61c598, 0xbef15aea
    .long 0x3f5df6be, 0xbeff17b2
    .long 0x3f59f26a, 0xbf064b82
    .long 0x3f55b993, 0xbf0cead0
    .long 0x3f514d3d, 0xbf13682a
    .long 0x3f4cae79, 0xbf19c200
    .long 0x3f47de65, 0xbf1ff6cb
    .long 0x3f42de29, 0xbf26050a
    .long 0x3f3daef9, 0xbf2beb4a
    .long 0x3f385216, 0xbf31a81d
    .long 0x3f32c8c9, 0xbf373a23
    .long 0x3f2d1469, 0xbf3ca003
    .long 0x3f273656, 0xbf41d870
    .long 0x3f212ff9, 0xbf46e22a
    .long 0x3f1b02c6, 0xbf4bbbf8
    .long 0x3f14b039, 0xbf5064af
    .long 0x3f0e39da, 0xbf54db31
    .long 0x3f07a136, 0xbf591e6a
    .long 0x3f00e7e4, 0xbf5d2d53
    .long 0x3ef41f07, 0xbf6106f2
    .long 0x3ee63375, 0xbf64aa59
    .long 0x3ed8106b, 0xbf6816a8
    .long 0x3ec9b953, 0xbf6b4b0c
    .long 0x3ebb31a0, 0xbf6e46be
    .long 0x3eac7cd4, 0xbf710908
    .long 0x3e9d9e78, 0xbf73913f
    .long 0x3e8e9a22, 0xbf75dec6
    .long 0x3e7ee6e1, 0xbf77f110
    .long 0x3e605c13, 0xbf79c79d
    .long 0x3e419b37, 0xbf7b61fc
    .long 0x3e22abb6, 0xbf7cbfc9
    .long 0x3e039502, 0xbf7de0b1
    .long 0x3dc8bd36, 0xbf7ec46d
    .long 0x3d8a200a, 0xbf7f6ac7
    .long 0x3d16c32c, 0xbf7fd397
    .long 0x3bc90f88, 0xbf7ffec4
    .long 0xbcc90ab0, 0xbf7fec43
    .long 0xbd621469, 0xbf7f9c18
    .long 0xbdafb680, 0xbf7f0e58
    .long 0xbdee3876, 0xbf7e4323
    .long 0xbe164083, 0xbf7d3aac
    .long 0xbe354098, 0xbf7bf531
    .long 0xbe541501, 0xbf7a7302
    .long 0xbe72b651, 0xbf78b47b
    .long 0xbe888e93, 0xbf76ba07
    .long 0xbe97a117, 0xbf748422
    .long 0xbea68f12, 0xbf721352
    .long 0xbeb554ec, 0xbf6f6830
    .long 0xbec3ef15, 0xbf6c835e
    .long 0xbed25a09, 0xbf696591
    .long 0xbee0924f, 0xbf660f88
    .long 0xbeee9479, 0xbf628210
    .long 0xbefc5d27, 0xbf5ebe05
    .long 0xbf04f484, 0xbf5ac450
    .long 0xbf0b9a6b, 0xbf5695e5
    .long 0xbf121eb0, 0xbf5233c6
    .long 0xbf187fc0, 0xbf4d9f02
    .long 0xbf1ebc12, 0xbf48d8b3
    .long 0xbf24d225, 0xbf43e200
    .long 0xbf2ac082, 0xbf3ebc1b
    .long 0xbf3085bb, 0xbf396842
    .long 0xbf36206c, 0xbf33e7bc
    .long 0xbf3b8f3b, 0xbf2e3bde
    .long 0xbf40d0da, 0xbf286605
    .long 0xbf45e403, 0xbf226799
    .long 0xbf4ac77f, 0xbf1c420c
    .long 0xbf4f7a1f, 0xbf15f6d9
    .long 0xbf53fac3, 0xbf0f8784
    .long 0xbf584853, 0xbf08f59b
    .long 0xbf5c61c7, 0xbf0242b1
    .long 0xbf604621, 0xbef6e0cb
    .long 0xbf63f473, 0xbee900b7
    .long 0xbf676bd8, 0xbedae880
    .long 0xbf6aab7b, 0xbecc9b8b
    .long 0xbf6db293, 0xbebe1d4a
    .long 0xbf708066, 0xbeaf713a
    .long 0xbf731447, 0xbea09ae5
    .long 0xbf756d97, 0xbe919ddd
    .long 0xbf778bc5, 0xbe827dc0
    .long 0xbf796e4e, 0xbe667c66
    .long 0xbf7b14be, 0xbe47c5c2
    .long 0xbf7c7eb0, 0xbe28defc
    .long 0xbf7dabcc, 0xbe09cf86
    .long 0xbf7e9bc9, 0xbdd53db9
    .long 0xbf7f4e6d, 0xbd96a905
    .long 0xbf7fc38f, 0xbd2fe007
    .long 0xbf7ffb11, 0xbc490e90
    .long 0xbf7ff4e6, 0x3c96c9b6
    .long 0xbf7fb10f, 0x3d48fb30
    .long 0xbf7f2f9d, 0x3da3308c
    .long 0xbf7e70b0, 0x3de1bc2e
    .long 0xbf7d7474, 0x3e1008b7
    .long 0xbf7c3b28, 0x3e2f10a2
    .long 0xbf7ac516, 0x3e4dee60
    .long 0xbf791298, 0x3e6c9a7f
    .long 0xbf772417, 0x3e8586ce
    .long 0xbf74fa0b, 0x3e94a031
    .long 0xbf7294f8, 0x3ea395c5
    .long 0xbf6ff573, 0x3eb263ef
    .long 0xbf6d1c1d, 0x3ec1071e
    .long 0xbf6a09a7, 0x3ecf7bca
    .long 0xbf66becc, 0x3eddbe79
    .long 0xbf633c5a, 0x3eebcbbb
    .long 0xbf5f8327, 0x3ef9a02d
    .long 0xbf5b941a, 0x3f039c3d
    .long 0xbf577026, 0x3f0a48ad
    .long 0xbf531849, 0x3f10d3cd
    .long 0xbf4e8d90, 0x3f173c07
    .long 0xbf49d112, 0x3f1d7fd1
    .long 0xbf44e3f5, 0x3f239da9
    .long 0xbf3fc767, 0x3f299415
    .long 0xbf3a7ca4, 0x3f2f61a5
    .long 0x3f800000, 0x80000000
    .long 0x3f7fdaaf, 0xbd0a342f
    .long 0x3f7f6ac7, 0xbd8a200a
    .long 0x3f7eb069, 0xbdcefdb7
    .long 0x3f7dabcc, 0xbe09cf86
    .long 0x3f7c5d3a, 0xbe2bf804
    .long 0x3f7ac516, 0xbe4dee60
    .long 0x3f78e3d6, 0xbe6fa8b2
    .long 0x3f76ba07, 0xbe888e93
    .long 0x3f74484b, 0xbe9920fe
    .long 0x3f718f57, 0xbea986c4
    .long 0x3f6e8ff8, 0xbeb9bb1e
    .long 0x3f6b4b0c, 0xbec9b953
    .long 0x3f67c187, 0xbed97cb9
    .long 0x3f63f473, 0xbee900b7
    .long 0x3f5fe4e9, 0xbef840c8
    .long 0x3f5b941a, 0xbf039c3d
    .long 0x3f570348, 0xbf0af1b7
    .long 0x3f5233c6, 0xbf121eb0
    .long 0x3f4d26fd, 0xbf19210f
    .long 0x3f47de65, 0xbf1ff6cb
    .long 0x3f425b89, 0xbf269de3
    .long 0x3f3ca003, 0xbf2d1469
    .long 0x3f36ad7f, 0xbf33587a
    .long 0x3f3085bb, 0xbf396842
    .long 0x3f2a2a80, 0xbf3f41fc
    .long 0x3f239da9, 0xbf44e3f5
    .long 0x3f1ce11f, 0xbf4a4c87
    .long 0x3f15f6d9, 0xbf4f7a1f
    .long 0x3f0ee0db, 0xbf546b3b
    .long 0x3f07a136, 0xbf591e6a
    .long 0x3f003a06, 0xbf5d924d
    .long 0x3ef15aea, 0xbf61c598
    .long 0x3ee1fb6a, 0xbf65b710
    .long 0x3ed25a09, 0xbf696591
    .long 0x3ec27b55, 0xbf6cd007
    .long 0x3eb263ef, 0xbf6ff573
    .long 0x3ea21887, 0xbf72d4eb
    .long 0x3e919ddd, 0xbf756d97
    .long 0x3e80f8c0, 0xbf77beb7
    .long 0x3e605c13, 0xbf79c79d
    .long 0x3e3e853e, 0xbf7b87b2
    .long 0x3e1c76de, 0xbf7cfe73
    .long 0x3df475c0, 0xbf7e2b72
    .long 0x3dafb680, 0xbf7f0e58
    .long 0x3d55880e, 0xbf7fa6e3
    .long 0x3c96c9b6, 0xbf7ff4e6
    .long 0xbc7b514b, 0xbf7ff84a
    .long 0xbd48fb30, 0xbf7fb10f
    .long 0xbda973ba, 0xbf7f1f49
    .long 0xbdee3876, 0xbf7e4323
    .long 0xbe195be0, 0xbf7d1cdd
    .long 0xbe3b6ecf, 0xbf7baccd
    .long 0xbe5d4b1a, 0xbf79f35e
    .long 0xbe7ee6e1, 0xbf77f110
    .long 0xbe901c2c, 0xbf75a67b
    .long 0xbea09ae5, 0xbf731447
    .long 0xbeb0eacb, 0xbf703b37
    .long 0xbec1071e, 0xbf6d1c1d
    .long 0xbed0eb2a, 0xbf69b7e4
    .long 0xbee0924f, 0xbf660f88
    .long 0xbeeff7fb, 0xbf62241a
    .long 0xbeff17b2, 0xbf5df6be
    .long 0xbf06f686, 0xbf5988ad
    .long 0xbf0e39da, 0xbf54db31
    .long 0xbf1553b7, 0xbf4fefa8
    .long 0xbf1c420c, 0xbf4ac77f
    .long 0xbf2302d3, 0xbf456439
    .long 0xbf299415, 0xbf3fc767
    .long 0xbf2ff3e6, 0xbf39f2ac
    .long 0xbf36206c, 0xbf33e7bc
    .long 0xbf3c17d9, 0xbf2da859
    .long 0xbf41d870, 0xbf273656
    .long 0xbf476085, 0xbf209393
    .long 0xbf4cae79, 0xbf19c200
    .long 0xbf51c0c2, 0xbf12c39a
    .long 0xbf5695e5, 0xbf0b9a6b
    .long 0xbf5b2c79, 0xbf044889
    .long 0xbf5f8327, 0xbef9a02d
    .long 0xbf6398ac, 0xbeea6681
    .long 0xbf676bd8, 0xbedae880
    .long 0xbf6afb8c, 0xbecb2aae
    .long 0xbf6e46be, 0xbebb31a0
    .long 0xbf714c7a, 0xbeab0201
    .long 0xbf740bdd, 0xbe9aa086
    .long 0xbf76841b, 0xbe8a11f7
    .long 0xbf78b47b, 0xbe72b651
    .long 0xbf7a9c59, 0xbe5101f1
    .long 0xbf7c3b28, 0xbe2f10a2
    .long 0xbf7d906e, 0xbe0cec4a
    .long 0xbf7e9bc9, 0xbdd53db9
    .long 0xbf7f5ce9, 0xbd9064b4
    .long 0xbf7fd397, 0xbd16c32c
    .long 0xbf7fffb1, 0xbb490fc6
    .long 0xbf7fe129, 0x3cfb49ba
    .long 0xbf7f7808, 0x3d83db0a
    .long 0xbf7ec46d, 0x3dc8bd36
    .long 0xbf7dc68c, 0x3e06b26e
    .long 0xbf7c7eb0, 0x3e28defc
    .long 0xbf7aed37, 0x3e4ada4f
    .long 0xbf791298, 0x3e6c9a7f
    .long 0xbf76ef5b, 0x3e870ada
    .long 0xbf748422, 0x3e97a117
    .long 0xbf71d19f, 0x3ea80b1f
    .long 0xbf6ed89e, 0x3eb8442a
    .long 0xbf6b99fb, 0x3ec8477c
    .long 0xbf6816a8, 0x3ed8106b
    .long 0xbf644fac, 0x3ee79a5d
    .long 0xbf604621, 0x3ef6e0cb
    .long 0xbf5bfb34, 0x3f02ef9f
    .long 0xbf577026, 0x3f0a48ad
    .long 0xbf52a649, 0x3f11796b
    .long 0xbf4d9f02, 0x3f187fc0
    .long 0xbf485bca, 0x3f1f599f
    .long 0xbf42de29, 0x3f26050a
    .long 0xbf3d27b8, 0x3f2c800f
    .long 0xbf373a23, 0x3f32c8c9
    .long 0xbf311722, 0x3f38dd65
    .long 0xbf2ac082, 0x3f3ebc1b
    .long 0xbf24381a, 0x3f446337
    .long 0xbf1d7fd1, 0x3f49d112
    .long 0xbf16999f, 0x3f4f0417
    .long 0xbf0f8784, 0x3f53fac3
    .long 0xbf084b92, 0x3f58b3a1
    .long 0xbf00e7e4, 0x3f5d2d53
    .long 0xbef2bd43, 0x3f61668a
    .long 0xbee363fa, 0x3f655e0b
    .long 0xbed3c867, 0x3f6912ae
    .long 0x3f800000, 0x80000000
    .long 0x3f7fd397, 0xbd16c32c
    .long 0x3f7f4e6d, 0xbd96a905
    .long 0x3f7e70b0, 0xbde1bc2e
    .long 0x3f7d3aac, 0xbe164083
    .long 0x3f7baccd, 0xbe3b6ecf
    .long 0x3f79c79d, 0xbe605c13
    .long 0x3f778bc5, 0xbe827dc0
    .long 0x3f74fa0b, 0xbe94a031
    .long 0x3f721352, 0xbea68f12
    .long 0x3f6ed89e, 0xbeb8442a
    .long 0x3f6b4b0c, 0xbec9b953
    .long 0x3f676bd8, 0xbedae880
    .long 0x3f633c5a, 0xbeebcbbb
    .long 0x3f5ebe05, 0xbefc5d27
    .long 0x3f59f26a, 0xbf064b82
    .long 0x3f54db31, 0xbf0e39da
    .long 0x3f4f7a1f, 0xbf15f6d9
    .long 0x3f49d112, 0xbf1d7fd1
    .long 0x3f43e200, 0xbf24d225
    .long 0x3f3daef9, 0xbf2beb4a
    .long 0x3f373a23, 0xbf32c8c9
    .long 0x3f3085bb, 0xbf396842
    .long 0x3f299415, 0xbf3fc767
    .long 0x3f226799, 0xbf45e403
    .long 0x3f1b02c6, 0xbf4bbbf8
    .long 0x3f13682a, 0xbf514d3d
    .long 0x3f0b9a6b, 0xbf5695e5
    .long 0x3f039c3d, 0xbf5b941a
    .long 0x3ef6e0cb, 0xbf604621
    .long 0x3ee63375, 0xbf64aa59
    .long 0x3ed53641, 0xbf68bf3c
    .long 0x3ec3ef15, 0xbf6c835e
    .long 0x3eb263ef, 0xbf6ff573
    .long 0x3ea09ae5, 0xbf731447
    .long 0x3e8e9a22, 0xbf75dec6
    .long 0x3e78cfcc, 0xbf7853f8
    .long 0x3e541501, 0xbf7a7302
    .long 0x3e2f10a2, 0xbf7c3b28
    .long 0x3e09cf86, 0xbf7dabcc
    .long 0x3dc8bd36, 0xbf7ec46d
    .long 0x3d7b2b74, 0xbf7f84ab
    .long 0x3cc90ab0, 0xbf7fec43
    .long 0xbc490e90, 0xbf7ffb11
    .long 0xbd48fb30, 0xbf7fb10f
    .long 0xbdafb680, 0xbf7f0e58
    .long 0xbdfab273, 0xbf7e1324
    .long 0xbe22abb6, 0xbf7cbfc9
    .long 0xbe47c5c2, 0xbf7b14be
    .long 0xbe6c9a7f, 0xbf791298
    .long 0xbe888e93, 0xbf76ba07
    .long 0xbe9aa086, 0xbf740bdd
    .long 0xbeac7cd4, 0xbf710908
    .long 0xbebe1d4a, 0xbf6db293
    .long 0xbecf7bca, 0xbf6a09a7
    .long 0xbee0924f, 0xbf660f88
    .long 0xbef15aea, 0xbf61c598
    .long 0xbf00e7e4, 0xbf5d2d53
    .long 0xbf08f59b, 0xbf584853
    .long 0xbf10d3cd, 0xbf531849
    .long 0xbf187fc0, 0xbf4d9f02
    .long 0xbf1ff6cb, 0xbf47de65
    .long 0xbf273656, 0xbf41d870
    .long 0xbf2e3bde, 0xbf3b8f3b
    .long 0xbf3504f3, 0xbf3504f3
    .long 0xbf3b8f3b, 0xbf2e3bde
    .long 0xbf41d870, 0xbf273656
    .long 0xbf47de65, 0xbf1ff6cb
    .long 0xbf4d9f02, 0xbf187fc0
    .long 0xbf531849, 0xbf10d3cd
    .long 0xbf584853, 0xbf08f59b
    .long 0xbf5d2d53, 0xbf00e7e4
    .long 0xbf61c598, 0xbef15aea
    .long 0xbf660f88, 0xbee0924f
    .long 0xbf6a09a7, 0xbecf7bca
    .long 0xbf6db293, 0xbebe1d4a
    .long 0xbf710908, 0xbeac7cd4
    .long 0xbf740bdd, 0xbe9aa086
    .long 0xbf76ba07, 0xbe888e93
    .long 0xbf791298, 0xbe6c9a7f
    .long 0xbf7b14be, 0xbe47c5c2
    .long 0xbf7cbfc9, 0xbe22abb6
    .long 0xbf7e1324, 0xbdfab273
    .long 0xbf7f0e58, 0xbdafb680
    .long 0xbf7fb10f, 0xbd48fb30
    .long 0xbf7ffb11, 0xbc490e90
    .long 0xbf7fec43, 0x3cc90ab0
    .long 0xbf7f84ab, 0x3d7b2b74
    .long 0xbf7ec46d, 0x3dc8bd36
    .long 0xbf7dabcc, 0x3e09cf86
    .long 0xbf7c3b28, 0x3e2f10a2
    .long 0xbf7a7302, 0x3e541501
    .long 0xbf7853f8, 0x3e78cfcc
    .long 0xbf75dec6, 0x3e8e9a22
    .long 0xbf731447, 0x3ea09ae5
    .long 0xbf6ff573, 0x3eb263ef
    .long 0xbf6c835e, 0x3ec3ef15
    .long 0xbf68bf3c, 0x3ed53641
    .long 0xbf64aa59, 0x3ee63375
    .long 0xbf604621, 0x3ef6e0cb
    .long 0xbf5b941a, 0x3f039c3d
    .long 0xbf5695e5, 0x3f0b9a6b
    .long 0xbf514d3d, 0x3f13682a
    .long 0xbf4bbbf8, 0x3f1b02c6
    .long 0xbf45e403, 0x3f226799
    .long 0xbf3fc767, 0x3f299415
    .long 0xbf396842, 0x3f3085bb
    .long 0xbf32c8c9, 0x3f373a23
    .long 0xbf2beb4a, 0x3f3daef9
    .long 0xbf24d225, 0x3f43e200
    .long 0xbf1d7fd1, 0x3f49d112
    .long 0xbf15f6d9, 0x3f4f7a1f
    .long 0xbf0e39da, 0x3f54db31
    .long 0xbf064b82, 0x3f59f26a
    .long 0xbefc5d27, 0x3f5ebe05
    .long 0xbeebcbbb, 0x3f633c5a
    .long 0xbedae880, 0x3f676bd8
    .long 0xbec9b953, 0x3f6b4b0c
    .long 0xbeb8442a, 0x3f6ed89e
    .long 0xbea68f12, 0x3f721352
    .long 0xbe94a031, 0x3f74fa0b
    .long 0xbe827dc0, 0x3f778bc5
    .long 0xbe605c13, 0x3f79c79d
    .long 0xbe3b6ecf, 0x3f7baccd
    .long 0xbe164083, 0x3f7d3aac
    .long 0xbde1bc2e, 0x3f7e70b0
    .long 0xbd96a905, 0x3f7f4e6d
    .long 0xbd16c32c, 0x3f7fd397
    .long 0x3f800000, 0x80000000
    .long 0x3f7fcbe2, 0xbd2351cb
    .long 0x3f7f2f9d, 0xbda3308c
    .long 0x3f7e2b72, 0xbdf475c0
    .long 0x3f7cbfc9, 0xbe22abb6
    .long 0x3f7aed37, 0xbe4ada4f
    .long 0x3f78b47b, 0xbe72b651
    .long 0x3f76167a, 0xbe8d17c0
    .long 0x3f731447, 0xbea09ae5
    .long 0x3f6faf1b, 0xbeb3dca5
    .long 0x3f6be858, 0xbec6d529
    .long 0x3f67c187, 0xbed97cb9
    .long 0x3f633c5a, 0xbeebcbbb
    .long 0x3f5e5aa6, 0xbefdbabb
    .long 0x3f591e6a, 0xbf07a136
    .long 0x3f5389c7, 0xbf102dd5
    .long 0x3f4d9f02, 0xbf187fc0
    .long 0x3f476085, 0xbf209393
    .long 0x3f40d0da, 0xbf286605
    .long 0x3f39f2ac, 0xbf2ff3e6
    .long 0x3f32c8c9, 0xbf373a23
    .long 0x3f2b561b, 0xbf3e35c5
    .long 0x3f239da9, 0xbf44e3f5
    .long 0x3f1ba299, 0xbf4b41fa
    .long 0x3f13682a, 0xbf514d3d
    .long 0x3f0af1b7, 0xbf570348
    .long 0x3f0242b1, 0xbf5c61c7
    .long 0x3ef2bd43, 0xbf61668a
    .long 0x3ee0924f, 0xbf660f88
    .long 0x3ece0bea, 0xbf6a5ad9
    .long 0x3ebb31a0, 0xbf6e46be
    .long 0x3ea80b1f, 0xbf71d19f
    .long 0x3e94a031, 0xbf74fa0b
    .long 0x3e80f8c0, 0xbf77beb7
    .long 0x3e5a3997, 0xbf7a1e84
    .long 0x3e3228d4, 0xbf7c187a
    .long 0x3e09cf86, 0xbf7dabcc
    .long 0x3dc27c39, 0xbf7ed7d4
    .long 0x3d621469, 0xbf7f9c18
    .long 0x3c7b514b, 0xbf7ff84a
    .long 0xbcc90ab0, 0xbf7fec43
    .long 0xbd83db0a, 0xbf7f7808
    .long 0xbdd53db9, 0xbf7e9bc9
    .long 0xbe1324ca, 0xbf7d57de
    .long 0xbe3b6ecf, 0xbf7baccd
    .long 0xbe636c83, 0xbf799b43
    .long 0xbe8586ce, 0xbf772417
    .long 0xbe9920fe, 0xbf74484b
    .long 0xbeac7cd4, 0xbf710908
    .long 0xbebf926f, 0xbf6d67a1
    .long 0xbed25a09, 0xbf696591
    .long 0xbee4cbfe, 0xbf650479
    .long 0xbef6e0cb, 0xbf604621
    .long 0xbf044889, 0xbf5b2c79
    .long 0xbf0cead0, 0xbf55b993
    .long 0xbf1553b7, 0xbf4fefa8
    .long 0xbf1d7fd1, 0xbf49d112
    .long 0xbf256bcb, 0xbf436051
    .long 0xbf2d1469, 0xbf3ca003
    .long 0xbf34768f, 0xbf3592e7
    .long 0xbf3b8f3b, 0xbf2e3bde
    .long 0xbf425b89, 0xbf269de3
    .long 0xbf48d8b3, 0xbf1ebc12
    .long 0xbf4f0417, 0xbf16999f
    .long 0xbf54db31, 0xbf0e39da
    .long 0xbf5a5ba0, 0xbf05a02c
    .long 0xbf5f8327, 0xbef9a02d
    .long 0xbf644fac, 0xbee79a5d
    .long 0xbf68bf3c, 0xbed53641
    .long 0xbf6cd007, 0xbec27b55
    .long 0xbf708066, 0xbeaf713a
    .long 0xbf73ced9, 0xbe9c1faf
    .long 0xbf76ba07, 0xbe888e93
    .long 0xbf7940c0, 0xbe698bba
    .long 0xbf7b61fc, 0xbe419b37
    .long 0xbf7d1cdd, 0xbe195be0
    .long 0xbf7e70b0, 0xbde1bc2e
    .long 0xbf7f5ce9, 0xbd9064b4
    .long 0xbf7fe129, 0xbcfb49ba
    .long 0xbf7ffd39, 0x3c16cb58
    .long 0xbf7fb10f, 0x3d48fb30
    .long 0xbf7efcc9, 0x3db5f8da
    .long 0xbf7de0b1, 0x3e039502
    .long 0xbf7c5d3a, 0x3e2bf804
    .long 0xbf7a7302, 0x3e541501
    .long 0xbf7822d1, 0x3e7bdba4
    .long 0xbf756d97, 0x3e919ddd
    .long 0xbf725470, 0x3ea5129f
    .long 0xbf6ed89e, 0x3eb8442a
    .long 0xbf6afb8c, 0x3ecb2aae
    .long 0xbf66becc, 0x3eddbe79
    .long 0xbf62241a, 0x3eeff7fb
    .long 0xbf5d2d53, 0x3f00e7e4
    .long 0xbf57dc7f, 0x3f099f4e
    .long 0xbf5233c6, 0x3f121eb0
    .long 0xbf4c3578, 0x3f1a6293
    .long 0xbf45e403, 0x3f226799
    .long 0xbf3f41fc, 0x3f2a2a80
    .long 0xbf385216, 0x3f31a81d
    .long 0xbf311722, 0x3f38dd65
    .long 0xbf299415, 0x3f3fc767
    .long 0xbf21cbfb, 0x3f466354
    .long 0xbf19c200, 0x3f4cae79
    .long 0xbf11796b, 0x3f52a649
    .long 0xbf08f59b, 0x3f584853
    .long 0xbf003a06, 0x3f5d924d
    .long 0xbeee9479, 0x3f628210
    .long 0xbedc53c1, 0x3f671599
    .long 0xbec9b953, 0x3f6b4b0c
    .long 0xbeb6ccc3, 0x3f6f20b0
    .long 0xbea395c5, 0x3f7294f8
    .long 0xbe901c2c, 0x3f75a67b
    .long 0xbe78cfcc, 0x3f7853f8
    .long 0xbe5101f1, 0x3f7a9c59
    .long 0xbe28defc, 0x3f7c7eb0
    .long 0xbe007745, 0x3f7dfa38
    .long 0xbdafb680, 0x3f7f0e58
    .long 0xbd3c6dd5, 0x3f7fba9e
    .long 0xbbc90f88, 0x3f7ffec4
    .long 0x3d0a342f, 0x3f7fdaaf
    .long 0x3d96a905, 0x3f7f4e6d
    .long 0x3de7fa9a, 0x3f7e5a38
    .long 0x3e1c76de, 0x3f7cfe73
    .long 0x3e44b0b9, 0x3f7b3bab
    .long 0x3e6c9a7f, 0x3f791298
    .long 0x3e8a11f7, 0x3f76841b
    .long 0x3e9d9e78, 0x3f73913f
    .long 0x3eb0eacb, 0x3f703b37
    .long 0x3f800000, 0x80000000
    .long 0x3f7fc38f, 0xbd2fe007
    .long 0x3f7f0e58, 0xbdafb680
    .long 0x3f7de0b1, 0xbe039502
    .long 0x3f7c3b28, 0xbe2f10a2
    .long 0x3f7a1e84, 0xbe5a3997
    .long 0x3f778bc5, 0xbe827dc0
    .long 0x3f748422, 0xbe97a117
    .long 0x3f710908, 0xbeac7cd4
    .long 0x3f6d1c1d, 0xbec1071e
    .long 0x3f68bf3c, 0xbed53641
    .long 0x3f63f473, 0xbee900b7
    .long 0x3f5ebe05, 0xbefc5d27
    .long 0x3f591e6a, 0xbf07a136
    .long 0x3f531849, 0xbf10d3cd
    .long 0x3f4cae79, 0xbf19c200
    .long 0x3f45e403, 0xbf226799
    .long 0x3f3ebc1b, 0xbf2ac082
    .long 0x3f373a23, 0xbf32c8c9
    .long 0x3f2f61a5, 0xbf3a7ca4
    .long 0x3f273656, 0xbf41d870
    .long 0x3f1ebc12, 0xbf48d8b3
    .long 0x3f15f6d9, 0xbf4f7a1f
    .long 0x3f0cead0, 0xbf55b993
    .long 0x3f039c3d, 0xbf5b941a
    .long 0x3ef41f07, 0xbf6106f2
    .long 0x3ee0924f, 0xbf660f88
    .long 0x3ecc9b8b, 0xbf6aab7b
    .long 0x3eb8442a, 0xbf6ed89e
    .long 0x3ea395c5, 0xbf7294f8
    .long 0x3e8e9a22, 0xbf75dec6
    .long 0x3e72b651, 0xbf78b47b
    .long 0x3e47c5c2, 0xbf7b14be
    .long 0x3e1c76de, 0xbf7cfe73
    .long 0x3de1bc2e, 0xbf7e70b0
    .long 0x3d8a200a, 0xbf7f6ac7
    .long 0x3cc90ab0, 0xbf7fec43
    .long 0xbc96c9b6, 0xbf7ff4e6
    .long 0xbd7b2b74, 0xbf7f84ab
    .long 0xbdd53db9, 0xbf7e9bc9
    .long 0xbe164083, 0xbf7d3aac
    .long 0xbe419b37, 0xbf7b61fc
    .long 0xbe6c9a7f, 0xbf791298
    .long 0xbe8b9507, 0xbf764d97
    .long 0xbea09ae5, 0xbf731447
    .long 0xbeb554ec, 0xbf6f6830
    .long 0xbec9b953, 0xbf6b4b0c
    .long 0xbeddbe79, 0xbf66becc
    .long 0xbef15aea, 0xbf61c598
    .long 0xbf0242b1, 0xbf5c61c7
    .long 0xbf0b9a6b, 0xbf5695e5
    .long 0xbf14b039, 0xbf5064af
    .long 0xbf1d7fd1, 0xbf49d112
    .long 0xbf26050a, 0xbf42de29
    .long 0xbf2e3bde, 0xbf3b8f3b
    .long 0xbf36206c, 0xbf33e7bc
    .long 0xbf3daef9, 0xbf2beb4a
    .long 0xbf44e3f5, 0xbf239da9
    .long 0xbf4bbbf8, 0xbf1b02c6
    .long 0xbf5233c6, 0xbf121eb0
    .long 0xbf584853, 0xbf08f59b
    .long 0xbf5df6be, 0xbeff17b2
    .long 0xbf633c5a, 0xbeebcbbb
    .long 0xbf6816a8, 0xbed8106b
    .long 0xbf6c835e, 0xbec3ef15
    .long 0xbf708066, 0xbeaf713a
    .long 0xbf740bdd, 0xbe9aa086
    .long 0xbf772417, 0xbe8586ce
    .long 0xbf79c79d, 0xbe605c13
    .long 0xbf7bf531, 0xbe354098
    .long 0xbf7dabcc, 0xbe09cf86
    .long 0xbf7eea9d, 0xbdbc3ac3
    .long 0xbf7fb10f, 0xbd48fb30
    .long 0xbf7ffec4, 0xbbc90f88
    .long 0xbf7fd397, 0x3d16c32c
    .long 0xbf7f2f9d, 0x3da3308c
    .long 0xbf7e1324, 0x3dfab273
    .long 0xbf7c7eb0, 0x3e28defc
    .long 0xbf7a7302, 0x3e541501
    .long 0xbf77f110, 0x3e7ee6e1
    .long 0xbf74fa0b, 0x3e94a031
    .long 0xbf718f57, 0x3ea986c4
    .long 0xbf6db293, 0x3ebe1d4a
    .long 0xbf696591, 0x3ed25a09
    .long 0xbf64aa59, 0x3ee63375
    .long 0xbf5f8327, 0x3ef9a02d
    .long 0xbf59f26a, 0x3f064b82
    .long 0xbf53fac3, 0x3f0f8784
    .long 0xbf4d9f02, 0x3f187fc0
    .long 0xbf46e22a, 0x3f212ff9
    .long 0xbf3fc767, 0x3f299415
    .long 0xbf385216, 0x3f31a81d
    .long 0xbf3085bb, 0x3f396842
    .long 0xbf286605, 0x3f40d0da
    .long 0xbf1ff6cb, 0x3f47de65
    .long 0xbf173c07, 0x3f4e8d90
    .long 0xbf0e39da, 0x3f54db31
    .long 0xbf04f484, 0x3f5ac450
    .long 0xbef6e0cb, 0x3f604621
    .long 0xbee363fa, 0x3f655e0b
    .long 0xbecf7bca, 0x3f6a09a7
    .long 0xbebb31a0, 0x3f6e46be
    .long 0xbea68f12, 0x3f721352
    .long 0xbe919ddd, 0x3f756d97
    .long 0xbe78cfcc, 0x3f7853f8
    .long 0xbe4dee60, 0x3f7ac516
    .long 0xbe22abb6, 0x3f7cbfc9
    .long 0xbdee3876, 0x3f7e4323
    .long 0xbd96a905, 0x3f7f4e6d
    .long 0xbcfb49ba, 0x3f7fe129
    .long 0x3c490e90, 0x3f7ffb11
    .long 0x3d621469, 0x3f7f9c18
    .long 0x3dc8bd36, 0x3f7ec46d
    .long 0x3e1008b7, 0x3f7d7474
    .long 0x3e3b6ecf, 0x3f7baccd
    .long 0x3e667c66, 0x3f796e4e
    .long 0x3e888e93, 0x3f76ba07
    .long 0x3e9d9e78, 0x3f73913f
    .long 0x3eb263ef, 0x3f6ff573
    .long 0x3ec6d529, 0x3f6be858
    .long 0x3edae880, 0x3f676bd8
    .long 0x3eee9479, 0x3f628210
    .long 0x3f00e7e4, 0x3f5d2d53
    .long 0x3f0a48ad, 0x3f577026
    .long 0x3f13682a, 0x3f514d3d
    .long 0x3f1c420c, 0x3f4ac77f
    .long 0x3f24d225, 0x3f43e200
    .long 0x3f2d1469, 0x3f3ca003
    .long 0x3f800000, 0x80000000
    .long 0x3f7fba9e, 0xbd3c6dd5
    .long 0x3f7eea9d, 0xbdbc3ac3
    .long 0x3f7d906e, 0xbe0cec4a
    .long 0x3f7baccd, 0xbe3b6ecf
    .long 0x3f7940c0, 0xbe698bba
    .long 0x3f764d97, 0xbe8b9507
    .long 0x3f72d4eb, 0xbea21887
    .long 0x3f6ed89e, 0xbeb8442a
    .long 0x3f6a5ad9, 0xbece0bea
    .long 0x3f655e0b, 0xbee363fa
    .long 0x3f5fe4e9, 0xbef840c8
    .long 0x3f59f26a, 0xbf064b82
    .long 0x3f5389c7, 0xbf102dd5
    .long 0x3f4cae79, 0xbf19c200
    .long 0x3f456439, 0xbf2302d3
    .long 0x3f3daef9, 0xbf2beb4a
    .long 0x3f3592e7, 0xbf34768f
    .long 0x3f2d1469, 0xbf3ca003
    .long 0x3f24381a, 0xbf446337
    .long 0x3f1b02c6, 0xbf4bbbf8
    .long 0x3f11796b, 0xbf52a649
    .long 0x3f07a136, 0xbf591e6a
    .long 0x3efafef7, 0xbf5f20db
    .long 0x3ee63375, 0xbf64aa59
    .long 0x3ed0eb2a, 0xbf69b7e4
    .long 0x3ebb31a0, 0xbf6e46be
    .long 0x3ea5129f, 0xbf725470
    .long 0x3e8e9a22, 0xbf75dec6
    .long 0x3e6fa8b2, 0xbf78e3d6
    .long 0x3e419b37, 0xbf7b61fc
    .long 0x3e1324ca, 0xbf7d57de
    .long 0x3dc8bd36, 0xbf7ec46d
    .long 0x3d55880e, 0xbf7fa6e3
    .long 0x3bc90f88, 0xbf7ffec4
    .long 0xbd2351cb, 0xbf7fcbe2
    .long 0xbdafb680, 0xbf7f0e58
    .long 0xbe06b26e, 0xbf7dc68c
    .long 0xbe354098, 0xbf7bf531
    .long 0xbe636c83, 0xbf799b43
    .long 0xbe888e93, 0xbf76ba07
    .long 0xbe9f1cdf, 0xbf73530e
    .long 0xbeb554ec, 0xbf6f6830
    .long 0xbecb2aae, 0xbf6afb8c
    .long 0xbee0924f, 0xbf660f88
    .long 0xbef58035, 0xbf60a6cf
    .long 0xbf04f484, 0xbf5ac450
    .long 0xbf0ee0db, 0xbf546b3b
    .long 0xbf187fc0, 0xbf4d9f02
    .long 0xbf21cbfb, 0xbf466354
    .long 0xbf2ac082, 0xbf3ebc1b
    .long 0xbf33587a, 0xbf36ad7f
    .long 0xbf3b8f3b, 0xbf2e3bde
    .long 0xbf436051, 0xbf256bcb
    .long 0xbf4ac77f, 0xbf1c420c
    .long 0xbf51c0c2, 0xbf12c39a
    .long 0xbf584853, 0xbf08f59b
    .long 0xbf5e5aa6, 0xbefdbabb
    .long 0xbf63f473, 0xbee900b7
    .long 0xbf6912ae, 0xbed3c867
    .long 0xbf6db293, 0xbebe1d4a
    .long 0xbf71d19f, 0xbea80b1f
    .long 0xbf756d97, 0xbe919ddd
    .long 0xbf788486, 0xbe75c35a
    .long 0xbf7b14be, 0xbe47c5c2
    .long 0xbf7d1cdd, 0xbe195be0
    .long 0xbf7e9bc9, 0xbdd53db9
    .long 0xbf7f90b1, 0xbd6ea038
    .long 0xbf7ffb11, 0xbc490e90
    .long 0xbf7fdaaf, 0x3d0a342f
    .long 0xbf7f2f9d, 0x3da3308c
    .long 0xbf7dfa38, 0x3e007745
    .long 0xbf7c3b28, 0x3e2f10a2
    .long 0xbf79f35e, 0x3e5d4b1a
    .long 0xbf772417, 0x3e8586ce
    .long 0xbf73ced9, 0x3e9c1faf
    .long 0xbf6ff573, 0x3eb263ef
    .long 0xbf6b99fb, 0x3ec8477c
    .long 0xbf66becc, 0x3eddbe79
    .long 0xbf61668a, 0x3ef2bd43
    .long 0xbf5b941a, 0x3f039c3d
    .long 0xbf554aa4, 0x3f0d9281
    .long 0xbf4e8d90, 0x3f173c07
    .long 0xbf476085, 0x3f209393
    .long 0xbf3fc767, 0x3f299415
    .long 0xbf37c655, 0x3f3238aa
    .long 0xbf2f61a5, 0x3f3a7ca4
    .long 0xbf269de3, 0x3f425b89
    .long 0xbf1d7fd1, 0x3f49d112
    .long 0xbf140c5f, 0x3f50d937
    .long 0xbf0a48ad, 0x3f577026
    .long 0xbf003a06, 0x3f5d924d
    .long 0xbeebcbbb, 0x3f633c5a
    .long 0xbed6a399, 0x3f686b39
    .long 0xbec1071e, 0x3f6d1c1d
    .long 0xbeab0201, 0x3f714c7a
    .long 0xbe94a031, 0x3f74fa0b
    .long 0xbe7bdba4, 0x3f7822d1
    .long 0xbe4dee60, 0x3f7ac516
    .long 0xbe1f917b, 0x3f7cdf6c
    .long 0xbde1bc2e, 0x3f7e70b0
    .long 0xbd83db0a, 0x3f7f7808
    .long 0xbc96c9b6, 0x3f7ff4e6
    .long 0x3ce22a7a, 0x3f7fe705
    .long 0x3d96a905, 0x3f7f4e6d
    .long 0x3df475c0, 0x3f7e2b72
    .long 0x3e28defc, 0x3f7c7eb0
    .long 0x3e57278f, 0x3f7a4910
    .long 0x3e827dc0, 0x3f778bc5
    .long 0x3e9920fe, 0x3f74484b
    .long 0x3eaf713a, 0x3f708066
    .long 0x3ec5625c, 0x3f6c3624
    .long 0x3edae880, 0x3f676bd8
    .long 0x3eeff7fb, 0x3f62241a
    .long 0x3f0242b1, 0x3f5c61c7
    .long 0x3f0c42c9, 0x3f5627fe
    .long 0x3f15f6d9, 0x3f4f7a1f
    .long 0x3f1f599f, 0x3f485bca
    .long 0x3f286605, 0x3f40d0da
    .long 0x3f311722, 0x3f38dd65
    .long 0x3f396842, 0x3f3085bb
    .long 0x3f4154e1, 0x3f27ce61
    .long 0x3f48d8b3, 0x3f1ebc12
    .long 0x3f4fefa8, 0x3f1553b7
    .long 0x3f5695e5, 0x3f0b9a6b
    .long 0x3f5cc7d1, 0x3f019573
    .long 0x3f628210, 0x3eee9479
    .long 0x3f67c187, 0x3ed97cb9
    .long 0x3f800000, 0x80000000
    .long 0x3f7fb10f, 0xbd48fb30
    .long 0x3f7ec46d, 0xbdc8bd36
    .long 0x3f7d3aac, 0xbe164083
    .long 0x3f7b14be, 0xbe47c5c2
    .long 0x3f7853f8, 0xbe78cfcc
    .long 0x3f74fa0b, 0xbe94a031
    .long 0x3f710908, 0xbeac7cd4
    .long 0x3f800000, 0x80000000
    .long 0x3f7ec46d, 0xbdc8bd36
    .long 0x3f7b14be, 0xbe47c5c2
    .long 0x3f74fa0b, 0xbe94a031
    .long 0x3f6c835e, 0xbec3ef15
    .long 0x3f61c598, 0xbef15aea
    .long 0x3f54db31, 0xbf0e39da
    .long 0x3f45e403, 0xbf226799
    .long 0x3f800000, 0x80000000
    .long 0x3f7d3aac, 0xbe164083
    .long 0x3f74fa0b, 0xbe94a031
    .long 0x3f676bd8, 0xbedae880
    .long 0x3f54db31, 0xbf0e39da
    .long 0x3f3daef9, 0xbf2beb4a
    .long 0x3f226799, 0xbf45e403
    .long 0x3f039c3d, 0xbf5b941a
    .long 0x3f800000, 0x80000000
    .long 0x3f7b14be, 0xbe47c5c2
    .long 0x3f6c835e, 0xbec3ef15
    .long 0x3f54db31, 0xbf0e39da
    .long 0x3f3504f3, 0xbf3504f3
    .long 0x3f0e39da, 0xbf54db31
    .long 0x3ec3ef15, 0xbf6c835e
    .long 0x3e47c5c2, 0xbf7b14be
    .long 0x3f800000, 0x80000000
    .long 0x3f7853f8, 0xbe78cfcc
    .long 0x3f61c598, 0xbef15aea
    .long 0x3f3daef9, 0xbf2beb4a
    .long 0x3f0e39da, 0xbf54db31
    .long 0x3eac7cd4, 0xbf710908
    .long 0x3dc8bd36, 0xbf7ec46d
    .long 0xbe164083, 0xbf7d3aac
    .long 0x3f800000, 0x80000000
    .long 0x3f74fa0b, 0xbe94a031
    .long 0x3f54db31, 0xbf0e39da
    .long 0x3f226799, 0xbf45e403
    .long 0x3ec3ef15, 0xbf6c835e
    .long 0x3dc8bd36, 0xbf7ec46d
    .long 0xbe47c5c2, 0xbf7b14be
    .long 0xbef15aea, 0xbf61c598
    .long 0x3f800000, 0x80000000
    .long 0x3f710908, 0xbeac7cd4
    .long 0x3f45e403, 0xbf226799
    .long 0x3f039c3d, 0xbf5b941a
    .long 0x3e47c5c2, 0xbf7b14be
    .long 0xbe164083, 0xbf7d3aac
    .long 0xbef15aea, 0xbf61c598
    .long 0xbf3daef9, 0xbf2beb4a
    .long 0x3f800000, 0x80000000
    .long 0x3f6c835e, 0xbec3ef15
    .long 0x3f3504f3, 0xbf3504f3
    .long 0x3ec3ef15, 0xbf6c835e
    .long 0x248d3132, 0xbf800000
    .long 0xbec3ef15, 0xbf6c835e
    .long 0xbf3504f3, 0xbf3504f3
    .long 0xbf6c835e, 0xbec3ef15
    .long 0x3f800000, 0x80000000
    .long 0x3f676bd8, 0xbedae880
    .long 0x3f226799, 0xbf45e403
    .long 0x3e78cfcc, 0xbf7853f8
    .long 0xbe47c5c2, 0xbf7b14be
    .long 0xbf187fc0, 0xbf4d9f02
    .long 0xbf61c598, 0xbef15aea
    .long 0xbf7fb10f, 0xbd48fb30
    .long 0x3f800000, 0x80000000
    .long 0x3f61c598, 0xbef15aea
    .long 0x3f0e39da, 0xbf54db31
    .long 0x3dc8bd36, 0xbf7ec46d
    .long 0xbec3ef15, 0xbf6c835e
    .long 0xbf45e403, 0xbf226799
    .long 0xbf7b14be, 0xbe47c5c2
    .long 0xbf74fa0b, 0x3e94a031
    .long 0x3f800000, 0x80000000
    .long 0x3f5b941a, 0xbf039c3d
    .long 0x3ef15aea, 0xbf61c598
    .long 0xbd48fb30, 0xbf7fb10f
    .long 0xbf0e39da, 0xbf54db31
    .long 0xbf676bd8, 0xbedae880
    .long 0xbf7ec46d, 0x3dc8bd36
    .long 0xbf4d9f02, 0x3f187fc0
    .long 0x3f800000, 0x80000000
    .long 0x3f54db31, 0xbf0e39da
    .long 0x3ec3ef15, 0xbf6c835e
    .long 0xbe47c5c2, 0xbf7b14be
    .long 0xbf3504f3, 0xbf3504f3
    .long 0xbf7b14be, 0xbe47c5c2
    .long 0xbf6c835e, 0x3ec3ef15
    .long 0xbf0e39da, 0x3f54db31
    .long 0x3f800000, 0x80000000
    .long 0x3f4d9f02, 0xbf187fc0
    .long 0x3e94a031, 0xbf74fa0b
    .long 0xbeac7cd4, 0xbf710908
    .long 0xbf54db31, 0xbf0e39da
    .long 0xbf7fb10f, 0x3d48fb30
    .long 0xbf45e403, 0x3f226799
    .long 0xbe78cfcc, 0x3f7853f8
    .long 0x3f800000, 0x80000000
    .long 0x3f45e403, 0xbf226799
    .long 0x3e47c5c2, 0xbf7b14be
    .long 0xbef15aea, 0xbf61c598
    .long 0xbf6c835e, 0xbec3ef15
    .long 0xbf74fa0b, 0x3e94a031
    .long 0xbf0e39da, 0x3f54db31
    .long 0x3dc8bd36, 0x3f7ec46d
    .long 0x3f800000, 0x80000000
    .long 0x3f3daef9, 0xbf2beb4a
    .long 0x3dc8bd36, 0xbf7ec46d
    .long 0xbf187fc0, 0xbf4d9f02
    .long 0xbf7b14be, 0xbe47c5c2
    .long 0xbf5b941a, 0x3f039c3d
    .long 0xbe94a031, 0x3f74fa0b
    .long 0x3edae880, 0x3f676bd8
.size twk2, 16320
.section .rodata,"a"
.p2align 6
.amdhsa_kernel k1_kernel
  .amdhsa_next_free_vgpr 100
  .amdhsa_next_free_sgpr 102
  .amdhsa_accum_offset 100
  .amdhsa_group_segment_fixed_size 0
  .amdhsa_kernarg_size 88
  .amdhsa_user_sgpr_count 2
  .amdhsa_user_sgpr_kernarg_segment_ptr 1
  .amdhsa_system_sgpr_workgroup_id_x 1
.end_amdhsa_kernel
.amdhsa_kernel k2_kernel
  .amdhsa_next_free_vgpr 152
  .amdhsa_next_free_sgpr 102
  .amdhsa_accum_offset 152
  .amdhsa_group_segment_fixed_size 0
  .amdhsa_kernarg_size 88
  .amdhsa_user_sgpr_count 2
  .amdhsa_user_sgpr_kernarg_segment_ptr 1
  .amdhsa_system_sgpr_workgroup_id_x 1
.end_amdhsa_kernel
.amdhsa_kernel k3_kernel
  .amdhsa_next_free_vgpr 136
  .amdhsa_next_free_sgpr 102
  .amdhsa_accum_offset 136
  .amdhsa_group_segment_fixed_size 0
  .amdhsa_kernarg_size 88
  .amdhsa_user_sgpr_count 2
  .amdhsa_user_sgpr_kernarg_segment_ptr 1
  .amdhsa_system_sgpr_workgroup_id_x 1
.end_amdhsa_kernel
.amdhsa_kernel k4_kernel
  .amdhsa_next_free_vgpr 248
  .amdhsa_next_free_sgpr 102
  .amdhsa_accum_offset 248
  .amdhsa_group_segment_fixed_size 0
  .amdhsa_kernarg_size 88
  .amdhsa_user_sgpr_count 2
  .amdhsa_user_sgpr_kernarg_segment_ptr 1
  .amdhsa_system_sgpr_workgroup_id_x 1
.end_amdhsa_kernel
.amdhsa_kernel k5_kernel
  .amdhsa_next_free_vgpr 208
  .amdhsa_next_free_sgpr 102
  .amdhsa_accum_offset 208
  .amdhsa_group_segment_fixed_size 0
  .amdhsa_kernarg_size 88
  .amdhsa_user_sgpr_count 2
  .amdhsa_user_sgpr_kernarg_segment_ptr 1
  .amdhsa_system_sgpr_workgroup_id_x 1
.end_amdhsa_kernel
```
